```python
import torch

def _softmax(x, axis=-1):
    return torch.softmax(x, dim=axis)
def _gelu(x):
    return torch.nn.functional.gelu(x, approximate="tanh")
def _silu(x):
    return torch.nn.functional.silu(x)
def _sigmoid(x):
    return torch.sigmoid(x)
def _layernorm(x, axis=-1, eps=1e-5):
    m = x.mean(dim=axis, keepdim=True)
    v = x.var(dim=axis, keepdim=True, unbiased=False)
    return (x - m) / torch.sqrt(v + eps)
def _scatter_add(tgt, idx, src, axis=0):
    return tgt.clone().index_add_(axis, idx, src)
def _segment_sum(src, seg, n):
    out = torch.zeros((n,) + src.shape[1:], dtype=src.dtype)
    return out.index_add_(0, seg, src)
def _pad(x, pw):
    flat = tuple(v for pair in reversed(pw) for v in pair)
    return torch.nn.functional.pad(x, flat)

kernel_name = 'parallel_sum__sliding_local_dilated__glu_gated_swiglu__prompt'

def setup_inputs():

    _w = (lambda a: (lambda t: t.to(torch.bfloat16) if t.is_floating_point() else t)(torch.as_tensor(a)))
    def _A_setup():
        B, S, D = 1, 2048, 640
        return {
            "x": _w((lambda *s: torch.randn(*s, dtype=torch.bfloat16) * 0.05)(B, S, D)),
            "wqkv": _w((lambda *s: torch.randn(*s, dtype=torch.bfloat16) * 0.05)(D, 3 * D)),
            "wo": _w((lambda *s: torch.randn(*s, dtype=torch.bfloat16) * 0.05)(D, D)),
        }
    _A_in = _A_setup()

    def _B_setup():
        B, S, D, F = 1, 2048, 640, 1536
        return {
            "x": _w((lambda *s: torch.randn(*s, dtype=torch.bfloat16) * 0.05)(B, S, D)),
            "w1": _w((lambda *s: torch.randn(*s, dtype=torch.bfloat16) * 0.8)(D, F) * (2.0 / D) ** 0.5),
            "w3": _w((lambda *s: torch.randn(*s, dtype=torch.bfloat16) * 0.8)(D, F) * (2.0 / D) ** 0.5),
            "w2": _w((lambda *s: torch.randn(*s, dtype=torch.bfloat16) * 0.8)(F, D) * (2.0 / F) ** 0.5),
        }
    _B_in = _B_setup()

    return {
        "A_x": _A_in["x"],
        "A_wqkv": _A_in["wqkv"],
        "A_wo": _A_in["wo"],
        "B_x": _B_in["x"],
        "B_w1": _B_in["w1"],
        "B_w3": _B_in["w3"],
        "B_w2": _B_in["w2"],
    }

def reference(A_x, A_wqkv, A_wo, B_x, B_w1, B_w3, B_w2):
    def _A_ref(x, wqkv, wo):
        B, S, D = x.shape
        H = 32; Dh = D // H
        W, dil = 8, 2
        qkv = (lambda x, *d: x.permute(*d))((x @ wqkv).reshape(B, S, 3, H, Dh), 2, 0, 3, 1, 4)
        q, k, v = qkv[0], qkv[1], qkv[2]
        scale = Dh ** -0.5
        pos = torch.arange(S)
        off = torch.arange(W) * dil
        idx = pos[:, None] - off[None, :]
        mask = idx >= 0
        idx_c = torch.where(mask, idx, 0).reshape(-1)
        kg = k[:, :, idx_c, :].reshape(B, H, S, W, Dh)
        vg = v[:, :, idx_c, :].reshape(B, H, S, W, Dh)
        logits = torch.einsum("bhsd,bhswd->bhsw", q, kg) * scale
        logits = torch.where(mask[None, None, :, :], logits, -1e9)
        attn = _softmax(logits, axis=-1)
        o = torch.einsum("bhsw,bhswd->bhsd", attn, vg)
        return (lambda x, *d: x.permute(*d))(o, 0, 2, 1, 3).reshape(B, S, D) @ wo

    def _B_ref(x, w1, w3, w2):
        gate = torch.einsum("bsd,df->bsf", x, w1)
        up = torch.einsum("bsd,df->bsf", x, w3)
        h = _silu(gate) * up
        out = torch.einsum("bsf,fd->bsd", h, w2)
        return out

    x = A_x
    xn = _layernorm(x, axis=-1)
    return x + _A_ref(xn, A_wqkv, A_wo) + _B_ref(xn, B_w1, B_w3, B_w2)
```

```asm
; @launch kernel=g1_kernel grid=(256,1,1) block=(512,1,1) lds=163840
.amdgcn_target "amdgcn-amd-amdhsa--gfx950"
.text
.globl g1_kernel
.p2align 8
.type g1_kernel,@function
g1_kernel:
    s_cmp_ge_u32 s2, 256
    s_cbranch_scc1 G1_done
    s_load_dwordx2 s[16:17], s[0:1], 0
    s_load_dwordx2 s[18:19], s[0:1], 72
    s_load_dwordx4 s[24:27], s[0:1], 32
    s_load_dwordx2 s[28:29], s[0:1], 8
    s_load_dwordx2 s[80:81], s[0:1], 16
    s_load_dwordx2 s[82:83], s[0:1], 48
    s_load_dwordx2 s[6:7], s[0:1], 56
    s_getpc_b64 s[4:5]
G1_pc:
    v_lshlrev_b32 v255, 7, v0
    v_min_u32 v255, G1_done-G1_pc, v255
    global_load_dword v255, v255, s[4:5]
    s_and_b32 s3, s2, 7
    s_lshr_b32 s20, s2, 3
    v_lshrrev_b32 v1, 6, v0
    v_and_b32 v2, 63, v0
    s_nop 0
    v_readfirstlane_b32 s22, v1
    v_lshlrev_b32 v4, 4, v2
    s_mov_b32 s50, 0xffff0000
    v_lshrrev_b32 v10, 4, v2
    v_and_b32 v11, 1, v1
    v_lshl_add_u32 v10, v11, 2, v10
    v_and_b32 v11, 7, v2
    v_xor_b32 v10, v10, v11
    v_lshrrev_b32 v11, 3, v2
    v_mul_u32_u24 v11, 2560, v11
    v_lshl_add_u32 v5, v10, 4, v11
    v_and_b32 v10, 15, v2
    v_lshrrev_b32 v11, 1, v10
    v_lshrrev_b32 v12, 4, v2
    v_xor_b32 v11, v11, v12
    v_lshlrev_b32 v10, 7, v10
    v_lshl_add_u32 v3, v11, 4, v10
    v_and_b32 v10, 15, v2
    v_and_b32 v11, 32, v2
    v_lshl_add_u32 v10, v10, 1, v11
    v_and_b32 v11, 1, v12
    v_add_lshl_u32 v232, v10, v11, 3
    s_waitcnt lgkmcnt(0)
    s_mov_b32 s8, s16
    s_mov_b32 s9, s17
    s_and_b32 s9, s9, 0xffff
    s_mov_b32 s10, 0x280000
    s_mov_b32 s11, 0x00020000
    s_mov_b32 s38, s10
    s_add_u32 s64, s18, 0x1580000
    s_addc_u32 s65, s19, 0
    s_and_b32 s65, s65, 0xffff
    s_mov_b32 s66, 0x65000
    s_mov_b32 s67, 0x00020000
    s_buffer_load_dword s76, s[64:67], 68608
    s_lshl_b32 s40, s2, 3
    s_add_u32 s40, s40, s22
    s_lshl_b32 s68, s40, 3
    s_add_u32 s68, s68, 69632
    s_mul_i32 s41, s40, 1280
    v_lshlrev_b32 v10, 2, v2
    buffer_load_dword v128, v10, s[8:11], s41 offen offset:0
    buffer_load_dword v129, v10, s[8:11], s41 offen offset:256
    buffer_load_dword v130, v10, s[8:11], s41 offen offset:512
    buffer_load_dword v131, v10, s[8:11], s41 offen offset:768
    buffer_load_dword v132, v10, s[8:11], s41 offen offset:1024
    v_lshlrev_b32 v231, 2, v0
    v_add_u32 v231, 65536, v231
    s_mov_b32 s78, 0x5010
    s_mov_b32 s36, 0
    s_mov_b32 s37, 0
    s_lshl_b32 s30, s22, 10
    s_cmp_ge_u32 s20, 16
    s_cbranch_scc1 G1_qkv
    s_lshl_b32 s23, s3, 1
    s_and_b32 s21, s20, 1
    s_add_u32 s23, s23, s21
    s_lshr_b32 s21, s20, 1
    s_lshl_b32 s69, s21, 5
    s_and_b32 s40, s22, 3
    s_lshl_b32 s40, s40, 3
    s_add_u32 s69, s69, s40
    s_and_b32 s40, s22, 4
    s_add_u32 s69, s69, s40
    s_lshr_b32 s40, s23, 2
    s_add_u32 s69, s69, s40
    s_lshl_b32 s69, s69, 8
    s_and_b32 s40, s23, 3
    s_lshl_b32 s40, s40, 2
    s_add_u32 s69, s69, s40
    s_mov_b32 s48, 0
    s_mov_b32 s49, 0
    s_lshl_b32 s40, s21, 11
    s_add_u32 s40, s40, 69632
    s_and_b32 s41, s22, 3
    s_lshl_b32 s41, s41, 9
    s_add_u32 s40, s40, s41
    v_add_u32 v237, s40, v232
    s_cmp_lt_u32 s22, 6
    s_cselect_b32 s12, s24, s26
    s_cselect_b32 s13, s25, s27
    s_and_b32 s13, s13, 0xffff
    s_mov_b32 s44, s26
    s_and_b32 s45, s27, 0xffff
    s_mov_b32 s14, 1966080
    s_mov_b32 s15, 0x00020000
    s_mov_b32 s47, 0x00020000
    s_cmp_lt_u32 s22, 4
    s_cselect_b32 s46, s14, 0
    s_cselect_b32 s42, 1, 0
    v_subrev_u32 v14, 6, v1
    v_cmp_gt_u32 vcc, 6, v1
    s_nop 1
    v_cndmask_b32 v14, v14, v1, vcc
    v_mul_u32_u24 v10, 86, v14
    v_lshrrev_b32 v10, 8, v10
    v_mul_u32_u24 v11, 3, v10
    v_sub_u32 v11, v14, v11
    v_lshl_add_u32 v11, v11, 6, v2
    v_mul_u32_u24 v12, 171, v11
    v_lshrrev_b32 v12, 11, v12
    v_mul_u32_u24 v13, 12, v12
    v_sub_u32 v13, v11, v13
    v_lshl_add_u32 v12, v10, 4, v12
    v_bfe_u32 v10, v12, 3, 1
    v_lshlrev_b32 v10, 1, v10
    v_xor_b32 v13, v13, v10
    v_mul_u32_u24 v12, 3072, v12
    v_lshl_add_u32 v6, v13, 4, v12
    v_add_u32 v14, 2, v1
    v_and_b32 v14, 7, v14
    v_min_u32 v14, 5, v14
    v_mul_u32_u24 v10, 86, v14
    v_lshrrev_b32 v10, 8, v10
    v_mul_u32_u24 v11, 3, v10
    v_sub_u32 v11, v14, v11
    v_lshl_add_u32 v11, v11, 6, v2
    v_mul_u32_u24 v12, 171, v11
    v_lshrrev_b32 v12, 11, v12
    v_mul_u32_u24 v13, 12, v12
    v_sub_u32 v13, v11, v13
    v_lshl_add_u32 v12, v10, 4, v12
    v_bfe_u32 v10, v12, 3, 1
    v_lshlrev_b32 v10, 1, v10
    v_xor_b32 v13, v13, v10
    v_mul_u32_u24 v12, 3072, v12
    v_lshl_add_u32 v7, v13, 4, v12
    s_lshr_b32 s32, s22, 2
    s_lshl_b32 s32, s32, 5
    s_bfe_u32 s41, s22, 0x10001
    s_add_u32 s32, s32, s41
    s_and_b32 s41, s22, 1
    s_lshl_b32 s41, s41, 4
    s_add_u32 s32, s32, s41
    s_lshl_b32 s41, s21, 8
    s_add_u32 s32, s32, s41
    s_mul_i32 s32, s32, 1280
    s_mul_i32 s33, s23, 192
    s_cmp_lt_u32 s22, 4
    s_mov_b32 s29, 155648
    s_cselect_b32 s29, 106496, s29
    s_add_u32 s29, s29, s30
    s_add_u32 s40, s30, s36
    s_add_u32 m0, s40, 0
    s_add_u32 s41, s32, 0
    buffer_load_dwordx4 v5, s[8:11], s41 offen lds
    s_add_u32 m0, s40, 8192
    s_add_u32 s41, s32, 81920
    buffer_load_dwordx4 v5, s[8:11], s41 offen lds
    s_add_u32 s40, s30, s36
    s_add_u32 m0, s40, 16384
    s_add_u32 s41, s32, 163840
    buffer_load_dwordx4 v5, s[8:11], s41 offen lds
    s_add_u32 m0, s40, 24576
    s_add_u32 s41, s32, 245760
    buffer_load_dwordx4 v5, s[8:11], s41 offen lds
    s_add_u32 s32, s32, 128
    s_add_u32 s36, s36, 32768
    s_cmp_eq_u32 s36, 98304
    s_cselect_b32 s36, 0, s36
    s_add_u32 s40, s30, s48
    s_add_u32 m0, s40, 98304
    s_mul_i32 s40, s48, s42
    buffer_load_dwordx4 v6, s[12:15], s33 offen lds
    s_add_u32 m0, s40, s29
    s_nop 0
    buffer_load_dwordx4 v7, s[44:47], s33 offen lds
    s_add_u32 s33, s33, 98304
    s_add_u32 s48, s48, 12288
    s_cmp_eq_u32 s48, 49152
    s_cselect_b32 s48, 0, s48
    v_and_b32 v14, 3, v1
    v_lshl_add_u32 v14, v14, 13, v3
    v_lshrrev_b32 v15, 2, v1
    v_lshl_add_u32 v10, v15, 12, v14
    v_xor_b32 v11, 4096, v10
    v_xor_b32 v12, 64, v10
    v_xor_b32 v13, 64, v11
    v_lshrrev_b32 v17, 4, v2
    v_bfe_u32 v18, v2, 2, 2
    v_lshl_add_u32 v18, v17, 3, v18
    v_mul_u32_u24 v18, 192, v18
    v_add_u32 v18, 98304, v18
    v_and_b32 v17, 1, v17
    v_lshlrev_b32 v17, 5, v17
    v_and_b32 v19, 3, v2
    v_lshlrev_b32 v19, 3, v19
    v_mul_u32_u24 v15, 96, v15
    v_add_u32 v19, v19, v15
    s_and_b32 s56, s22, 3
    s_cmp_eq_u32 s56, 3
    s_cselect_b32 s56, 0, s56
    s_lshl_b32 s56, s56, 5
    s_add_u32 s57, s56, 32
    s_cmp_eq_u32 s57, 96
    s_cselect_b32 s57, 0, s57
    s_add_u32 s58, s57, 32
    s_cmp_eq_u32 s58, 96
    s_cselect_b32 s58, 0, s58
    v_add_u32 v20, s56, v19
    v_xor_b32 v20, v20, v17
    v_add_u32 v14, v20, v18
    v_add_u32 v20, s57, v19
    v_xor_b32 v20, v20, v17
    v_add_u32 v15, v20, v18
    v_add_u32 v20, s58, v19
    v_xor_b32 v20, v20, v17
    v_add_u32 v16, v20, v18
    s_add_u32 s52, s18, 0xa00000
    s_addc_u32 s53, s19, 0
    s_and_b32 s53, s53, 0xffff
    s_mov_b32 s54, 0x2a8000
    s_mov_b32 s55, 0x00020000
    s_lshr_b32 s59, s2, 6
    s_cmp_eq_u32 s59, 3
    s_cselect_b32 s59, 0, s59
    s_lshl_b32 s59, s59, 10
    s_add_u32 s60, s59, 1024
    s_cmp_eq_u32 s60, 3072
    s_cselect_b32 s60, 0, s60
    s_add_u32 s61, s60, 1024
    s_cmp_eq_u32 s61, 3072
    s_cselect_b32 s61, 0, s61
    s_bfe_u32 s74, s2, 0x30003
    s_mul_i32 s74, s74, 68*5120
    s_mul_i32 s73, s22, 6*5120
    s_add_u32 s73, s73, s74
    s_add_u32 s73, s73, 20*5120
    s_mul_i32 s70, s59, 5
    s_add_u32 s70, s70, s73
    s_mul_i32 s71, s60, 5
    s_add_u32 s71, s71, s73
    s_mul_i32 s72, s61, 5
    s_add_u32 s72, s72, s73
    s_and_b32 s73, s22, 3
    s_mul_i32 s73, s73, 5*5120
    s_add_u32 s40, s73, s74
    s_mov_b32 s41, s70
    s_mov_b32 s75, s71
    s_mov_b32 s43, s72
    s_cmp_lt_u32 s22, 4
    s_cselect_b32 s70, s41, s40
    s_cmp_lt_u32 s22, 4
    s_cselect_b32 s71, s41, s40
    s_cselect_b32 s35, 15, 5
    s_lshl_b32 s35, s35, 10
    s_add_u32 s71, s71, s35
    s_cmp_lt_u32 s22, 4
    s_cselect_b32 s72, s75, s40
    s_cselect_b32 s35, 0, 10240
    s_add_u32 s72, s72, s35
    s_cmp_lt_u32 s22, 4
    s_cselect_b32 s73, s75, s41
    s_cselect_b32 s35, 15360, 0
    s_add_u32 s73, s73, s35
    s_cmp_lt_u32 s22, 4
    s_cselect_b32 s74, s43, s41
    s_cselect_b32 s35, 0, 15360
    s_add_u32 s74, s74, s35
    s_cmp_lt_u32 s22, 4
    s_cselect_b32 s80, s43, s75
    s_cselect_b32 s35, 15360, 0
    s_add_u32 s80, s80, s35
    s_cmp_lt_u32 s22, 4
    s_cselect_b32 s81, s40, s75
    s_add_u32 s81, s81, 15360
    s_cmp_lt_u32 s22, 4
    s_cselect_b32 s82, s40, s43
    s_cselect_b32 s35, 20480, 0
    s_add_u32 s82, s82, s35
    s_add_u32 s83, s43, 15360
    s_lshr_b32 s26, s22, 2
    s_lshl_b32 s26, s26, 1
    s_lshl_b32 s25, s21, 4
    s_and_b32 s27, s22, 3
    s_lshl_b32 s27, s27, 2
    s_add_u32 s25, s25, s27
    s_xor_b32 s27, s26, 2
    s_add_u32 s27, s27, s25
    s_add_u32 s25, s25, s26
    s_mul_i32 s25, s25, 69632
    s_mul_i32 s27, s27, 69632
    s_mul_i32 s26, s26, 12288
    s_add_u32 s25, s25, s26
    s_add_u32 s27, s27, s26
    s_and_b32 s26, s23, 1
    s_lshl_b32 s26, s26, 9
    s_add_u32 s25, s25, s26
    s_add_u32 s27, s27, s26
    s_mul_i32 s26, s3, 3072
    s_add_u32 s26, s26, 20480
    s_add_u32 s25, s25, s26
    s_add_u32 s27, s27, s26
    s_lshl_b32 s26, s56, 5
    s_add_u32 s4, s25, s26
    s_add_u32 s5, s27, s26
    s_lshl_b32 s26, s57, 5
    s_add_u32 s20, s25, s26
    s_add_u32 s28, s27, s26
    s_lshl_b32 s26, s58, 5
    s_add_u32 s39, s25, s26
    s_add_u32 s51, s27, s26
    v_mov_b32 v32, 0
    v_mov_b32 v33, 0
    v_mov_b32 v34, 0
    v_mov_b32 v35, 0
    v_mov_b32 v36, 0
    v_mov_b32 v37, 0
    v_mov_b32 v38, 0
    v_mov_b32 v39, 0
    v_mov_b32 v40, 0
    v_mov_b32 v41, 0
    v_mov_b32 v42, 0
    v_mov_b32 v43, 0
    v_mov_b32 v44, 0
    v_mov_b32 v45, 0
    v_mov_b32 v46, 0
    v_mov_b32 v47, 0
    v_mov_b32 v48, 0
    v_mov_b32 v49, 0
    v_mov_b32 v50, 0
    v_mov_b32 v51, 0
    v_mov_b32 v52, 0
    v_mov_b32 v53, 0
    v_mov_b32 v54, 0
    v_mov_b32 v55, 0
    v_mov_b32 v56, 0
    v_mov_b32 v57, 0
    v_mov_b32 v58, 0
    v_mov_b32 v59, 0
    v_mov_b32 v60, 0
    v_mov_b32 v61, 0
    v_mov_b32 v62, 0
    v_mov_b32 v63, 0
    v_mov_b32 v64, 0
    v_mov_b32 v65, 0
    v_mov_b32 v66, 0
    v_mov_b32 v67, 0
    v_mov_b32 v68, 0
    v_mov_b32 v69, 0
    v_mov_b32 v70, 0
    v_mov_b32 v71, 0
    v_mov_b32 v72, 0
    v_mov_b32 v73, 0
    v_mov_b32 v74, 0
    v_mov_b32 v75, 0
    v_mov_b32 v76, 0
    v_mov_b32 v77, 0
    v_mov_b32 v78, 0
    v_mov_b32 v79, 0
    v_mov_b32 v80, 0
    v_mov_b32 v81, 0
    v_mov_b32 v82, 0
    v_mov_b32 v83, 0
    v_mov_b32 v84, 0
    v_mov_b32 v85, 0
    v_mov_b32 v86, 0
    v_mov_b32 v87, 0
    v_mov_b32 v88, 0
    v_mov_b32 v89, 0
    v_mov_b32 v90, 0
    v_mov_b32 v91, 0
    v_mov_b32 v92, 0
    v_mov_b32 v93, 0
    v_mov_b32 v94, 0
    v_mov_b32 v95, 0
    v_mov_b32 v96, 0
    v_mov_b32 v97, 0
    v_mov_b32 v98, 0
    v_mov_b32 v99, 0
    v_mov_b32 v100, 0
    v_mov_b32 v101, 0
    v_mov_b32 v102, 0
    v_mov_b32 v103, 0
    v_mov_b32 v104, 0
    v_mov_b32 v105, 0
    v_mov_b32 v106, 0
    v_mov_b32 v107, 0
    v_mov_b32 v108, 0
    v_mov_b32 v109, 0
    v_mov_b32 v110, 0
    v_mov_b32 v111, 0
    v_mov_b32 v112, 0
    v_mov_b32 v113, 0
    v_mov_b32 v114, 0
    v_mov_b32 v115, 0
    v_mov_b32 v116, 0
    v_mov_b32 v117, 0
    v_mov_b32 v118, 0
    v_mov_b32 v119, 0
    v_mov_b32 v120, 0
    v_mov_b32 v121, 0
    v_mov_b32 v122, 0
    v_mov_b32 v123, 0
    v_mov_b32 v124, 0
    v_mov_b32 v125, 0
    v_mov_b32 v126, 0
    v_mov_b32 v127, 0
    v_mov_b32 v208, 0
    v_mov_b32 v209, 0
    v_mov_b32 v210, 0
    v_mov_b32 v211, 0
    v_mov_b32 v212, 0
    v_mov_b32 v213, 0
    v_mov_b32 v214, 0
    v_mov_b32 v215, 0
    v_mov_b32 v28, 0x3f803f80
    v_mov_b32 v29, 0x3f803f80
    v_mov_b32 v30, 0x3f803f80
    v_mov_b32 v31, 0x3f803f80
    s_mov_b32 s35, 0
    s_lshl_b32 s77, s21, 1
    s_sub_u32 s77, 14, s77
    s_bitset1_b32 s78, s77
    s_lshl_b32 s63, s23, 1
    s_lshr_b32 s40, s22, 2
    s_add_u32 s63, s63, s40
    s_mul_i32 s63, s63, 6144
    s_lshl_b32 s40, s56, 6
    s_add_u32 s63, s63, s40
    s_add_u32 s63, s63, 86016
    s_add_u32 s40, s30, s36
    s_add_u32 m0, s40, 0
    s_add_u32 s41, s32, 0
    buffer_load_dwordx4 v5, s[8:11], s41 offen lds
    s_add_u32 m0, s40, 8192
    s_add_u32 s41, s32, 81920
    buffer_load_dwordx4 v5, s[8:11], s41 offen lds
    s_add_u32 s40, s30, s48
    s_add_u32 m0, s40, 98304
    s_mul_i32 s40, s48, s42
    buffer_load_dwordx4 v6, s[12:15], s33 offen lds
    s_add_u32 m0, s40, s29
    s_nop 0
    buffer_load_dwordx4 v7, s[44:47], s33 offen lds
    s_add_u32 s33, s33, 98304
    s_add_u32 s48, s48, 12288
    s_cmp_eq_u32 s48, 49152
    s_cselect_b32 s48, 0, s48
    s_add_u32 s40, s30, s36
    s_add_u32 m0, s40, 16384
    s_add_u32 s41, s32, 163840
    buffer_load_dwordx4 v5, s[8:11], s41 offen lds
    s_add_u32 m0, s40, 24576
    s_add_u32 s41, s32, 245760
    buffer_load_dwordx4 v5, s[8:11], s41 offen lds
    s_add_u32 s32, s32, 128
    s_add_u32 s36, s36, 32768
    s_cmp_eq_u32 s36, 98304
    s_cselect_b32 s36, 0, s36
    s_add_u32 s40, s30, s48
    s_add_u32 m0, s40, 98304
    s_mul_i32 s40, s48, s42
    buffer_load_dwordx4 v6, s[12:15], s33 offen lds
    s_add_u32 m0, s40, s29
    s_nop 0
    buffer_load_dwordx4 v7, s[44:47], s33 offen lds
    s_add_u32 s33, s33, 98304
    s_add_u32 s48, s48, 12288
    s_cmp_eq_u32 s48, 49152
    s_cselect_b32 s48, 0, s48
    s_waitcnt vmcnt(14)
    v_lshlrev_b32 v134, 16, v128
    v_and_b32 v135, s50, v128
    v_lshlrev_b32 v136, 16, v129
    v_and_b32 v137, s50, v129
    v_lshlrev_b32 v138, 16, v130
    v_and_b32 v139, s50, v130
    v_lshlrev_b32 v140, 16, v131
    v_and_b32 v141, s50, v131
    v_lshlrev_b32 v142, 16, v132
    v_and_b32 v143, s50, v132
    v_add_f32 v144, v134, v135
    v_add_f32 v145, v136, v137
    v_add_f32 v144, v144, v138
    v_add_f32 v145, v145, v139
    v_add_f32 v144, v144, v140
    v_add_f32 v145, v145, v141
    v_add_f32 v144, v144, v142
    v_add_f32 v145, v145, v143
    v_add_f32 v144, v144, v145
    s_nop 1
    v_add_f32_dpp v144, v144, v144 row_ror:8 row_mask:0xf bank_mask:0xf
    s_nop 1
    v_add_f32_dpp v144, v144, v144 row_ror:4 row_mask:0xf bank_mask:0xf
    s_nop 1
    v_add_f32_dpp v144, v144, v144 row_ror:2 row_mask:0xf bank_mask:0xf
    s_nop 1
    v_add_f32_dpp v144, v144, v144 row_ror:1 row_mask:0xf bank_mask:0xf
    s_nop 1
    v_add_f32_dpp v144, v144, v144 row_bcast:15 row_mask:0xa bank_mask:0xf
    s_nop 1
    v_add_f32_dpp v144, v144, v144 row_bcast:31 row_mask:0xc bank_mask:0xf
    s_nop 1
    v_readlane_b32 s40, v144, 63
    v_mov_b32 v146, 0x3acccccd
    s_nop 0
    v_mul_f32 v147, s40, v146
    v_sub_f32 v134, v134, v147
    v_sub_f32 v135, v135, v147
    v_sub_f32 v136, v136, v147
    v_sub_f32 v137, v137, v147
    v_sub_f32 v138, v138, v147
    v_sub_f32 v139, v139, v147
    v_sub_f32 v140, v140, v147
    v_sub_f32 v141, v141, v147
    v_sub_f32 v142, v142, v147
    v_sub_f32 v143, v143, v147
    v_mul_f32 v144, v134, v134
    v_mul_f32 v145, v135, v135
    v_fmac_f32 v144, v136, v136
    v_fmac_f32 v145, v137, v137
    v_fmac_f32 v144, v138, v138
    v_fmac_f32 v145, v139, v139
    v_fmac_f32 v144, v140, v140
    v_fmac_f32 v145, v141, v141
    v_fmac_f32 v144, v142, v142
    v_fmac_f32 v145, v143, v143
    v_add_f32 v144, v144, v145
    s_nop 1
    v_add_f32_dpp v144, v144, v144 row_ror:8 row_mask:0xf bank_mask:0xf
    s_nop 1
    v_add_f32_dpp v144, v144, v144 row_ror:4 row_mask:0xf bank_mask:0xf
    s_nop 1
    v_add_f32_dpp v144, v144, v144 row_ror:2 row_mask:0xf bank_mask:0xf
    s_nop 1
    v_add_f32_dpp v144, v144, v144 row_ror:1 row_mask:0xf bank_mask:0xf
    s_nop 1
    v_add_f32_dpp v144, v144, v144 row_bcast:15 row_mask:0xa bank_mask:0xf
    s_nop 1
    v_add_f32_dpp v144, v144, v144 row_bcast:31 row_mask:0xc bank_mask:0xf
    s_nop 1
    v_readlane_b32 s40, v144, 63
    s_nop 1
    v_mul_f32 v148, s40, v146
    v_cvt_pk_bf16_f32 v148, v148, v148
    v_lshlrev_b32 v148, 16, v148
    v_add_f32 v148, 0x3727c5ac, v148
    v_cvt_pk_bf16_f32 v148, v148, v148
    v_lshlrev_b32 v148, 16, v148
    v_sqrt_f32 v148, v148
    s_nop 0
    v_cvt_pk_bf16_f32 v238, v147, v148
    s_waitcnt vmcnt(8) lgkmcnt(0)
    s_add_u32 s76, s76, 0x9e3779b9
    v_add_u32 v22, s37, v10
    v_add_u32 v23, s37, v11
    v_add_u32 v24, s49, v14
    v_add_u32 v25, s49, v15
    v_add_u32 v26, s49, v16
    s_barrier
    ds_read_b128 v[128:131], v22 offset:0
    ds_read_b128 v[132:135], v22 offset:2048
    ds_read_b128 v[136:139], v23 offset:0
    ds_read_b128 v[140:143], v23 offset:2048
    ds_read_b64_tr_b16 v[144:145], v24 offset:0
    ds_read_b64_tr_b16 v[146:147], v24 offset:768
    ds_read_b64_tr_b16 v[148:149], v25 offset:0
    ds_read_b64_tr_b16 v[150:151], v25 offset:768
    ds_read_b64_tr_b16 v[152:153], v26 offset:0
    ds_read_b64_tr_b16 v[154:155], v26 offset:768
    ds_read_b64_tr_b16 v[156:157], v24 offset:6144
    ds_read_b64_tr_b16 v[158:159], v24 offset:6912
    ds_read_b64_tr_b16 v[160:161], v25 offset:6144
    ds_read_b64_tr_b16 v[162:163], v25 offset:6912
    ds_read_b64_tr_b16 v[164:165], v26 offset:6144
    ds_read_b64_tr_b16 v[166:167], v26 offset:6912
    s_add_u32 s40, s30, s36
    s_add_u32 m0, s40, 0
    s_add_u32 s41, s32, 0
    buffer_load_dwordx4 v5, s[8:11], s41 offen lds
    s_add_u32 m0, s40, 8192
    s_add_u32 s41, s32, 81920
    buffer_load_dwordx4 v5, s[8:11], s41 offen lds
    s_add_u32 s40, s30, s48
    s_add_u32 m0, s40, 98304
    s_mul_i32 s40, s48, s42
    buffer_load_dwordx4 v6, s[12:15], s33 offen lds
    s_add_u32 m0, s40, s29
    s_nop 0
    buffer_load_dwordx4 v7, s[44:47], s33 offen lds
    s_add_u32 s33, s33, 98304
    s_add_u32 s48, s48, 12288
    s_cmp_eq_u32 s48, 49152
    s_cselect_b32 s48, 0, s48
    s_add_u32 s49, s49, 12288
    s_cmp_eq_u32 s49, 49152
    s_cselect_b32 s49, 0, s49
    v_add_u32 v22, s37, v12
    v_add_u32 v23, s37, v13
    v_add_u32 v24, s49, v14
    v_add_u32 v25, s49, v15
    v_add_u32 v26, s49, v16
    s_cmp_eq_u32 s77, 0
    s_cbranch_scc1 G1F_hz
    s_branch G1F_ent
G1F_loop:
    v_mfma_f32_16x16x32_bf16 v[120:123], v[204:207], v[176:179], v[120:123]
    v_mfma_f32_16x16x32_bf16 v[124:127], v[204:207], v[180:183], v[124:127]
G1F_ent:
    s_waitcnt vmcnt(8) lgkmcnt(0)
    s_barrier
    v_mfma_f32_16x16x32_bf16 v[32:35], v[144:147], v[128:131], v[32:35]
    ds_read_b128 v[168:171], v22 offset:0
    s_add_u32 s40, s30, s36
    s_add_u32 m0, s40, 16384
    s_add_u32 s41, s32, 163840
    buffer_load_dwordx4 v5, s[8:11], s41 offen lds
    v_mfma_f32_16x16x32_bf16 v[36:39], v[144:147], v[132:135], v[36:39]
    ds_read_b128 v[172:175], v22 offset:2048
    v_mfma_f32_16x16x32_bf16 v[40:43], v[144:147], v[136:139], v[40:43]
    ds_read_b128 v[176:179], v23 offset:0
    v_mfma_f32_16x16x32_bf16 v[44:47], v[144:147], v[140:143], v[44:47]
    ds_read_b128 v[180:183], v23 offset:2048
    v_mfma_f32_16x16x32_bf16 v[48:51], v[148:151], v[128:131], v[48:51]
    ds_read_b64_tr_b16 v[184:185], v24 offset:0
    s_add_u32 m0, s40, 24576
    v_mfma_f32_16x16x32_bf16 v[52:55], v[148:151], v[132:135], v[52:55]
    ds_read_b64_tr_b16 v[186:187], v24 offset:768
    s_add_u32 s41, s32, 245760
    v_mfma_f32_16x16x32_bf16 v[56:59], v[148:151], v[136:139], v[56:59]
    ds_read_b64_tr_b16 v[188:189], v25 offset:0
    buffer_load_dwordx4 v5, s[8:11], s41 offen lds
    v_mfma_f32_16x16x32_bf16 v[60:63], v[148:151], v[140:143], v[60:63]
    ds_read_b64_tr_b16 v[190:191], v25 offset:768
    v_mfma_f32_16x16x32_bf16 v[64:67], v[152:155], v[128:131], v[64:67]
    ds_read_b64_tr_b16 v[192:193], v26 offset:0
    s_add_u32 s32, s32, 128
    s_add_u32 s36, s36, 32768
    v_mfma_f32_16x16x32_bf16 v[68:71], v[152:155], v[132:135], v[68:71]
    ds_read_b64_tr_b16 v[194:195], v26 offset:768
    s_cmp_eq_u32 s36, 98304
    s_cselect_b32 s36, 0, s36
    s_add_u32 s40, s30, s48
    v_mfma_f32_16x16x32_bf16 v[72:75], v[152:155], v[136:139], v[72:75]
    ds_read_b64_tr_b16 v[196:197], v24 offset:6144
    s_add_u32 m0, s40, 98304
    s_mul_i32 s40, s48, s42
    v_mfma_f32_16x16x32_bf16 v[76:79], v[152:155], v[140:143], v[76:79]
    ds_read_b64_tr_b16 v[198:199], v24 offset:6912
    buffer_load_dwordx4 v6, s[12:15], s33 offen lds
    v_mfma_f32_16x16x32_bf16 v[80:83], v[156:159], v[128:131], v[80:83]
    ds_read_b64_tr_b16 v[200:201], v25 offset:6144
    v_mfma_f32_16x16x32_bf16 v[84:87], v[156:159], v[132:135], v[84:87]
    ds_read_b64_tr_b16 v[202:203], v25 offset:6912
    v_mfma_f32_16x16x32_bf16 v[88:91], v[156:159], v[136:139], v[88:91]
    ds_read_b64_tr_b16 v[204:205], v26 offset:6144
    v_mfma_f32_16x16x32_bf16 v[92:95], v[156:159], v[140:143], v[92:95]
    ds_read_b64_tr_b16 v[206:207], v26 offset:6912
    v_mfma_f32_16x16x32_bf16 v[96:99], v[160:163], v[128:131], v[96:99]
    s_add_u32 s37, s37, 32768
    s_cmp_eq_u32 s37, 98304
    s_cselect_b32 s37, 0, s37
    v_mfma_f32_16x16x32_bf16 v[100:103], v[160:163], v[132:135], v[100:103]
    s_add_u32 s49, s49, 12288
    s_cmp_eq_u32 s49, 49152
    s_cselect_b32 s49, 0, s49
    s_add_u32 m0, s40, s29
    s_nop 0
    buffer_load_dwordx4 v7, s[44:47], s33 offen lds
    v_mfma_f32_16x16x32_bf16 v[104:107], v[160:163], v[136:139], v[104:107]
    v_add_u32 v22, s37, v10
    v_add_u32 v23, s37, v11
    s_add_u32 s33, s33, 98304
    v_mfma_f32_16x16x32_bf16 v[108:111], v[160:163], v[140:143], v[108:111]
    v_add_u32 v24, s49, v14
    v_add_u32 v25, s49, v15
    s_add_u32 s48, s48, 12288
    v_mfma_f32_16x16x32_bf16 v[112:115], v[164:167], v[128:131], v[112:115]
    v_add_u32 v26, s49, v16
    s_cmp_eq_u32 s48, 49152
    s_cselect_b32 s48, 0, s48
    v_mfma_f32_16x16x32_bf16 v[116:119], v[164:167], v[132:135], v[116:119]
    v_mfma_f32_16x16x32_bf16 v[120:123], v[164:167], v[136:139], v[120:123]
    v_mfma_f32_16x16x32_bf16 v[124:127], v[164:167], v[140:143], v[124:127]
    s_waitcnt vmcnt(8) lgkmcnt(0)
    s_barrier
    v_mfma_f32_16x16x32_bf16 v[32:35], v[184:187], v[168:171], v[32:35]
    ds_read_b128 v[128:131], v22 offset:0
    s_add_u32 s40, s30, s36
    s_add_u32 m0, s40, 0
    s_add_u32 s41, s32, 0
    buffer_load_dwordx4 v5, s[8:11], s41 offen lds
    v_mfma_f32_16x16x32_bf16 v[36:39], v[184:187], v[172:175], v[36:39]
    ds_read_b128 v[132:135], v22 offset:2048
    v_mfma_f32_16x16x32_bf16 v[40:43], v[184:187], v[176:179], v[40:43]
    ds_read_b128 v[136:139], v23 offset:0
    v_mfma_f32_16x16x32_bf16 v[44:47], v[184:187], v[180:183], v[44:47]
    ds_read_b128 v[140:143], v23 offset:2048
    v_mfma_f32_16x16x32_bf16 v[48:51], v[188:191], v[168:171], v[48:51]
    ds_read_b64_tr_b16 v[144:145], v24 offset:0
    s_add_u32 m0, s40, 8192
    v_mfma_f32_16x16x32_bf16 v[52:55], v[188:191], v[172:175], v[52:55]
    ds_read_b64_tr_b16 v[146:147], v24 offset:768
    s_add_u32 s41, s32, 81920
    v_mfma_f32_16x16x32_bf16 v[56:59], v[188:191], v[176:179], v[56:59]
    ds_read_b64_tr_b16 v[148:149], v25 offset:0
    buffer_load_dwordx4 v5, s[8:11], s41 offen lds
    v_mfma_f32_16x16x32_bf16 v[60:63], v[188:191], v[180:183], v[60:63]
    ds_read_b64_tr_b16 v[150:151], v25 offset:768
    v_mfma_f32_16x16x32_bf16 v[64:67], v[192:195], v[168:171], v[64:67]
    ds_read_b64_tr_b16 v[152:153], v26 offset:0
    s_add_u32 s40, s30, s48
    v_mfma_f32_16x16x32_bf16 v[68:71], v[192:195], v[172:175], v[68:71]
    ds_read_b64_tr_b16 v[154:155], v26 offset:768
    s_add_u32 m0, s40, 98304
    v_mfma_f32_16x16x32_bf16 v[72:75], v[192:195], v[176:179], v[72:75]
    ds_read_b64_tr_b16 v[156:157], v24 offset:6144
    s_mul_i32 s40, s48, s42
    v_mfma_f32_16x16x32_bf16 v[76:79], v[192:195], v[180:183], v[76:79]
    ds_read_b64_tr_b16 v[158:159], v24 offset:6912
    buffer_load_dwordx4 v6, s[12:15], s33 offen lds
    v_mfma_f32_16x16x32_bf16 v[80:83], v[196:199], v[168:171], v[80:83]
    ds_read_b64_tr_b16 v[160:161], v25 offset:6144
    v_mfma_f32_16x16x32_bf16 v[84:87], v[196:199], v[172:175], v[84:87]
    ds_read_b64_tr_b16 v[162:163], v25 offset:6912
    v_mfma_f32_16x16x32_bf16 v[88:91], v[196:199], v[176:179], v[88:91]
    ds_read_b64_tr_b16 v[164:165], v26 offset:6144
    v_mfma_f32_16x16x32_bf16 v[92:95], v[196:199], v[180:183], v[92:95]
    ds_read_b64_tr_b16 v[166:167], v26 offset:6912
    v_mfma_f32_16x16x32_bf16 v[96:99], v[200:203], v[168:171], v[96:99]
    s_add_u32 s49, s49, 12288
    s_cmp_eq_u32 s49, 49152
    s_cselect_b32 s49, 0, s49
    v_mfma_f32_16x16x32_bf16 v[100:103], v[200:203], v[172:175], v[100:103]
    v_add_u32 v22, s37, v12
    v_add_u32 v23, s37, v13
    s_add_u32 m0, s40, s29
    s_nop 0
    buffer_load_dwordx4 v7, s[44:47], s33 offen lds
    v_mfma_f32_16x16x32_bf16 v[104:107], v[200:203], v[176:179], v[104:107]
    v_add_u32 v24, s49, v14
    v_add_u32 v25, s49, v15
    s_add_u32 s33, s33, 98304
    v_mfma_f32_16x16x32_bf16 v[108:111], v[200:203], v[180:183], v[108:111]
    v_add_u32 v26, s49, v16
    s_add_u32 s48, s48, 12288
    v_mfma_f32_16x16x32_bf16 v[112:115], v[204:207], v[168:171], v[112:115]
    s_cmp_eq_u32 s48, 49152
    s_cselect_b32 s48, 0, s48
    v_mfma_f32_16x16x32_bf16 v[116:119], v[204:207], v[172:175], v[116:119]
    s_add_u32 s35, s35, 2
    s_bitcmp1_b32 s78, s35
    s_cbranch_scc0 G1F_loop
    s_cmp_eq_u32 s35, s77
    s_cbranch_scc0 G1F_h0
    v_mfma_f32_16x16x32_bf16 v[208:211], v[28:31], v[184:187], v[208:211]
    v_mfma_f32_16x16x32_bf16 v[212:215], v[28:31], v[196:199], v[212:215]
G1F_hz:
    s_waitcnt lgkmcnt(0)
    s_nop 3
    v_mfma_f32_16x16x32_bf16 v[208:211], v[28:31], v[144:147], v[208:211]
    v_mfma_f32_16x16x32_bf16 v[212:215], v[28:31], v[156:159], v[212:215]
    s_and_b32 s40, s77, 6
    s_lshl_b32 s40, s40, 7
    s_and_b32 s41, s77, 8
    s_add_u32 s40, s40, s41
    s_add_u32 s40, s40, s63
    s_mov_b64 exec, 0xffff
    s_nop 6
    v_mov_b32 v209, s76
    v_cvt_pk_bf16_f32 v208, v208, v212
    buffer_store_dwordx2 v[208:209], v4, s[64:67], s40 offen sc1
    s_mov_b64 exec, -1
    s_cmp_eq_u32 s35, 0
    s_cbranch_scc1 G1F_ent
G1F_h0:
    s_cmp_eq_u32 s35, 4
    s_cbranch_scc0 G1F_h2
    v_mov_b32 v239, s76
    v_mov_b32 v233, 0
    s_mov_b64 exec, 1
    buffer_store_dwordx2 v[238:239], v233, s[64:67], s68 offen sc1
    s_mov_b64 exec, -1
    s_branch G1F_loop
G1F_h2:
    s_cmp_eq_u32 s35, 14
    s_cbranch_scc1 G1F_end
    s_cmp_eq_u32 s35, 12
    s_cbranch_scc0 G1F_loop
    buffer_load_dwordx2 v[238:239], v237, s[64:67], 0 offen sc1
    buffer_load_dword v230, v231, s[64:67], 0 offen sc1
    s_branch G1F_loop
G1F_sp:
    s_sleep 2
    buffer_load_dwordx2 v[238:239], v237, s[64:67], 0 offen sc1
    buffer_load_dword v230, v231, s[64:67], 0 offen sc1
    s_waitcnt vmcnt(0)
    s_add_u32 s35, s35, 1
    s_cmp_lt_u32 s35, 0x40000
    s_cbranch_scc1 G1F_vf
    s_branch G1F_so
G1F_cs:
    s_sleep 2
    buffer_load_dwordx4 v[252:255], v4, s[64:67], s63 offen sc1
    s_waitcnt vmcnt(0)
    s_add_u32 s35, s35, 1
    s_cmp_lt_u32 s35, 0x40000
    s_cbranch_scc1 G1F_cv
    s_branch G1F_co
G1F_end:
    v_mfma_f32_16x16x32_bf16 v[120:123], v[204:207], v[176:179], v[120:123]
    v_mfma_f32_16x16x32_bf16 v[124:127], v[204:207], v[180:183], v[124:127]
    s_waitcnt vmcnt(8) lgkmcnt(0)
G1F_vf:
    v_cmp_ne_u32 vcc, s76, v239
    v_cmp_ne_u32 s[40:41], s76, v230
    s_or_b64 vcc, vcc, s[40:41]
    s_cbranch_scc1 G1F_sp
G1F_so:
    s_barrier
    v_mfma_f32_16x16x32_bf16 v[32:35], v[144:147], v[128:131], v[32:35]
    ds_read_b128 v[168:171], v22 offset:0
    s_add_u32 s40, s30, s36
    s_add_u32 m0, s40, 16384
    s_add_u32 s41, s32, 163840
    buffer_load_dwordx4 v5, s[8:11], s41 offen lds
    v_mfma_f32_16x16x32_bf16 v[36:39], v[144:147], v[132:135], v[36:39]
    ds_read_b128 v[172:175], v22 offset:2048
    v_mfma_f32_16x16x32_bf16 v[40:43], v[144:147], v[136:139], v[40:43]
    ds_read_b128 v[176:179], v23 offset:0
    s_add_u32 m0, s40, 24576
    v_mfma_f32_16x16x32_bf16 v[44:47], v[144:147], v[140:143], v[44:47]
    ds_read_b128 v[180:183], v23 offset:2048
    s_add_u32 s41, s32, 245760
    v_mfma_f32_16x16x32_bf16 v[48:51], v[148:151], v[128:131], v[48:51]
    ds_read_b64_tr_b16 v[184:185], v24 offset:0
    buffer_load_dwordx4 v5, s[8:11], s41 offen lds
    v_mfma_f32_16x16x32_bf16 v[52:55], v[148:151], v[132:135], v[52:55]
    ds_read_b64_tr_b16 v[186:187], v24 offset:768
    s_add_u32 s40, s30, s48
    v_mfma_f32_16x16x32_bf16 v[56:59], v[148:151], v[136:139], v[56:59]
    ds_read_b64_tr_b16 v[188:189], v25 offset:0
    s_add_u32 m0, s40, 98304
    s_mul_i32 s40, s48, s42
    v_mfma_f32_16x16x32_bf16 v[60:63], v[148:151], v[140:143], v[60:63]
    ds_read_b64_tr_b16 v[190:191], v25 offset:768
    buffer_load_dwordx4 v6, s[12:15], s33 offen lds
    v_mfma_f32_16x16x32_bf16 v[64:67], v[152:155], v[128:131], v[64:67]
    ds_read_b64_tr_b16 v[192:193], v26 offset:0
    v_mfma_f32_16x16x32_bf16 v[68:71], v[152:155], v[132:135], v[68:71]
    ds_read_b64_tr_b16 v[194:195], v26 offset:768
    v_mfma_f32_16x16x32_bf16 v[72:75], v[152:155], v[136:139], v[72:75]
    ds_read_b64_tr_b16 v[196:197], v24 offset:6144
    v_mfma_f32_16x16x32_bf16 v[76:79], v[152:155], v[140:143], v[76:79]
    ds_read_b64_tr_b16 v[198:199], v24 offset:6912
    s_add_u32 m0, s40, s29
    s_nop 0
    buffer_load_dwordx4 v7, s[44:47], s33 offen lds
    v_mfma_f32_16x16x32_bf16 v[80:83], v[156:159], v[128:131], v[80:83]
    ds_read_b64_tr_b16 v[200:201], v25 offset:6144
    v_mfma_f32_16x16x32_bf16 v[84:87], v[156:159], v[132:135], v[84:87]
    ds_read_b64_tr_b16 v[202:203], v25 offset:6912
    s_add_u32 s33, s33, 98304
    s_add_u32 s48, s48, 12288
    v_mfma_f32_16x16x32_bf16 v[88:91], v[156:159], v[136:139], v[88:91]
    ds_read_b64_tr_b16 v[204:205], v26 offset:6144
    s_cmp_eq_u32 s48, 49152
    s_cselect_b32 s48, 0, s48
    v_mov_b32 v8, v238
    v_mfma_f32_16x16x32_bf16 v[92:95], v[156:159], v[140:143], v[92:95]
    ds_read_b64_tr_b16 v[206:207], v26 offset:6912
    s_add_u32 m0, s30, 147456
    s_add_u32 s40, s73, 3072
    buffer_load_dwordx4 v4, s[52:55], s40 offen lds
    v_mfma_f32_16x16x32_bf16 v[96:99], v[160:163], v[128:131], v[96:99]
    s_add_u32 s37, s37, 32768
    s_cmp_eq_u32 s37, 98304
    s_cselect_b32 s37, 0, s37
    v_mfma_f32_16x16x32_bf16 v[100:103], v[160:163], v[132:135], v[100:103]
    s_add_u32 s49, s49, 12288
    s_cmp_eq_u32 s49, 49152
    s_cselect_b32 s49, 0, s49
    v_mfma_f32_16x16x32_bf16 v[104:107], v[160:163], v[136:139], v[104:107]
    v_add_u32 v22, s37, v10
    v_add_u32 v23, s37, v11
    buffer_load_dwordx4 v[216:219], v4, s[52:55], s71 offen offset:1024
    v_mfma_f32_16x16x32_bf16 v[108:111], v[160:163], v[140:143], v[108:111]
    v_add_u32 v24, s49, v14
    v_add_u32 v25, s49, v15
    v_mfma_f32_16x16x32_bf16 v[112:115], v[164:167], v[128:131], v[112:115]
    v_add_u32 v26, s49, v16
    v_mfma_f32_16x16x32_bf16 v[116:119], v[164:167], v[132:135], v[116:119]
    v_mfma_f32_16x16x32_bf16 v[120:123], v[164:167], v[136:139], v[120:123]
    v_mfma_f32_16x16x32_bf16 v[124:127], v[164:167], v[140:143], v[124:127]
    s_waitcnt vmcnt(10) lgkmcnt(0)
    s_barrier
    v_mfma_f32_16x16x32_bf16 v[32:35], v[184:187], v[168:171], v[32:35]
    ds_read_b128 v[128:131], v22 offset:0
    s_add_u32 s40, s30, s48
    s_add_u32 m0, s40, 98304
    s_mul_i32 s40, s48, s42
    v_mfma_f32_16x16x32_bf16 v[36:39], v[184:187], v[172:175], v[36:39]
    ds_read_b128 v[132:135], v22 offset:2048
    buffer_load_dwordx4 v6, s[12:15], s33 offen lds
    v_mfma_f32_16x16x32_bf16 v[40:43], v[184:187], v[176:179], v[40:43]
    ds_read_b128 v[136:139], v23 offset:0
    v_mfma_f32_16x16x32_bf16 v[44:47], v[184:187], v[180:183], v[44:47]
    ds_read_b128 v[140:143], v23 offset:2048
    v_mfma_f32_16x16x32_bf16 v[48:51], v[188:191], v[168:171], v[48:51]
    ds_read_b64_tr_b16 v[144:145], v24 offset:0
    v_mfma_f32_16x16x32_bf16 v[52:55], v[188:191], v[172:175], v[52:55]
    ds_read_b64_tr_b16 v[146:147], v24 offset:768
    v_mfma_f32_16x16x32_bf16 v[56:59], v[188:191], v[176:179], v[56:59]
    ds_read_b64_tr_b16 v[148:149], v25 offset:0
    v_mfma_f32_16x16x32_bf16 v[60:63], v[188:191], v[180:183], v[60:63]
    ds_read_b64_tr_b16 v[150:151], v25 offset:768
    v_mfma_f32_16x16x32_bf16 v[208:211], v[184:187], v[28:31], 0
    ds_read_b64_tr_b16 v[152:153], v26 offset:0
    v_mfma_f32_16x16x32_bf16 v[64:67], v[192:195], v[168:171], v[64:67]
    ds_read_b64_tr_b16 v[154:155], v26 offset:768
    v_mfma_f32_16x16x32_bf16 v[68:71], v[192:195], v[172:175], v[68:71]
    ds_read_b64_tr_b16 v[156:157], v24 offset:6144
    v_mfma_f32_16x16x32_bf16 v[72:75], v[192:195], v[176:179], v[72:75]
    ds_read_b64_tr_b16 v[158:159], v24 offset:6912
    v_mfma_f32_16x16x32_bf16 v[76:79], v[192:195], v[180:183], v[76:79]
    ds_read_b64_tr_b16 v[160:161], v25 offset:6144
    v_mfma_f32_16x16x32_bf16 v[80:83], v[196:199], v[168:171], v[80:83]
    ds_read_b64_tr_b16 v[162:163], v25 offset:6912
    s_add_u32 m0, s40, s29
    s_nop 0
    buffer_load_dwordx4 v7, s[44:47], s33 offen lds
    v_mfma_f32_16x16x32_bf16 v[84:87], v[196:199], v[172:175], v[84:87]
    ds_read_b64_tr_b16 v[164:165], v26 offset:6144
    v_mfma_f32_16x16x32_bf16 v[88:91], v[196:199], v[176:179], v[88:91]
    ds_read_b64_tr_b16 v[166:167], v26 offset:6912
    v_mfma_f32_16x16x32_bf16 v[212:215], v[196:199], v[28:31], 0
    s_add_u32 s49, s49, 12288
    v_mfma_f32_16x16x32_bf16 v[92:95], v[196:199], v[180:183], v[92:95]
    s_cmp_eq_u32 s49, 49152
    s_cselect_b32 s49, 0, s49
    v_mfma_f32_16x16x32_bf16 v[96:99], v[200:203], v[168:171], v[96:99]
    v_add_u32 v22, s37, v12
    v_mfma_f32_16x16x32_bf16 v[100:103], v[200:203], v[172:175], v[100:103]
    v_add_u32 v23, s37, v13
    v_mfma_f32_16x16x32_bf16 v[104:107], v[200:203], v[176:179], v[104:107]
    v_add_u32 v24, s49, v14
    v_mfma_f32_16x16x32_bf16 v[108:111], v[200:203], v[180:183], v[108:111]
    v_add_u32 v25, s49, v15
    v_mfma_f32_16x16x32_bf16 v[112:115], v[204:207], v[168:171], v[112:115]
    v_add_u32 v26, s49, v16
    v_mfma_f32_16x16x32_bf16 v[116:119], v[204:207], v[172:175], v[116:119]
    v_mfma_f32_16x16x32_bf16 v[120:123], v[204:207], v[176:179], v[120:123]
    v_mfma_f32_16x16x32_bf16 v[124:127], v[204:207], v[180:183], v[124:127]
    s_waitcnt vmcnt(8) lgkmcnt(0)
    s_barrier
    v_mfma_f32_16x16x32_bf16 v[32:35], v[144:147], v[128:131], v[32:35]
    ds_read_b128 v[168:171], v22 offset:0
    buffer_load_dwordx4 v[252:255], v4, s[64:67], s63 offen sc1
    v_mfma_f32_16x16x32_bf16 v[36:39], v[144:147], v[132:135], v[36:39]
    ds_read_b128 v[172:175], v22 offset:2048
    v_mfma_f32_16x16x32_bf16 v[40:43], v[144:147], v[136:139], v[40:43]
    ds_read_b128 v[176:179], v23 offset:0
    v_mfma_f32_16x16x32_bf16 v[44:47], v[144:147], v[140:143], v[44:47]
    ds_read_b128 v[180:183], v23 offset:2048
    v_mfma_f32_16x16x32_bf16 v[48:51], v[148:151], v[128:131], v[48:51]
    ds_read_b64_tr_b16 v[184:185], v24 offset:0
    s_add_u32 m0, s30, 98304
    s_add_u32 s40, s74, 2048
    buffer_load_dwordx4 v4, s[52:55], s40 offen lds
    v_mfma_f32_16x16x32_bf16 v[52:55], v[148:151], v[132:135], v[52:55]
    ds_read_b64_tr_b16 v[186:187], v24 offset:768
    v_mfma_f32_16x16x32_bf16 v[56:59], v[148:151], v[136:139], v[56:59]
    ds_read_b64_tr_b16 v[188:189], v25 offset:0
    v_mfma_f32_16x16x32_bf16 v[60:63], v[148:151], v[140:143], v[60:63]
    ds_read_b64_tr_b16 v[190:191], v25 offset:768
    v_mfma_f32_16x16x32_bf16 v[208:211], v[144:147], v[28:31], v[208:211]
    ds_read_b64_tr_b16 v[192:193], v26 offset:0
    buffer_load_dwordx4 v[220:223], v4, s[52:55], s71 offen offset:2048
    v_mfma_f32_16x16x32_bf16 v[64:67], v[152:155], v[128:131], v[64:67]
    ds_read_b64_tr_b16 v[194:195], v26 offset:768
    v_mfma_f32_16x16x32_bf16 v[68:71], v[152:155], v[132:135], v[68:71]
    ds_read_b64_tr_b16 v[196:197], v24 offset:6144
    v_mfma_f32_16x16x32_bf16 v[72:75], v[152:155], v[136:139], v[72:75]
    ds_read_b64_tr_b16 v[198:199], v24 offset:6912
    v_mfma_f32_16x16x32_bf16 v[76:79], v[152:155], v[140:143], v[76:79]
    ds_read_b64_tr_b16 v[200:201], v25 offset:6144
    buffer_load_dwordx4 v[224:227], v4, s[52:55], s71 offen offset:3072
    v_mfma_f32_16x16x32_bf16 v[80:83], v[156:159], v[128:131], v[80:83]
    ds_read_b64_tr_b16 v[202:203], v25 offset:6912
    v_mfma_f32_16x16x32_bf16 v[84:87], v[156:159], v[132:135], v[84:87]
    ds_read_b64_tr_b16 v[204:205], v26 offset:6144
    v_mfma_f32_16x16x32_bf16 v[88:91], v[156:159], v[136:139], v[88:91]
    ds_read_b64_tr_b16 v[206:207], v26 offset:6912
    v_mfma_f32_16x16x32_bf16 v[212:215], v[156:159], v[28:31], v[212:215]
    s_add_u32 s37, s37, 32768
    s_cmp_eq_u32 s37, 98304
    s_cselect_b32 s37, 0, s37
    s_add_u32 s40, s71, 4096
    buffer_load_dwordx4 v[228:231], v4, s[52:55], s40 offen
    v_mfma_f32_16x16x32_bf16 v[92:95], v[156:159], v[140:143], v[92:95]
    s_add_u32 s49, s49, 12288
    s_cmp_eq_u32 s49, 49152
    s_cselect_b32 s49, 0, s49
    v_mfma_f32_16x16x32_bf16 v[96:99], v[160:163], v[128:131], v[96:99]
    v_add_u32 v22, s37, v10
    v_add_u32 v23, s37, v11
    v_mfma_f32_16x16x32_bf16 v[100:103], v[160:163], v[132:135], v[100:103]
    v_add_u32 v24, s49, v14
    v_add_u32 v25, s49, v15
    v_mfma_f32_16x16x32_bf16 v[104:107], v[160:163], v[136:139], v[104:107]
    v_add_u32 v26, s49, v16
    buffer_load_dwordx4 v[232:235], v4, s[52:55], s72 offen offset:0
    v_mfma_f32_16x16x32_bf16 v[108:111], v[160:163], v[140:143], v[108:111]
    s_add_u32 s8, s18, 0xd00000
    s_addc_u32 s9, s19, 0
    s_and_b32 s9, s9, 0xffff
    v_mfma_f32_16x16x32_bf16 v[112:115], v[164:167], v[128:131], v[112:115]
    s_mov_b32 s10, 0x880000
    v_mfma_f32_16x16x32_bf16 v[116:119], v[164:167], v[132:135], v[116:119]
    s_mov_b32 s11, 0x00020000
    v_mfma_f32_16x16x32_bf16 v[120:123], v[164:167], v[136:139], v[120:123]
    v_mfma_f32_16x16x32_bf16 v[124:127], v[164:167], v[140:143], v[124:127]
    s_waitcnt vmcnt(10) lgkmcnt(0)
    s_barrier
    v_mfma_f32_16x16x32_bf16 v[32:35], v[184:187], v[168:171], v[32:35]
    ds_read_b128 v[128:131], v22 offset:0
    s_add_u32 m0, s30, 81920
    s_add_u32 s40, s74, 0
    buffer_load_dwordx4 v4, s[52:55], s40 offen lds
    v_mfma_f32_16x16x32_bf16 v[36:39], v[184:187], v[172:175], v[36:39]
    ds_read_b128 v[132:135], v22 offset:2048
    v_mfma_f32_16x16x32_bf16 v[40:43], v[184:187], v[176:179], v[40:43]
    ds_read_b128 v[136:139], v23 offset:0
    v_mfma_f32_16x16x32_bf16 v[44:47], v[184:187], v[180:183], v[44:47]
    ds_read_b128 v[140:143], v23 offset:2048
    v_mfma_f32_16x16x32_bf16 v[48:51], v[188:191], v[168:171], v[48:51]
    ds_read_b64_tr_b16 v[144:145], v24 offset:0
    v_mfma_f32_16x16x32_bf16 v[52:55], v[188:191], v[172:175], v[52:55]
    ds_read_b64_tr_b16 v[146:147], v24 offset:768
    v_mfma_f32_16x16x32_bf16 v[56:59], v[188:191], v[176:179], v[56:59]
    ds_read_b64_tr_b16 v[148:149], v25 offset:0
    s_add_u32 m0, s30, 90112
    s_add_u32 s40, s74, 1024
    buffer_load_dwordx4 v4, s[52:55], s40 offen lds
    v_mfma_f32_16x16x32_bf16 v[60:63], v[188:191], v[180:183], v[60:63]
    ds_read_b64_tr_b16 v[150:151], v25 offset:768
    v_mfma_f32_16x16x32_bf16 v[208:211], v[184:187], v[28:31], v[208:211]
    ds_read_b64_tr_b16 v[152:153], v26 offset:0
    v_mfma_f32_16x16x32_bf16 v[64:67], v[192:195], v[168:171], v[64:67]
    ds_read_b64_tr_b16 v[154:155], v26 offset:768
    v_mfma_f32_16x16x32_bf16 v[68:71], v[192:195], v[172:175], v[68:71]
    ds_read_b64_tr_b16 v[156:157], v24 offset:6144
    v_mfma_f32_16x16x32_bf16 v[72:75], v[192:195], v[176:179], v[72:75]
    ds_read_b64_tr_b16 v[158:159], v24 offset:6912
    v_mfma_f32_16x16x32_bf16 v[76:79], v[192:195], v[180:183], v[76:79]
    ds_read_b64_tr_b16 v[160:161], v25 offset:6144
    s_add_u32 m0, s30, 106496
    s_add_u32 s40, s74, 3072
    buffer_load_dwordx4 v4, s[52:55], s40 offen lds
    v_mfma_f32_16x16x32_bf16 v[80:83], v[196:199], v[168:171], v[80:83]
    ds_read_b64_tr_b16 v[162:163], v25 offset:6912
    v_mfma_f32_16x16x32_bf16 v[84:87], v[196:199], v[172:175], v[84:87]
    ds_read_b64_tr_b16 v[164:165], v26 offset:6144
    v_mfma_f32_16x16x32_bf16 v[88:91], v[196:199], v[176:179], v[88:91]
    ds_read_b64_tr_b16 v[166:167], v26 offset:6912
    v_mfma_f32_16x16x32_bf16 v[212:215], v[196:199], v[28:31], v[212:215]
    s_add_u32 s49, s49, 12288
    v_mfma_f32_16x16x32_bf16 v[92:95], v[196:199], v[180:183], v[92:95]
    s_cmp_eq_u32 s49, 49152
    s_cselect_b32 s49, 0, s49
    v_mfma_f32_16x16x32_bf16 v[96:99], v[200:203], v[168:171], v[96:99]
    v_add_u32 v22, s37, v12
    s_add_u32 m0, s30, 114688
    s_add_u32 s40, s74, 4096
    buffer_load_dwordx4 v4, s[52:55], s40 offen lds
    v_mfma_f32_16x16x32_bf16 v[100:103], v[200:203], v[172:175], v[100:103]
    v_add_u32 v23, s37, v13
    v_mfma_f32_16x16x32_bf16 v[104:107], v[200:203], v[176:179], v[104:107]
    v_add_u32 v24, s49, v14
    v_mfma_f32_16x16x32_bf16 v[108:111], v[200:203], v[180:183], v[108:111]
    v_add_u32 v25, s49, v15
    v_mfma_f32_16x16x32_bf16 v[112:115], v[204:207], v[168:171], v[112:115]
    v_add_u32 v26, s49, v16
    v_mfma_f32_16x16x32_bf16 v[116:119], v[204:207], v[172:175], v[116:119]
    v_mfma_f32_16x16x32_bf16 v[120:123], v[204:207], v[176:179], v[120:123]
    v_mfma_f32_16x16x32_bf16 v[124:127], v[204:207], v[180:183], v[124:127]
    s_waitcnt vmcnt(9) lgkmcnt(0)
    s_barrier
    v_mfma_f32_16x16x32_bf16 v[208:211], v[144:147], v[28:31], v[208:211]
    ds_read_b64_tr_b16 v[184:185], v24 offset:0
    s_add_u32 m0, s30, 122880
    s_add_u32 s40, s73, 0
    buffer_load_dwordx4 v4, s[52:55], s40 offen lds
    v_mfma_f32_16x16x32_bf16 v[212:215], v[156:159], v[28:31], v[212:215]
    ds_read_b64_tr_b16 v[186:187], v24 offset:768
    v_mfma_f32_16x16x32_bf16 v[32:35], v[144:147], v[128:131], v[32:35]
G1F_cv:
    v_cmp_ne_u32 vcc, s76, v253
    v_cmp_ne_u32 s[40:41], s76, v255
    s_or_b64 vcc, vcc, s[40:41]
    s_cbranch_scc1 G1F_cs
G1F_co:
    v_and_b32 v255, s50, v252
    v_lshlrev_b32 v253, 16, v254
    ds_read_b64_tr_b16 v[196:197], v24 offset:6144
    v_lshrrev_b32 v10, 4, v2
    v_mfma_f32_16x16x32_bf16 v[36:39], v[144:147], v[132:135], v[36:39]
    v_lshlrev_b32 v252, 16, v252
    v_and_b32 v254, s50, v254
    ds_read_b64_tr_b16 v[198:199], v24 offset:6912
    v_lshlrev_b32 v10, 4, v10
    v_add_u32 v10, 155648, v10
    v_mfma_f32_16x16x32_bf16 v[40:43], v[144:147], v[136:139], v[40:43]
    ds_read_b128 v[168:171], v22 offset:0
    v_and_b32 v11, 3, v2
    v_and_b32 v12, 4, v1
    v_mfma_f32_16x16x32_bf16 v[44:47], v[144:147], v[140:143], v[44:47]
    v_mfma_f32_16x16x16_bf16 v[208:211], v[252:253], v[28:29], v[208:211]
    ds_read_b128 v[172:175], v22 offset:2048
    buffer_load_dwordx4 v[236:239], v4, s[52:55], s72 offen offset:1024
    v_mfma_f32_16x16x32_bf16 v[48:51], v[148:151], v[128:131], v[48:51]
    v_mfma_f32_16x16x16_bf16 v[212:215], v[254:255], v[28:29], v[212:215]
    ds_read_b128 v[176:179], v23 offset:0
    v_mfma_f32_16x16x32_bf16 v[52:55], v[148:151], v[132:135], v[52:55]
    ds_read_b128 v[180:183], v23 offset:2048
    v_mfma_f32_16x16x32_bf16 v[56:59], v[148:151], v[136:139], v[56:59]
    ds_read_b64_tr_b16 v[188:189], v25 offset:0
    v_add_u32 v11, v11, v12
    v_lshl_add_u32 v17, v11, 10, v10
    v_mfma_f32_16x16x32_bf16 v[60:63], v[148:151], v[140:143], v[60:63]
    ds_read_b64_tr_b16 v[190:191], v25 offset:768
    v_lshl_add_u32 v17, s56, 1, v17
    v_add_u32 v10, s30, v10
    s_waitcnt lgkmcnt(6)
    v_mfma_f32_16x16x32_bf16 v[208:211], v[184:187], v[28:31], v[208:211]
    ds_read_b64_tr_b16 v[192:193], v26 offset:0
    v_lshl_add_u32 v18, s57, 1, v10
    v_lshl_add_u32 v19, s58, 1, v10
    v_mfma_f32_16x16x32_bf16 v[212:215], v[196:199], v[28:31], v[212:215]
    ds_read_b64_tr_b16 v[194:195], v26 offset:768
    buffer_load_dwordx4 v[240:243], v4, s[52:55], s72 offen offset:2048
    v_mfma_f32_16x16x32_bf16 v[64:67], v[152:155], v[128:131], v[64:67]
    ds_read_b64_tr_b16 v[200:201], v25 offset:6144
    v_and_b32 v10, 15, v2
    v_mfma_f32_16x16x32_bf16 v[68:71], v[152:155], v[132:135], v[68:71]
    ds_read_b64_tr_b16 v[202:203], v25 offset:6912
    v_lshlrev_b32 v10, 2, v10
    v_mfma_f32_16x16x32_bf16 v[72:75], v[152:155], v[136:139], v[72:75]
    ds_read_b64_tr_b16 v[204:205], v26 offset:6144
    v_lshl_add_u32 v10, v12, 5, v10
    v_mfma_f32_16x16x32_bf16 v[76:79], v[152:155], v[140:143], v[76:79]
    ds_read_b64_tr_b16 v[206:207], v26 offset:6912
    v_xor_b32 v11, 128, v10
    v_mfma_f32_16x16x32_bf16 v[80:83], v[156:159], v[128:131], v[80:83]
    buffer_load_dwordx4 v[244:247], v4, s[52:55], s72 offen offset:3072
    v_mfma_f32_16x16x32_bf16 v[84:87], v[156:159], v[132:135], v[84:87]
    s_mov_b32 exec_lo, 0x000f000f
    s_mov_b32 exec_hi, 0x000f000f
    ds_write_b128 v17, v[208:211]
    ds_write_b128 v17, v[212:215] offset:192
    s_mov_b64 exec, -1
    v_mfma_f32_16x16x32_bf16 v[88:91], v[156:159], v[136:139], v[88:91]
    v_and_b32 v20, 31, v2
    v_mfma_f32_16x16x32_bf16 v[92:95], v[156:159], v[140:143], v[92:95]
    v_lshlrev_b32 v20, 4, v20
    v_lshrrev_b32 v21, 5, v2
    v_mfma_f32_16x16x32_bf16 v[96:99], v[160:163], v[128:131], v[96:99]
    v_mul_u32_u24 v21, 69632, v21
    v_add_u32 v20, v20, v21
    v_mfma_f32_16x16x32_bf16 v[100:103], v[160:163], v[132:135], v[100:103]
    s_add_u32 s40, s72, 4096
    buffer_load_dwordx4 v[248:251], v4, s[52:55], s40 offen
    v_mfma_f32_16x16x32_bf16 v[104:107], v[160:163], v[136:139], v[104:107]
    v_mfma_f32_16x16x32_bf16 v[108:111], v[160:163], v[140:143], v[108:111]
    v_mfma_f32_16x16x32_bf16 v[112:115], v[164:167], v[128:131], v[112:115]
    v_mfma_f32_16x16x32_bf16 v[116:119], v[164:167], v[132:135], v[116:119]
    v_mfma_f32_16x16x32_bf16 v[120:123], v[164:167], v[136:139], v[120:123]
    v_mfma_f32_16x16x32_bf16 v[124:127], v[164:167], v[140:143], v[124:127]
    s_waitcnt lgkmcnt(0)
    s_setprio 3
    s_barrier
    v_mfma_f32_16x16x32_bf16 v[32:35], v[184:187], v[168:171], v[32:35]
    ds_bpermute_b32 v131, v10, v8 offset:0
    ds_bpermute_b32 v137, v10, v8 offset:64
    v_mfma_f32_16x16x32_bf16 v[36:39], v[184:187], v[172:175], v[36:39]
    ds_bpermute_b32 v143, v11, v8 offset:0
    ds_bpermute_b32 v149, v11, v8 offset:64
    v_mfma_f32_16x16x32_bf16 v[40:43], v[184:187], v[176:179], v[40:43]
    ds_read_b128 v[152:155], v18 offset:0
    ds_read_b128 v[156:159], v19 offset:0
    v_mfma_f32_16x16x32_bf16 v[44:47], v[184:187], v[180:183], v[44:47]
    ds_read_b128 v[160:163], v18 offset:192
    ds_read_b128 v[164:167], v19 offset:192
    v_mfma_f32_16x16x32_bf16 v[80:83], v[196:199], v[168:171], v[80:83]
    s_add_u32 m0, s30, 131072
    s_add_u32 s40, s73, 1024
    buffer_load_dwordx4 v4, s[52:55], s40 offen lds
    v_mfma_f32_16x16x32_bf16 v[84:87], v[196:199], v[172:175], v[84:87]
    v_mfma_f32_16x16x32_bf16 v[88:91], v[196:199], v[176:179], v[88:91]
    v_mfma_f32_16x16x32_bf16 v[92:95], v[196:199], v[180:183], v[92:95]
    v_mfma_f32_16x16x32_bf16 v[48:51], v[188:191], v[168:171], v[48:51]
    v_mfma_f32_16x16x32_bf16 v[52:55], v[188:191], v[172:175], v[52:55]
    s_waitcnt lgkmcnt(0)
    v_and_b32 v130, s50, v131
    v_rcp_f32 v132, v130
    v_mfma_f32_16x16x32_bf16 v[56:59], v[188:191], v[176:179], v[56:59]
    v_lshlrev_b32 v128, 16, v131
    v_mul_f32 v130, v130, v130
    v_mfma_f32_16x16x32_bf16 v[60:63], v[188:191], v[180:183], v[60:63]
    v_mul_f32 v132, 0xbfb8aa3b, v132
    v_and_b32 v136, s50, v137
    v_mfma_f32_16x16x32_bf16 v[96:99], v[200:203], v[168:171], v[96:99]
    v_rcp_f32 v138, v136
    v_lshlrev_b32 v134, 16, v137
    s_add_u32 m0, s30, 139264
    s_add_u32 s40, s73, 2048
    buffer_load_dwordx4 v4, s[52:55], s40 offen lds
    v_mfma_f32_16x16x32_bf16 v[100:103], v[200:203], v[172:175], v[100:103]
    v_mul_f32 v136, v136, v136
    v_mul_f32 v138, 0xbfb8aa3b, v138
    v_mfma_f32_16x16x32_bf16 v[104:107], v[200:203], v[176:179], v[104:107]
    v_and_b32 v142, s50, v143
    v_rcp_f32 v144, v142
    v_mfma_f32_16x16x32_bf16 v[108:111], v[200:203], v[180:183], v[108:111]
    v_lshlrev_b32 v140, 16, v143
    v_mul_f32 v142, v142, v142
    v_mfma_f32_16x16x32_bf16 v[64:67], v[192:195], v[168:171], v[64:67]
    v_mul_f32 v144, 0xbfb8aa3b, v144
    v_and_b32 v148, s50, v149
    v_mfma_f32_16x16x32_bf16 v[68:71], v[192:195], v[172:175], v[68:71]
    v_rcp_f32 v150, v148
    v_lshlrev_b32 v146, 16, v149
    v_mfma_f32_16x16x32_bf16 v[72:75], v[192:195], v[176:179], v[72:75]
    v_mul_f32 v148, v148, v148
    v_mul_f32 v150, 0xbfb8aa3b, v150
    v_mfma_f32_16x16x32_bf16 v[76:79], v[192:195], v[180:183], v[76:79]
    v_mfma_f32_16x16x32_bf16 v[112:115], v[204:207], v[168:171], v[112:115]
    s_add_u32 m0, s30, 155648
    s_add_u32 s40, s73, 4096
    buffer_load_dwordx4 v4, s[52:55], s40 offen lds
    v_mfma_f32_16x16x32_bf16 v[116:119], v[204:207], v[172:175], v[116:119]
    v_mfma_f32_16x16x32_bf16 v[120:123], v[204:207], v[176:179], v[120:123]
    v_mfma_f32_16x16x32_bf16 v[124:127], v[204:207], v[180:183], v[124:127]
    v_pk_fma_f32 v[32:33], v[208:209], v[128:129], v[32:33] op_sel:[0,0,0] op_sel_hi:[1,0,1] neg_lo:[0,1,0] neg_hi:[0,1,0]
    v_pk_fma_f32 v[34:35], v[210:211], v[128:129], v[34:35] op_sel:[0,0,0] op_sel_hi:[1,0,1] neg_lo:[0,1,0] neg_hi:[0,1,0]
    v_pk_fma_f32 v[36:37], v[208:209], v[134:135], v[36:37] op_sel:[0,0,0] op_sel_hi:[1,0,1] neg_lo:[0,1,0] neg_hi:[0,1,0]
    v_pk_fma_f32 v[38:39], v[210:211], v[134:135], v[38:39] op_sel:[0,0,0] op_sel_hi:[1,0,1] neg_lo:[0,1,0] neg_hi:[0,1,0]
    buffer_load_dwordx4 v[192:195], v4, s[52:55], s70 offen offset:0
    v_pk_fma_f32 v[80:81], v[212:213], v[128:129], v[80:81] op_sel:[0,0,0] op_sel_hi:[1,0,1] neg_lo:[0,1,0] neg_hi:[0,1,0]
    v_pk_fma_f32 v[82:83], v[214:215], v[128:129], v[82:83] op_sel:[0,0,0] op_sel_hi:[1,0,1] neg_lo:[0,1,0] neg_hi:[0,1,0]
    v_pk_fma_f32 v[84:85], v[212:213], v[134:135], v[84:85] op_sel:[0,0,0] op_sel_hi:[1,0,1] neg_lo:[0,1,0] neg_hi:[0,1,0]
    v_pk_fma_f32 v[86:87], v[214:215], v[134:135], v[86:87] op_sel:[0,0,0] op_sel_hi:[1,0,1] neg_lo:[0,1,0] neg_hi:[0,1,0]
    buffer_load_dwordx4 v[196:199], v4, s[52:55], s70 offen offset:1024
    v_pk_mul_f32 v[80:81], v[32:33], v[80:81]
    v_pk_mul_f32 v[82:83], v[34:35], v[82:83]
    v_pk_mul_f32 v[84:85], v[36:37], v[84:85]
    v_pk_mul_f32 v[86:87], v[38:39], v[86:87]
    buffer_load_dwordx4 v[200:203], v4, s[52:55], s70 offen offset:2048
    v_pk_mul_f32 v[32:33], v[32:33], v[132:133] op_sel:[0,0] op_sel_hi:[1,0]
    v_pk_mul_f32 v[34:35], v[34:35], v[132:133] op_sel:[0,0] op_sel_hi:[1,0]
    v_pk_mul_f32 v[36:37], v[36:37], v[138:139] op_sel:[0,0] op_sel_hi:[1,0]
    v_pk_mul_f32 v[38:39], v[38:39], v[138:139] op_sel:[0,0] op_sel_hi:[1,0]
    buffer_load_dwordx4 v[204:207], v4, s[52:55], s70 offen offset:3072
    v_exp_f32 v32, v32
    v_exp_f32 v33, v33
    v_exp_f32 v34, v34
    v_exp_f32 v35, v35
    v_exp_f32 v36, v36
    v_exp_f32 v37, v37
    v_exp_f32 v38, v38
    v_exp_f32 v39, v39
    v_pk_fma_f32 v[32:33], v[32:33], v[130:131], v[130:131] op_sel:[0,0,0] op_sel_hi:[1,0,0]
    v_pk_fma_f32 v[34:35], v[34:35], v[130:131], v[130:131] op_sel:[0,0,0] op_sel_hi:[1,0,0]
    v_pk_fma_f32 v[36:37], v[36:37], v[136:137], v[136:137] op_sel:[0,0,0] op_sel_hi:[1,0,0]
    v_pk_fma_f32 v[38:39], v[38:39], v[136:137], v[136:137] op_sel:[0,0,0] op_sel_hi:[1,0,0]
    v_rcp_f32 v32, v32
    v_rcp_f32 v33, v33
    v_rcp_f32 v34, v34
    v_rcp_f32 v35, v35
    v_rcp_f32 v36, v36
    v_rcp_f32 v37, v37
    v_rcp_f32 v38, v38
    v_rcp_f32 v39, v39
    v_pk_mul_f32 v[80:81], v[32:33], v[80:81]
    v_pk_mul_f32 v[82:83], v[34:35], v[82:83]
    v_pk_mul_f32 v[84:85], v[36:37], v[84:85]
    v_pk_mul_f32 v[86:87], v[38:39], v[86:87]
    v_cvt_pk_bf16_f32 v32, v80, v81
    v_cvt_pk_bf16_f32 v33, v82, v83
    v_cvt_pk_bf16_f32 v34, v84, v85
    v_cvt_pk_bf16_f32 v35, v86, v87
    s_nop 1
    v_permlane32_swap_b32 v32, v34
    v_permlane32_swap_b32 v33, v35
    buffer_store_dwordx4 v[32:35], v20, s[8:11], s4 offen sc1
    v_pk_fma_f32 v[40:41], v[208:209], v[140:141], v[40:41] op_sel:[0,0,0] op_sel_hi:[1,0,1] neg_lo:[0,1,0] neg_hi:[0,1,0]
    v_pk_fma_f32 v[42:43], v[210:211], v[140:141], v[42:43] op_sel:[0,0,0] op_sel_hi:[1,0,1] neg_lo:[0,1,0] neg_hi:[0,1,0]
    v_pk_fma_f32 v[44:45], v[208:209], v[146:147], v[44:45] op_sel:[0,0,0] op_sel_hi:[1,0,1] neg_lo:[0,1,0] neg_hi:[0,1,0]
    v_pk_fma_f32 v[46:47], v[210:211], v[146:147], v[46:47] op_sel:[0,0,0] op_sel_hi:[1,0,1] neg_lo:[0,1,0] neg_hi:[0,1,0]
    v_pk_fma_f32 v[88:89], v[212:213], v[140:141], v[88:89] op_sel:[0,0,0] op_sel_hi:[1,0,1] neg_lo:[0,1,0] neg_hi:[0,1,0]
    v_pk_fma_f32 v[90:91], v[214:215], v[140:141], v[90:91] op_sel:[0,0,0] op_sel_hi:[1,0,1] neg_lo:[0,1,0] neg_hi:[0,1,0]
    v_pk_fma_f32 v[92:93], v[212:213], v[146:147], v[92:93] op_sel:[0,0,0] op_sel_hi:[1,0,1] neg_lo:[0,1,0] neg_hi:[0,1,0]
    v_pk_fma_f32 v[94:95], v[214:215], v[146:147], v[94:95] op_sel:[0,0,0] op_sel_hi:[1,0,1] neg_lo:[0,1,0] neg_hi:[0,1,0]
    v_pk_mul_f32 v[88:89], v[40:41], v[88:89]
    v_pk_mul_f32 v[90:91], v[42:43], v[90:91]
    v_pk_mul_f32 v[92:93], v[44:45], v[92:93]
    v_pk_mul_f32 v[94:95], v[46:47], v[94:95]
    v_pk_mul_f32 v[40:41], v[40:41], v[144:145] op_sel:[0,0] op_sel_hi:[1,0]
    v_pk_mul_f32 v[42:43], v[42:43], v[144:145] op_sel:[0,0] op_sel_hi:[1,0]
    v_pk_mul_f32 v[44:45], v[44:45], v[150:151] op_sel:[0,0] op_sel_hi:[1,0]
    v_pk_mul_f32 v[46:47], v[46:47], v[150:151] op_sel:[0,0] op_sel_hi:[1,0]
    v_exp_f32 v40, v40
    v_exp_f32 v41, v41
    v_exp_f32 v42, v42
    v_exp_f32 v43, v43
    v_exp_f32 v44, v44
    v_exp_f32 v45, v45
    v_exp_f32 v46, v46
    v_exp_f32 v47, v47
    v_pk_fma_f32 v[40:41], v[40:41], v[142:143], v[142:143] op_sel:[0,0,0] op_sel_hi:[1,0,0]
    v_pk_fma_f32 v[42:43], v[42:43], v[142:143], v[142:143] op_sel:[0,0,0] op_sel_hi:[1,0,0]
    v_pk_fma_f32 v[44:45], v[44:45], v[148:149], v[148:149] op_sel:[0,0,0] op_sel_hi:[1,0,0]
    v_pk_fma_f32 v[46:47], v[46:47], v[148:149], v[148:149] op_sel:[0,0,0] op_sel_hi:[1,0,0]
    v_rcp_f32 v40, v40
    v_rcp_f32 v41, v41
    v_rcp_f32 v42, v42
    v_rcp_f32 v43, v43
    v_rcp_f32 v44, v44
    v_rcp_f32 v45, v45
    v_rcp_f32 v46, v46
    v_rcp_f32 v47, v47
    v_pk_mul_f32 v[88:89], v[40:41], v[88:89]
    v_pk_mul_f32 v[90:91], v[42:43], v[90:91]
    v_pk_mul_f32 v[92:93], v[44:45], v[92:93]
    v_pk_mul_f32 v[94:95], v[46:47], v[94:95]
    v_cvt_pk_bf16_f32 v40, v88, v89
    v_cvt_pk_bf16_f32 v41, v90, v91
    v_cvt_pk_bf16_f32 v42, v92, v93
    v_cvt_pk_bf16_f32 v43, v94, v95
    s_nop 1
    v_permlane32_swap_b32 v40, v42
    v_permlane32_swap_b32 v41, v43
    buffer_store_dwordx4 v[40:43], v20, s[8:11], s5 offen sc1
    v_pk_fma_f32 v[48:49], v[152:153], v[128:129], v[48:49] op_sel:[0,0,0] op_sel_hi:[1,0,1] neg_lo:[0,1,0] neg_hi:[0,1,0]
    v_pk_fma_f32 v[50:51], v[154:155], v[128:129], v[50:51] op_sel:[0,0,0] op_sel_hi:[1,0,1] neg_lo:[0,1,0] neg_hi:[0,1,0]
    v_pk_fma_f32 v[52:53], v[152:153], v[134:135], v[52:53] op_sel:[0,0,0] op_sel_hi:[1,0,1] neg_lo:[0,1,0] neg_hi:[0,1,0]
    v_pk_fma_f32 v[54:55], v[154:155], v[134:135], v[54:55] op_sel:[0,0,0] op_sel_hi:[1,0,1] neg_lo:[0,1,0] neg_hi:[0,1,0]
    s_add_u32 s40, s70, 4096
    buffer_load_dwordx4 v[208:211], v4, s[52:55], s40 offen
    v_pk_fma_f32 v[96:97], v[160:161], v[128:129], v[96:97] op_sel:[0,0,0] op_sel_hi:[1,0,1] neg_lo:[0,1,0] neg_hi:[0,1,0]
    v_pk_fma_f32 v[98:99], v[162:163], v[128:129], v[98:99] op_sel:[0,0,0] op_sel_hi:[1,0,1] neg_lo:[0,1,0] neg_hi:[0,1,0]
    v_pk_fma_f32 v[100:101], v[160:161], v[134:135], v[100:101] op_sel:[0,0,0] op_sel_hi:[1,0,1] neg_lo:[0,1,0] neg_hi:[0,1,0]
    v_pk_fma_f32 v[102:103], v[162:163], v[134:135], v[102:103] op_sel:[0,0,0] op_sel_hi:[1,0,1] neg_lo:[0,1,0] neg_hi:[0,1,0]
    buffer_load_dwordx4 v[212:215], v4, s[52:55], s71 offen offset:0
    v_pk_mul_f32 v[96:97], v[48:49], v[96:97]
    v_pk_mul_f32 v[98:99], v[50:51], v[98:99]
    v_pk_mul_f32 v[100:101], v[52:53], v[100:101]
    v_pk_mul_f32 v[102:103], v[54:55], v[102:103]
    v_pk_mul_f32 v[48:49], v[48:49], v[132:133] op_sel:[0,0] op_sel_hi:[1,0]
    v_pk_mul_f32 v[50:51], v[50:51], v[132:133] op_sel:[0,0] op_sel_hi:[1,0]
    v_pk_mul_f32 v[52:53], v[52:53], v[138:139] op_sel:[0,0] op_sel_hi:[1,0]
    v_pk_mul_f32 v[54:55], v[54:55], v[138:139] op_sel:[0,0] op_sel_hi:[1,0]
    v_exp_f32 v48, v48
    v_exp_f32 v49, v49
    v_exp_f32 v50, v50
    v_exp_f32 v51, v51
    v_exp_f32 v52, v52
    v_exp_f32 v53, v53
    v_exp_f32 v54, v54
    v_exp_f32 v55, v55
    v_pk_fma_f32 v[48:49], v[48:49], v[130:131], v[130:131] op_sel:[0,0,0] op_sel_hi:[1,0,0]
    v_pk_fma_f32 v[50:51], v[50:51], v[130:131], v[130:131] op_sel:[0,0,0] op_sel_hi:[1,0,0]
    v_pk_fma_f32 v[52:53], v[52:53], v[136:137], v[136:137] op_sel:[0,0,0] op_sel_hi:[1,0,0]
    v_pk_fma_f32 v[54:55], v[54:55], v[136:137], v[136:137] op_sel:[0,0,0] op_sel_hi:[1,0,0]
    v_rcp_f32 v48, v48
    v_rcp_f32 v49, v49
    v_rcp_f32 v50, v50
    v_rcp_f32 v51, v51
    v_rcp_f32 v52, v52
    v_rcp_f32 v53, v53
    v_rcp_f32 v54, v54
    v_rcp_f32 v55, v55
    v_pk_mul_f32 v[96:97], v[48:49], v[96:97]
    v_pk_mul_f32 v[98:99], v[50:51], v[98:99]
    v_pk_mul_f32 v[100:101], v[52:53], v[100:101]
    v_pk_mul_f32 v[102:103], v[54:55], v[102:103]
    v_cvt_pk_bf16_f32 v48, v96, v97
    v_cvt_pk_bf16_f32 v49, v98, v99
    v_cvt_pk_bf16_f32 v50, v100, v101
    v_cvt_pk_bf16_f32 v51, v102, v103
    s_nop 1
    v_permlane32_swap_b32 v48, v50
    v_permlane32_swap_b32 v49, v51
    buffer_store_dwordx4 v[48:51], v20, s[8:11], s20 offen sc1
    v_pk_fma_f32 v[56:57], v[152:153], v[140:141], v[56:57] op_sel:[0,0,0] op_sel_hi:[1,0,1] neg_lo:[0,1,0] neg_hi:[0,1,0]
    v_pk_fma_f32 v[58:59], v[154:155], v[140:141], v[58:59] op_sel:[0,0,0] op_sel_hi:[1,0,1] neg_lo:[0,1,0] neg_hi:[0,1,0]
    v_pk_fma_f32 v[60:61], v[152:153], v[146:147], v[60:61] op_sel:[0,0,0] op_sel_hi:[1,0,1] neg_lo:[0,1,0] neg_hi:[0,1,0]
    v_pk_fma_f32 v[62:63], v[154:155], v[146:147], v[62:63] op_sel:[0,0,0] op_sel_hi:[1,0,1] neg_lo:[0,1,0] neg_hi:[0,1,0]
    v_pk_fma_f32 v[104:105], v[160:161], v[140:141], v[104:105] op_sel:[0,0,0] op_sel_hi:[1,0,1] neg_lo:[0,1,0] neg_hi:[0,1,0]
    v_pk_fma_f32 v[106:107], v[162:163], v[140:141], v[106:107] op_sel:[0,0,0] op_sel_hi:[1,0,1] neg_lo:[0,1,0] neg_hi:[0,1,0]
    v_pk_fma_f32 v[108:109], v[160:161], v[146:147], v[108:109] op_sel:[0,0,0] op_sel_hi:[1,0,1] neg_lo:[0,1,0] neg_hi:[0,1,0]
    v_pk_fma_f32 v[110:111], v[162:163], v[146:147], v[110:111] op_sel:[0,0,0] op_sel_hi:[1,0,1] neg_lo:[0,1,0] neg_hi:[0,1,0]
    v_pk_mul_f32 v[104:105], v[56:57], v[104:105]
    v_pk_mul_f32 v[106:107], v[58:59], v[106:107]
    v_pk_mul_f32 v[108:109], v[60:61], v[108:109]
    v_pk_mul_f32 v[110:111], v[62:63], v[110:111]
    v_pk_mul_f32 v[56:57], v[56:57], v[144:145] op_sel:[0,0] op_sel_hi:[1,0]
    v_pk_mul_f32 v[58:59], v[58:59], v[144:145] op_sel:[0,0] op_sel_hi:[1,0]
    v_pk_mul_f32 v[60:61], v[60:61], v[150:151] op_sel:[0,0] op_sel_hi:[1,0]
    v_pk_mul_f32 v[62:63], v[62:63], v[150:151] op_sel:[0,0] op_sel_hi:[1,0]
    v_exp_f32 v56, v56
    v_exp_f32 v57, v57
    v_exp_f32 v58, v58
    v_exp_f32 v59, v59
    v_exp_f32 v60, v60
    v_exp_f32 v61, v61
    v_exp_f32 v62, v62
    v_exp_f32 v63, v63
    v_pk_fma_f32 v[56:57], v[56:57], v[142:143], v[142:143] op_sel:[0,0,0] op_sel_hi:[1,0,0]
    v_pk_fma_f32 v[58:59], v[58:59], v[142:143], v[142:143] op_sel:[0,0,0] op_sel_hi:[1,0,0]
    v_pk_fma_f32 v[60:61], v[60:61], v[148:149], v[148:149] op_sel:[0,0,0] op_sel_hi:[1,0,0]
    v_pk_fma_f32 v[62:63], v[62:63], v[148:149], v[148:149] op_sel:[0,0,0] op_sel_hi:[1,0,0]
    v_rcp_f32 v56, v56
    v_rcp_f32 v57, v57
    v_rcp_f32 v58, v58
    v_rcp_f32 v59, v59
    v_rcp_f32 v60, v60
    v_rcp_f32 v61, v61
    v_rcp_f32 v62, v62
    v_rcp_f32 v63, v63
    v_pk_mul_f32 v[104:105], v[56:57], v[104:105]
    v_pk_mul_f32 v[106:107], v[58:59], v[106:107]
    v_pk_mul_f32 v[108:109], v[60:61], v[108:109]
    v_pk_mul_f32 v[110:111], v[62:63], v[110:111]
    v_cvt_pk_bf16_f32 v56, v104, v105
    v_cvt_pk_bf16_f32 v57, v106, v107
    v_cvt_pk_bf16_f32 v58, v108, v109
    v_cvt_pk_bf16_f32 v59, v110, v111
    s_nop 1
    v_permlane32_swap_b32 v56, v58
    v_permlane32_swap_b32 v57, v59
    buffer_store_dwordx4 v[56:59], v20, s[8:11], s28 offen sc1
    v_pk_fma_f32 v[64:65], v[156:157], v[128:129], v[64:65] op_sel:[0,0,0] op_sel_hi:[1,0,1] neg_lo:[0,1,0] neg_hi:[0,1,0]
    v_pk_fma_f32 v[66:67], v[158:159], v[128:129], v[66:67] op_sel:[0,0,0] op_sel_hi:[1,0,1] neg_lo:[0,1,0] neg_hi:[0,1,0]
    v_pk_fma_f32 v[68:69], v[156:157], v[134:135], v[68:69] op_sel:[0,0,0] op_sel_hi:[1,0,1] neg_lo:[0,1,0] neg_hi:[0,1,0]
    v_pk_fma_f32 v[70:71], v[158:159], v[134:135], v[70:71] op_sel:[0,0,0] op_sel_hi:[1,0,1] neg_lo:[0,1,0] neg_hi:[0,1,0]
    s_and_b32 s43, s2, 7
    s_lshl_b32 s43, s43, 2
    s_lshr_b32 s41, s2, 6
    v_pk_fma_f32 v[112:113], v[164:165], v[128:129], v[112:113] op_sel:[0,0,0] op_sel_hi:[1,0,1] neg_lo:[0,1,0] neg_hi:[0,1,0]
    v_pk_fma_f32 v[114:115], v[166:167], v[128:129], v[114:115] op_sel:[0,0,0] op_sel_hi:[1,0,1] neg_lo:[0,1,0] neg_hi:[0,1,0]
    v_pk_fma_f32 v[116:117], v[164:165], v[134:135], v[116:117] op_sel:[0,0,0] op_sel_hi:[1,0,1] neg_lo:[0,1,0] neg_hi:[0,1,0]
    v_pk_fma_f32 v[118:119], v[166:167], v[134:135], v[118:119] op_sel:[0,0,0] op_sel_hi:[1,0,1] neg_lo:[0,1,0] neg_hi:[0,1,0]
    s_add_u32 s43, s43, s41
    s_mul_i32 s40, s43, 4*69632
    s_and_b32 s42, s22, 1
    v_pk_mul_f32 v[112:113], v[64:65], v[112:113]
    v_pk_mul_f32 v[114:115], v[66:67], v[114:115]
    v_pk_mul_f32 v[116:117], v[68:69], v[116:117]
    v_pk_mul_f32 v[118:119], v[70:71], v[118:119]
    s_mul_i32 s42, s42, 2*69632
    s_add_u32 s12, s40, s42
    s_add_u32 s13, s12, 69632
    v_pk_mul_f32 v[64:65], v[64:65], v[132:133] op_sel:[0,0] op_sel_hi:[1,0]
    v_pk_mul_f32 v[66:67], v[66:67], v[132:133] op_sel:[0,0] op_sel_hi:[1,0]
    v_pk_mul_f32 v[68:69], v[68:69], v[138:139] op_sel:[0,0] op_sel_hi:[1,0]
    v_pk_mul_f32 v[70:71], v[70:71], v[138:139] op_sel:[0,0] op_sel_hi:[1,0]
    s_sub_u32 s14, s40, s42
    s_add_u32 s14, s14, 2*69632
    s_add_u32 s15, s14, 69632
    v_exp_f32 v64, v64
    v_exp_f32 v65, v65
    v_exp_f32 v66, v66
    v_exp_f32 v67, v67
    v_exp_f32 v68, v68
    v_exp_f32 v69, v69
    v_exp_f32 v70, v70
    v_exp_f32 v71, v71
    s_mul_i32 s40, s22, 6144
    s_add_u32 s40, s40, 20480
    s_add_u32 s44, s12, s40
    v_pk_fma_f32 v[64:65], v[64:65], v[130:131], v[130:131] op_sel:[0,0,0] op_sel_hi:[1,0,0]
    v_pk_fma_f32 v[66:67], v[66:67], v[130:131], v[130:131] op_sel:[0,0,0] op_sel_hi:[1,0,0]
    v_pk_fma_f32 v[68:69], v[68:69], v[136:137], v[136:137] op_sel:[0,0,0] op_sel_hi:[1,0,0]
    v_pk_fma_f32 v[70:71], v[70:71], v[136:137], v[136:137] op_sel:[0,0,0] op_sel_hi:[1,0,0]
    s_add_u32 s45, s13, s40
    s_add_u32 s46, s14, s40
    s_add_u32 s47, s15, s40
    v_rcp_f32 v64, v64
    v_rcp_f32 v65, v65
    v_rcp_f32 v66, v66
    v_rcp_f32 v67, v67
    v_rcp_f32 v68, v68
    v_rcp_f32 v69, v69
    v_rcp_f32 v70, v70
    v_rcp_f32 v71, v71
    s_mul_i32 s40, s22, 5120
    s_and_b32 s42, s22, 4
    s_mul_i32 s41, s42, 5888
    v_pk_mul_f32 v[112:113], v[64:65], v[112:113]
    v_pk_mul_f32 v[114:115], v[66:67], v[114:115]
    v_pk_mul_f32 v[116:117], v[68:69], v[116:117]
    v_pk_mul_f32 v[118:119], v[70:71], v[118:119]
    s_sub_u32 s40, s40, s41
    s_add_u32 s40, s40, 3072
    s_add_u32 s12, s12, s40
    v_cvt_pk_bf16_f32 v64, v112, v113
    v_cvt_pk_bf16_f32 v65, v114, v115
    v_cvt_pk_bf16_f32 v66, v116, v117
    v_cvt_pk_bf16_f32 v67, v118, v119
    s_nop 1
    v_permlane32_swap_b32 v64, v66
    v_permlane32_swap_b32 v65, v67
    buffer_store_dwordx4 v[64:67], v20, s[8:11], s39 offen sc1
    v_pk_fma_f32 v[72:73], v[156:157], v[140:141], v[72:73] op_sel:[0,0,0] op_sel_hi:[1,0,1] neg_lo:[0,1,0] neg_hi:[0,1,0]
    v_pk_fma_f32 v[74:75], v[158:159], v[140:141], v[74:75] op_sel:[0,0,0] op_sel_hi:[1,0,1] neg_lo:[0,1,0] neg_hi:[0,1,0]
    v_pk_fma_f32 v[76:77], v[156:157], v[146:147], v[76:77] op_sel:[0,0,0] op_sel_hi:[1,0,1] neg_lo:[0,1,0] neg_hi:[0,1,0]
    v_pk_fma_f32 v[78:79], v[158:159], v[146:147], v[78:79] op_sel:[0,0,0] op_sel_hi:[1,0,1] neg_lo:[0,1,0] neg_hi:[0,1,0]
    s_add_u32 s13, s13, s40
    s_add_u32 s14, s14, s40
    s_add_u32 s15, s15, s40
    v_pk_fma_f32 v[120:121], v[164:165], v[140:141], v[120:121] op_sel:[0,0,0] op_sel_hi:[1,0,1] neg_lo:[0,1,0] neg_hi:[0,1,0]
    v_pk_fma_f32 v[122:123], v[166:167], v[140:141], v[122:123] op_sel:[0,0,0] op_sel_hi:[1,0,1] neg_lo:[0,1,0] neg_hi:[0,1,0]
    v_pk_fma_f32 v[124:125], v[164:165], v[146:147], v[124:125] op_sel:[0,0,0] op_sel_hi:[1,0,1] neg_lo:[0,1,0] neg_hi:[0,1,0]
    v_pk_fma_f32 v[126:127], v[166:167], v[146:147], v[126:127] op_sel:[0,0,0] op_sel_hi:[1,0,1] neg_lo:[0,1,0] neg_hi:[0,1,0]
    s_lshl_b32 s43, s43, 3
    s_add_u32 s43, s43, s22
    s_lshl_b32 s43, s43, 8
    v_pk_mul_f32 v[120:121], v[72:73], v[120:121]
    v_pk_mul_f32 v[122:123], v[74:75], v[122:123]
    v_pk_mul_f32 v[124:125], v[76:77], v[124:125]
    v_pk_mul_f32 v[126:127], v[78:79], v[126:127]
    v_and_b32 v15, 15, v2
    s_lshl_b32 s42, s42, 8
    v_lshrrev_b32 v13, 2, v15
    v_pk_mul_f32 v[72:73], v[72:73], v[144:145] op_sel:[0,0] op_sel_hi:[1,0]
    v_pk_mul_f32 v[74:75], v[74:75], v[144:145] op_sel:[0,0] op_sel_hi:[1,0]
    v_pk_mul_f32 v[76:77], v[76:77], v[150:151] op_sel:[0,0] op_sel_hi:[1,0]
    v_pk_mul_f32 v[78:79], v[78:79], v[150:151] op_sel:[0,0] op_sel_hi:[1,0]
    v_min_u32 v13, 1, v13
    v_mul_u32_u24 v13, s42, v13
    v_lshl_add_u32 v15, v15, 2, s43
    v_exp_f32 v72, v72
    v_exp_f32 v73, v73
    v_exp_f32 v74, v74
    v_exp_f32 v75, v75
    v_exp_f32 v76, v76
    v_exp_f32 v77, v77
    v_exp_f32 v78, v78
    v_exp_f32 v79, v79
    v_sub_u32 v15, v15, v13
    v_pk_fma_f32 v[72:73], v[72:73], v[142:143], v[142:143] op_sel:[0,0,0] op_sel_hi:[1,0,0]
    v_pk_fma_f32 v[74:75], v[74:75], v[142:143], v[142:143] op_sel:[0,0,0] op_sel_hi:[1,0,0]
    v_pk_fma_f32 v[76:77], v[76:77], v[148:149], v[148:149] op_sel:[0,0,0] op_sel_hi:[1,0,0]
    v_pk_fma_f32 v[78:79], v[78:79], v[148:149], v[148:149] op_sel:[0,0,0] op_sel_hi:[1,0,0]
    v_rcp_f32 v72, v72
    v_rcp_f32 v73, v73
    v_rcp_f32 v74, v74
    v_rcp_f32 v75, v75
    v_rcp_f32 v76, v76
    v_rcp_f32 v77, v77
    v_rcp_f32 v78, v78
    v_rcp_f32 v79, v79
    v_pk_mul_f32 v[120:121], v[72:73], v[120:121]
    v_pk_mul_f32 v[122:123], v[74:75], v[122:123]
    v_pk_mul_f32 v[124:125], v[76:77], v[124:125]
    v_pk_mul_f32 v[126:127], v[78:79], v[126:127]
    v_cvt_pk_bf16_f32 v72, v120, v121
    v_cvt_pk_bf16_f32 v73, v122, v123
    v_cvt_pk_bf16_f32 v74, v124, v125
    v_cvt_pk_bf16_f32 v75, v126, v127
    s_nop 1
    v_permlane32_swap_b32 v72, v74
    v_permlane32_swap_b32 v73, v75
    buffer_store_dwordx4 v[72:75], v20, s[8:11], s51 offen sc1
    s_branch G2
G1_qkv:
    s_sub_u32 s21, s20, 16
    s_lshl_b32 s69, s21, 4
    s_and_b32 s40, s22, 2
    s_lshl_b32 s40, s40, 2
    s_add_u32 s69, s69, s40
    s_lshr_b32 s40, s22, 2
    s_lshl_b32 s40, s40, 1
    s_add_u32 s69, s69, s40
    s_lshr_b32 s40, s3, 2
    s_add_u32 s69, s69, s40
    s_lshl_b32 s69, s69, 8
    s_and_b32 s40, s3, 3
    s_lshl_b32 s40, s40, 3
    s_add_u32 s69, s69, s40
    s_and_b32 s40, s22, 1
    s_lshl_b32 s40, s40, 2
    s_add_u32 s69, s69, s40
    s_add_u32 s69, s69, 16
    s_mov_b32 s48, 46080
    s_mov_b32 s49, 46080
    s_sub_u32 s79, s2, 128
    s_lshl_b32 s79, s79, 4
    s_and_b32 s40, s22, 3
    s_lshl_b32 s40, s40, 2
    s_add_u32 s79, s79, s40
    s_add_u32 s79, s79, 65536
    s_cmp_lt_u32 s22, 4
    s_cselect_b32 s79, 413696, s79
    s_lshl_b32 s40, s21, 7
    s_lshr_b32 s41, s22, 2
    s_lshl_b32 s41, s41, 6
    s_add_u32 s41, s41, s40
    s_lshl_b32 s41, s41, 3
    s_add_u32 s41, s41, 69632
    v_add_u32 v237, s41, v232
    s_sub_u32 s40, s40, 16
    s_max_i32 s40, s40, 0
    v_and_b32 v236, 7, v2
    v_bfe_u32 v235, v2, 3, 1
    v_lshl_add_u32 v236, v236, 1, v235
    v_add_u32 v236, s40, v236
    v_lshlrev_b32 v236, 3, v236
    v_add_u32 v236, 69632, v236
    s_sub_u32 s40, s22, 4
    s_cmp_lt_u32 s40, 3
    s_cselect_b32 s51, 119, 0
    s_cselect_b32 s40, 256, 0
    s_lshr_b32 s77, s51, 1
    s_or_b32 s78, s78, s40
    s_mov_b32 s12, s28
    s_mov_b32 s13, s29
    s_and_b32 s13, s13, 0xffff
    s_mov_b32 s14, 0x258000
    s_mov_b32 s15, 0x00020000
    s_cmp_eq_u32 s22, 0
    s_cselect_b32 s44, s8, s12
    s_cselect_b32 s45, s9, s13
    s_cselect_b32 s46, s38, s14
    s_mov_b32 s47, 0x00020000
    s_lshl_b32 s5, s21, 7
    s_sub_u32 s40, s22, 2
    s_lshr_b32 s32, s40, 2
    s_lshl_b32 s32, s32, 5
    s_bfe_u32 s41, s40, 0x10001
    s_add_u32 s32, s32, s41
    s_and_b32 s41, s40, 1
    s_lshl_b32 s41, s41, 4
    s_add_u32 s32, s32, s41
    s_add_u32 s32, s32, s5
    s_sub_u32 s41, s5, 16
    s_max_i32 s41, s41, 0
    s_add_u32 s41, s41, s22
    s_cmp_lt_u32 s22, 2
    s_cselect_b32 s32, s41, s32
    s_mul_i32 s32, s32, 1280
    s_add_u32 s40, s22, 7
    s_lshr_b32 s31, s40, 2
    s_lshl_b32 s31, s31, 5
    s_bfe_u32 s41, s40, 0x10001
    s_add_u32 s31, s31, s41
    s_and_b32 s41, s40, 1
    s_lshl_b32 s41, s41, 4
    s_add_u32 s31, s31, s41
    s_add_u32 s31, s31, s5
    s_mul_i32 s31, s31, 1280
    s_add_u32 s40, s5, 33
    s_mul_i32 s34, s40, 1280
    s_mul_i32 s33, s3, 160
    v_xor_b32 v6, 64, v5
    v_lshl_add_u32 v11, v1, 6, v2
    v_mul_u32_u24 v12, 1093, v11
    v_lshrrev_b32 v12, 15, v12
    v_mul_u32_u24 v13, 30, v12
    v_sub_u32 v13, v11, v13
    v_mul_u32_u24 v10, 26, v13
    v_lshrrev_b32 v10, 8, v10
    v_mul_u32_u24 v11, 10, v10
    v_sub_u32 v11, v13, v11
    v_and_b32 v13, 0x13, v12
    v_bfe_u32 v14, v12, 2, 1
    v_lshl_add_u32 v13, v14, 3, v13
    v_bfe_u32 v14, v12, 3, 1
    v_lshl_add_u32 v13, v14, 2, v13
    v_mul_u32_u24 v13, 3840, v13
    v_mul_u32_u24 v10, 1280, v10
    v_add_u32 v13, v13, v10
    v_lshl_add_u32 v7, v11, 4, v13
    v_add_u32 v15, 7, v1
    v_lshl_add_u32 v11, v15, 6, v2
    v_mul_u32_u24 v12, 1093, v11
    v_lshrrev_b32 v12, 15, v12
    v_mul_u32_u24 v13, 30, v12
    v_sub_u32 v13, v11, v13
    v_mul_u32_u24 v10, 26, v13
    v_lshrrev_b32 v10, 8, v10
    v_mul_u32_u24 v11, 10, v10
    v_sub_u32 v11, v13, v11
    v_and_b32 v13, 0x13, v12
    v_bfe_u32 v14, v12, 2, 1
    v_lshl_add_u32 v13, v14, 3, v13
    v_bfe_u32 v14, v12, 3, 1
    v_lshl_add_u32 v13, v14, 2, v13
    v_mul_u32_u24 v13, 3840, v13
    v_mul_u32_u24 v10, 1280, v10
    v_add_u32 v13, v13, v10
    v_lshl_add_u32 v8, v11, 4, v13
    v_cmp_eq_u32 vcc, 0, v1
    s_nop 1
    v_cndmask_b32 v9, v8, v6, vcc
    v_cndmask_b32 v8, v8, v5, vcc
    s_cmp_eq_u32 s22, 3
    s_cbranch_scc1 G1_vD
    s_cmp_eq_u32 s22, 7
    s_cbranch_scc1 G1_vE
    s_sub_u32 s40, s22, 1
    s_cmp_lt_u32 s40, 2
    s_cbranch_scc1 G1_vB
    s_add_u32 s40, s30, s36
    s_add_u32 m0, s40, 0
    s_nop 0
    buffer_load_dwordx4 v5, s[8:11], s32 offen lds
    s_cmp_lg_u32 s22, 0
    s_cbranch_scc1 1f
    s_add_u32 m0, s36, 8192
    s_nop 0
    buffer_load_dwordx4 v8, s[44:47], s34 offen lds
1:
    s_add_u32 s40, s30, s36
    s_add_u32 m0, s40, 9216
    s_nop 0
    buffer_load_dwordx4 v6, s[8:11], s31 offen lds
    s_add_u32 s40, s30, s48
    s_add_u32 m0, s40, 55296
    s_nop 0
    buffer_load_dwordx4 v7, s[12:15], s33 offen lds
    s_add_u32 s40, s40, 62464
    s_add_u32 s41, s36, 17408
    s_add_u32 s42, s34, 102400
    s_cmp_eq_u32 s22, 0
    s_cselect_b32 m0, s41, s40
    s_cselect_b32 s41, s42, s33
    buffer_load_dwordx4 v9, s[44:47], s41 offen lds
    s_add_u32 s33, s33, 122880
    s_sub_u32 s48, s48, 15360
    s_cselect_b32 s48, 46080, s48
    s_add_u32 s32, s32, 128
    s_add_u32 s31, s31, 128
    s_add_u32 s34, s34, 128
    s_add_u32 s36, s36, 18432
    s_cmp_eq_u32 s36, 55296
    s_cselect_b32 s36, 0, s36
    v_lshrrev_b32 v14, 2, v1
    v_lshl_add_u32 v10, v14, 13, v3
    v_xor_b32 v11, 64, v10
    v_lshrrev_b32 v16, 5, v2
    v_bfe_u32 v17, v2, 4, 1
    v_bfe_u32 v18, v2, 2, 2
    v_lshl_add_u32 v18, v16, 4, v18
    v_lshl_add_u32 v18, v17, 2, v18
    v_mul_u32_u24 v18, 480, v18
    v_and_b32 v17, 3, v2
    v_lshl_add_u32 v18, v17, 3, v18
    v_and_b32 v17, 3, v1
    v_lshl_add_u32 v18, v17, 7, v18
    v_add_u32 v18, 55296, v18
    s_lshr_b32 s56, s22, 2
    s_lshl_b32 s56, s56, 6
    s_cmp_eq_u32 s22, 7
    s_cselect_b32 s56, 0, s56
    s_xor_b32 s57, s56, 64
    v_add_u32 v15, s56, v18
    v_add_u32 v16, s57, v18
    v_mov_b32 v32, 0
    v_mov_b32 v33, 0
    v_mov_b32 v34, 0
    v_mov_b32 v35, 0
    v_mov_b32 v36, 0
    v_mov_b32 v37, 0
    v_mov_b32 v38, 0
    v_mov_b32 v39, 0
    v_mov_b32 v40, 0
    v_mov_b32 v41, 0
    v_mov_b32 v42, 0
    v_mov_b32 v43, 0
    v_mov_b32 v44, 0
    v_mov_b32 v45, 0
    v_mov_b32 v46, 0
    v_mov_b32 v47, 0
    v_mov_b32 v48, 0
    v_mov_b32 v49, 0
    v_mov_b32 v50, 0
    v_mov_b32 v51, 0
    v_mov_b32 v52, 0
    v_mov_b32 v53, 0
    v_mov_b32 v54, 0
    v_mov_b32 v55, 0
    v_mov_b32 v56, 0
    v_mov_b32 v57, 0
    v_mov_b32 v58, 0
    v_mov_b32 v59, 0
    v_mov_b32 v60, 0
    v_mov_b32 v61, 0
    v_mov_b32 v62, 0
    v_mov_b32 v63, 0
    v_mov_b32 v64, 0
    v_mov_b32 v65, 0
    v_mov_b32 v66, 0
    v_mov_b32 v67, 0
    v_mov_b32 v68, 0
    v_mov_b32 v69, 0
    v_mov_b32 v70, 0
    v_mov_b32 v71, 0
    v_mov_b32 v72, 0
    v_mov_b32 v73, 0
    v_mov_b32 v74, 0
    v_mov_b32 v75, 0
    v_mov_b32 v76, 0
    v_mov_b32 v77, 0
    v_mov_b32 v78, 0
    v_mov_b32 v79, 0
    v_mov_b32 v80, 0
    v_mov_b32 v81, 0
    v_mov_b32 v82, 0
    v_mov_b32 v83, 0
    v_mov_b32 v84, 0
    v_mov_b32 v85, 0
    v_mov_b32 v86, 0
    v_mov_b32 v87, 0
    v_mov_b32 v88, 0
    v_mov_b32 v89, 0
    v_mov_b32 v90, 0
    v_mov_b32 v91, 0
    v_mov_b32 v92, 0
    v_mov_b32 v93, 0
    v_mov_b32 v94, 0
    v_mov_b32 v95, 0
    v_mov_b32 v200, 0
    v_mov_b32 v201, 0
    v_mov_b32 v202, 0
    v_mov_b32 v203, 0
    v_mov_b32 v204, 0
    v_mov_b32 v205, 0
    v_mov_b32 v206, 0
    v_mov_b32 v207, 0
    v_mov_b32 v28, 0x3f803f80
    v_mov_b32 v29, 0x3f803f80
    v_mov_b32 v30, 0x3f803f80
    v_mov_b32 v31, 0x3f803f80
    s_mov_b32 s35, 0
    s_sub_u32 s28, 14, s21
    s_bitcmp1_b32 s21, 0
    s_cselect_b32 s28, 31, s28
    s_bitset1_b32 s78, s28
    s_lshl_b32 s29, s3, 3
    s_add_u32 s29, s29, s22
    s_lshl_b32 s29, s29, 11
    s_add_u32 s29, s29, 282624
    s_add_u32 s40, s30, s36
    s_add_u32 m0, s40, 0
    s_nop 0
    buffer_load_dwordx4 v5, s[8:11], s32 offen lds
    s_add_u32 s40, s30, s48
    s_add_u32 m0, s40, 55296
    s_nop 0
    buffer_load_dwordx4 v7, s[12:15], s33 offen lds
    s_add_u32 s40, s40, 62464
    s_add_u32 s41, s36, 8192
    s_add_u32 s42, s34, 0
    s_cmp_eq_u32 s22, 0
    s_cselect_b32 m0, s41, s40
    s_cselect_b32 s41, s42, s33
    buffer_load_dwordx4 v8, s[44:47], s41 offen lds
    s_add_u32 s33, s33, 122880
    s_sub_u32 s48, s48, 15360
    s_cselect_b32 s48, 46080, s48
    s_add_u32 s40, s30, s36
    s_add_u32 m0, s40, 9216
    s_nop 0
    buffer_load_dwordx4 v6, s[8:11], s31 offen lds
    s_add_u32 s40, s30, s48
    s_add_u32 m0, s40, 55296
    s_nop 0
    buffer_load_dwordx4 v7, s[12:15], s33 offen lds
    s_add_u32 s40, s40, 62464
    s_add_u32 s41, s36, 17408
    s_add_u32 s42, s34, 102400
    s_cmp_eq_u32 s22, 0
    s_cselect_b32 m0, s41, s40
    s_cselect_b32 s41, s42, s33
    buffer_load_dwordx4 v9, s[44:47], s41 offen lds
    s_add_u32 s33, s33, 122880
    s_sub_u32 s48, s48, 15360
    s_cselect_b32 s48, 46080, s48
    s_add_u32 s32, s32, 128
    s_add_u32 s31, s31, 128
    s_add_u32 s34, s34, 128
    s_add_u32 s36, s36, 18432
    s_cmp_eq_u32 s36, 55296
    s_cselect_b32 s36, 0, s36
    s_waitcnt vmcnt(10)
    v_lshlrev_b32 v134, 16, v128
    v_and_b32 v135, s50, v128
    v_lshlrev_b32 v136, 16, v129
    v_and_b32 v137, s50, v129
    v_lshlrev_b32 v138, 16, v130
    v_and_b32 v139, s50, v130
    v_lshlrev_b32 v140, 16, v131
    v_and_b32 v141, s50, v131
    v_lshlrev_b32 v142, 16, v132
    v_and_b32 v143, s50, v132
    v_add_f32 v144, v134, v135
    v_add_f32 v145, v136, v137
    v_add_f32 v144, v144, v138
    v_add_f32 v145, v145, v139
    v_add_f32 v144, v144, v140
    v_add_f32 v145, v145, v141
    v_add_f32 v144, v144, v142
    v_add_f32 v145, v145, v143
    v_add_f32 v144, v144, v145
    s_nop 1
    v_add_f32_dpp v144, v144, v144 row_ror:8 row_mask:0xf bank_mask:0xf
    s_nop 1
    v_add_f32_dpp v144, v144, v144 row_ror:4 row_mask:0xf bank_mask:0xf
    s_nop 1
    v_add_f32_dpp v144, v144, v144 row_ror:2 row_mask:0xf bank_mask:0xf
    s_nop 1
    v_add_f32_dpp v144, v144, v144 row_ror:1 row_mask:0xf bank_mask:0xf
    s_nop 1
    v_add_f32_dpp v144, v144, v144 row_bcast:15 row_mask:0xa bank_mask:0xf
    s_nop 1
    v_add_f32_dpp v144, v144, v144 row_bcast:31 row_mask:0xc bank_mask:0xf
    s_nop 1
    v_readlane_b32 s40, v144, 63
    v_mov_b32 v146, 0x3acccccd
    s_nop 0
    v_mul_f32 v147, s40, v146
    v_sub_f32 v134, v134, v147
    v_sub_f32 v135, v135, v147
    v_sub_f32 v136, v136, v147
    v_sub_f32 v137, v137, v147
    v_sub_f32 v138, v138, v147
    v_sub_f32 v139, v139, v147
    v_sub_f32 v140, v140, v147
    v_sub_f32 v141, v141, v147
    v_sub_f32 v142, v142, v147
    v_sub_f32 v143, v143, v147
    v_mul_f32 v144, v134, v134
    v_mul_f32 v145, v135, v135
    v_fmac_f32 v144, v136, v136
    v_fmac_f32 v145, v137, v137
    v_fmac_f32 v144, v138, v138
    v_fmac_f32 v145, v139, v139
    v_fmac_f32 v144, v140, v140
    v_fmac_f32 v145, v141, v141
    v_fmac_f32 v144, v142, v142
    v_fmac_f32 v145, v143, v143
    v_add_f32 v144, v144, v145
    s_nop 1
    v_add_f32_dpp v144, v144, v144 row_ror:8 row_mask:0xf bank_mask:0xf
    s_nop 1
    v_add_f32_dpp v144, v144, v144 row_ror:4 row_mask:0xf bank_mask:0xf
    s_nop 1
    v_add_f32_dpp v144, v144, v144 row_ror:2 row_mask:0xf bank_mask:0xf
    s_nop 1
    v_add_f32_dpp v144, v144, v144 row_ror:1 row_mask:0xf bank_mask:0xf
    s_nop 1
    v_add_f32_dpp v144, v144, v144 row_bcast:15 row_mask:0xa bank_mask:0xf
    s_nop 1
    v_add_f32_dpp v144, v144, v144 row_bcast:31 row_mask:0xc bank_mask:0xf
    s_nop 1
    v_readlane_b32 s40, v144, 63
    s_nop 1
    v_mul_f32 v148, s40, v146
    v_cvt_pk_bf16_f32 v148, v148, v148
    v_lshlrev_b32 v148, 16, v148
    v_add_f32 v148, 0x3727c5ac, v148
    v_cvt_pk_bf16_f32 v148, v148, v148
    v_lshlrev_b32 v148, 16, v148
    v_sqrt_f32 v148, v148
    s_nop 0
    v_cvt_pk_bf16_f32 v238, v147, v148
    s_lshl_b32 s23, s21, 3
    s_add_u32 s23, s23, s3
    s_mul_i32 s23, s23, 3
    s_add_u32 s23, s23, s22
    s_sub_u32 s23, s23, 4
    s_cmp_lt_u32 s23, 340
    s_cselect_b32 s61, -1, 0
    s_cmp_ge_u32 s23, 100
    s_cselect_b32 s52, s82, s80
    s_cselect_b32 s53, s83, s81
    s_cselect_b32 s25, 100, 0
    s_cselect_b32 s26, 20, 0
    s_sub_u32 s23, s23, s25
    s_mul_i32 s27, s23, 205
    s_lshr_b32 s27, s27, 10
    s_mul_i32 s25, s27, 5
    s_sub_u32 s23, s23, s25
    s_add_u32 s58, s27, s26
    s_mul_i32 s58, s58, 5120
    s_lshl_b32 s59, s23, 13
    s_add_u32 s58, s58, s59
    s_lshl_b32 s59, s23, 3
    s_lshl_b32 s60, s22, 13
    s_add_u32 s60, s60, 83968
    v_lshrrev_b32 v98, 4, v2
    v_lshl_add_u32 v99, s27, 2, v98
    v_lshlrev_b32 v96, 1, v98
    v_and_b32 v97, 15, v2
    v_xor_b32 v96, v96, v97
    v_mul_u32_u24 v97, 1280, v98
    v_lshl_add_u32 v96, v96, 4, v97
    v_xor_b32 v97, 128, v96
    s_mov_b32 s54, 819200
    s_cmp_eq_u32 s26, 0
    s_cbranch_scc1 PK_wo
    s_mov_b32 s54, 1966080
    v_mov_b32 v100, s27
    v_mul_u32_u24 v102, 86, v100
    v_lshrrev_b32 v102, 8, v102
    v_mul_u32_u24 v103, 3, v102
    v_sub_u32 v103, v100, v103
    v_lshrrev_b32 v104, 3, v102
    v_mul_u32_u24 v104, 48, v104
    v_lshl_add_u32 v103, v103, 4, v104
    v_and_b32 v102, 7, v102
    v_mul_u32_u24 v102, 192, v102
    v_add_u32 v102, v102, v103
    v_lshrrev_b32 v104, 1, v98
    v_mul_u32_u24 v104, 96, v104
    v_and_b32 v105, 1, v98
    v_lshl_add_u32 v104, v105, 2, v104
    v_add_u32 v102, v102, v104
    v_add_u32 v103, 8, v102
    s_branch PK_go
PK_wo:
    v_mul_u32_u24 v102, 103, v99
    v_lshrrev_b32 v102, 9, v102
    v_mul_u32_u24 v103, 5, v102
    v_sub_u32 v103, v99, v103
    v_lshrrev_b32 v104, 3, v102
    v_and_b32 v102, 7, v102
    v_lshl_add_u32 v102, v102, 1, v104
    v_mul_u32_u24 v102, 40, v102
    v_lshl_add_u32 v102, v103, 2, v102
    v_add_u32 v103, 20, v102
PK_go:
    s_lshl_b32 s23, s23, 8
    v_mul_u32_u24 v102, 1280, v102
    v_mul_u32_u24 v103, 1280, v103
    v_add_u32 v102, s23, v102
    v_add_u32 v103, s23, v103
    s_and_b32 s53, s53, 0xffff
    s_mov_b32 s55, 0x00020000
    s_and_b32 s54, s54, s61
    v_readlane_b32 s70, v102, 0
    v_readlane_b32 s71, v103, 0
    v_readlane_b32 s72, v102, 16
    v_readlane_b32 s73, v103, 16
    v_readlane_b32 s74, v102, 32
    v_readlane_b32 s75, v103, 32
    v_readlane_b32 s62, v102, 48
    v_readlane_b32 s63, v103, 48
PK_no:
    s_waitcnt vmcnt(6) lgkmcnt(0)
    s_add_u32 s76, s76, 0x9e3779b9
    v_add_u32 v22, s37, v10
    v_add_u32 v24, s49, v15
    v_add_u32 v25, s49, v16
    s_barrier
    ds_read_b128 v[128:131], v22 offset:2048
    ds_read_b128 v[132:135], v22 offset:4096
    ds_read_b128 v[136:139], v22 offset:6144
    ds_read_b128 v[140:143], v22 offset:8192
    ds_read_b64_tr_b16 v[144:145], v24 offset:0
    ds_read_b64_tr_b16 v[146:147], v24 offset:3840
    ds_read_b64_tr_b16 v[148:149], v24 offset:32
    ds_read_b64_tr_b16 v[150:151], v24 offset:3872
    ds_read_b64_tr_b16 v[152:153], v25 offset:0
    ds_read_b64_tr_b16 v[154:155], v25 offset:3840
    ds_read_b64_tr_b16 v[156:157], v25 offset:32
    ds_read_b64_tr_b16 v[158:159], v25 offset:3872
    s_add_u32 s40, s30, s36
    s_add_u32 m0, s40, 0
    s_nop 0
    buffer_load_dwordx4 v5, s[8:11], s32 offen lds
    s_add_u32 s40, s30, s48
    s_add_u32 m0, s40, 55296
    s_nop 0
    buffer_load_dwordx4 v7, s[12:15], s33 offen lds
    s_add_u32 s40, s40, 62464
    s_add_u32 s41, s36, 8192
    s_add_u32 s42, s34, 0
    s_cmp_eq_u32 s22, 0
    s_cselect_b32 m0, s41, s40
    s_cselect_b32 s41, s42, s33
    buffer_load_dwordx4 v8, s[44:47], s41 offen lds
    s_add_u32 s33, s33, 122880
    s_sub_u32 s48, s48, 15360
    s_cselect_b32 s48, 46080, s48
    s_cmp_eq_u32 s51, 0
    s_cbranch_scc1 PL_no
    s_add_u32 m0, s60, 0
    s_nop 0
    buffer_load_dwordx4 v96, s[52:55], s70 offen lds
    s_add_u32 m0, s60, 1024
    s_nop 0
    buffer_load_dwordx4 v96, s[52:55], s71 offen lds
    s_add_u32 m0, s60, 2048
    s_nop 0
    buffer_load_dwordx4 v97, s[52:55], s72 offen lds
    s_add_u32 m0, s60, 3072
    s_nop 0
    buffer_load_dwordx4 v97, s[52:55], s73 offen lds
    s_add_u32 m0, s60, 4096
    s_nop 0
    buffer_load_dwordx4 v96, s[52:55], s74 offen lds
    s_add_u32 m0, s60, 5120
    s_nop 0
    buffer_load_dwordx4 v96, s[52:55], s75 offen lds
    s_add_u32 m0, s60, 6144
    s_nop 0
    buffer_load_dwordx4 v97, s[52:55], s62 offen lds
    s_add_u32 m0, s60, 7168
    s_nop 0
    buffer_load_dwordx4 v97, s[52:55], s63 offen lds
PL_no:
    s_sub_u32 s49, s49, 15360
    s_cselect_b32 s49, 46080, s49
    v_add_u32 v22, s37, v11
    v_add_u32 v24, s49, v15
    v_add_u32 v25, s49, v16
    s_cmp_eq_u32 s28, 0
    s_cbranch_scc1 G1QA_hz
    s_branch G1QA_ent
G1QA_loop:
    v_mfma_f32_16x16x32_bf16 v[88:91], v[188:191], v[168:171], v[88:91]
    v_mfma_f32_16x16x32_bf16 v[92:95], v[188:191], v[172:175], v[92:95]
G1QA_ent:
    s_bitcmp1_b32 s51, s35
    s_cbranch_scc1 G1QA_rw0
    s_waitcnt vmcnt(6)
G1QA_rw0:
    s_waitcnt vmcnt(14) lgkmcnt(0)
    s_barrier
    v_mfma_f32_16x16x32_bf16 v[32:35], v[144:147], v[128:131], v[32:35]
    ds_read_b128 v[160:163], v22 offset:2048
    ds_read_b128 v[164:167], v22 offset:4096
    s_add_u32 s40, s30, s36
    s_add_u32 m0, s40, 9216
    s_nop 0
    buffer_load_dwordx4 v6, s[8:11], s31 offen lds
    v_mfma_f32_16x16x32_bf16 v[36:39], v[144:147], v[132:135], v[36:39]
    ds_read_b128 v[168:171], v22 offset:6144
    ds_read_b128 v[172:175], v22 offset:8192
    s_add_u32 s40, s30, s48
    s_add_u32 m0, s40, 55296
    s_nop 0
    buffer_load_dwordx4 v7, s[12:15], s33 offen lds
    v_mfma_f32_16x16x32_bf16 v[40:43], v[144:147], v[136:139], v[40:43]
    ds_read_b64_tr_b16 v[176:177], v24 offset:0
    ds_read_b64_tr_b16 v[178:179], v24 offset:3840
    s_add_u32 s40, s40, 62464
    s_add_u32 s41, s36, 17408
    v_mfma_f32_16x16x32_bf16 v[44:47], v[144:147], v[140:143], v[44:47]
    ds_read_b64_tr_b16 v[180:181], v24 offset:32
    ds_read_b64_tr_b16 v[182:183], v24 offset:3872
    s_add_u32 s42, s34, 102400
    s_cmp_eq_u32 s22, 0
    s_cselect_b32 m0, s41, s40
    s_cselect_b32 s41, s42, s33
    v_mfma_f32_16x16x32_bf16 v[48:51], v[148:151], v[128:131], v[48:51]
    ds_read_b64_tr_b16 v[184:185], v25 offset:0
    ds_read_b64_tr_b16 v[186:187], v25 offset:3840
    buffer_load_dwordx4 v9, s[44:47], s41 offen lds
    s_add_u32 s33, s33, 122880
    v_mfma_f32_16x16x32_bf16 v[52:55], v[148:151], v[132:135], v[52:55]
    ds_read_b64_tr_b16 v[188:189], v25 offset:32
    ds_read_b64_tr_b16 v[190:191], v25 offset:3872
    s_sub_u32 s48, s48, 15360
    s_cselect_b32 s48, 46080, s48
    s_add_u32 s32, s32, 128
    v_mfma_f32_16x16x32_bf16 v[56:59], v[148:151], v[136:139], v[56:59]
    s_add_u32 s37, s37, 18432
    s_add_u32 s31, s31, 128
    s_add_u32 s34, s34, 128
    v_mfma_f32_16x16x32_bf16 v[60:63], v[148:151], v[140:143], v[60:63]
    s_cmp_eq_u32 s37, 55296
    s_cselect_b32 s37, 0, s37
    s_add_u32 s36, s36, 18432
    s_cmp_eq_u32 s36, 55296
    s_cselect_b32 s36, 0, s36
    v_mfma_f32_16x16x32_bf16 v[64:67], v[152:155], v[128:131], v[64:67]
    s_sub_u32 s49, s49, 15360
    s_cselect_b32 s49, 46080, s49
    v_mfma_f32_16x16x32_bf16 v[68:71], v[152:155], v[132:135], v[68:71]
    v_add_u32 v22, s37, v10
    v_mfma_f32_16x16x32_bf16 v[72:75], v[152:155], v[136:139], v[72:75]
    v_add_u32 v24, s49, v15
    v_mfma_f32_16x16x32_bf16 v[76:79], v[152:155], v[140:143], v[76:79]
    v_add_u32 v25, s49, v16
    v_mfma_f32_16x16x32_bf16 v[80:83], v[156:159], v[128:131], v[80:83]
    v_mfma_f32_16x16x32_bf16 v[84:87], v[156:159], v[132:135], v[84:87]
    v_mfma_f32_16x16x32_bf16 v[88:91], v[156:159], v[136:139], v[88:91]
    v_mfma_f32_16x16x32_bf16 v[92:95], v[156:159], v[140:143], v[92:95]
    s_bitcmp1_b32 s77, s35
    s_cbranch_scc1 G1QA_rw1
    s_waitcnt vmcnt(6)
G1QA_rw1:
    s_waitcnt vmcnt(14) lgkmcnt(0)
    s_barrier
    v_mfma_f32_16x16x32_bf16 v[32:35], v[176:179], v[160:163], v[32:35]
    ds_read_b128 v[128:131], v22 offset:2048
    ds_read_b128 v[132:135], v22 offset:4096
    s_add_u32 s40, s30, s36
    v_mfma_f32_16x16x32_bf16 v[36:39], v[176:179], v[164:167], v[36:39]
    ds_read_b128 v[136:139], v22 offset:6144
    ds_read_b128 v[140:143], v22 offset:8192
    s_add_u32 m0, s40, 0
    s_nop 0
    buffer_load_dwordx4 v5, s[8:11], s32 offen lds
    v_mfma_f32_16x16x32_bf16 v[40:43], v[176:179], v[168:171], v[40:43]
    ds_read_b64_tr_b16 v[144:145], v24 offset:0
    ds_read_b64_tr_b16 v[146:147], v24 offset:3840
    s_add_u32 s40, s30, s48
    v_mfma_f32_16x16x32_bf16 v[44:47], v[176:179], v[172:175], v[44:47]
    ds_read_b64_tr_b16 v[148:149], v24 offset:32
    ds_read_b64_tr_b16 v[150:151], v24 offset:3872
    s_add_u32 m0, s40, 55296
    s_nop 0
    buffer_load_dwordx4 v7, s[12:15], s33 offen lds
    v_mfma_f32_16x16x32_bf16 v[48:51], v[180:183], v[160:163], v[48:51]
    ds_read_b64_tr_b16 v[152:153], v25 offset:0
    ds_read_b64_tr_b16 v[154:155], v25 offset:3840
    s_add_u32 s40, s40, 62464
    v_mfma_f32_16x16x32_bf16 v[52:55], v[180:183], v[164:167], v[52:55]
    ds_read_b64_tr_b16 v[156:157], v25 offset:32
    ds_read_b64_tr_b16 v[158:159], v25 offset:3872
    s_add_u32 s41, s36, 8192
    v_mfma_f32_16x16x32_bf16 v[56:59], v[180:183], v[168:171], v[56:59]
    s_sub_u32 s49, s49, 15360
    s_cselect_b32 s49, 46080, s49
    s_add_u32 s42, s34, 0
    v_mfma_f32_16x16x32_bf16 v[60:63], v[180:183], v[172:175], v[60:63]
    v_add_u32 v22, s37, v11
    s_cmp_eq_u32 s22, 0
    s_cselect_b32 m0, s41, s40
    s_cselect_b32 s41, s42, s33
    v_mfma_f32_16x16x32_bf16 v[64:67], v[184:187], v[160:163], v[64:67]
    v_add_u32 v24, s49, v15
    buffer_load_dwordx4 v8, s[44:47], s41 offen lds
    v_mfma_f32_16x16x32_bf16 v[68:71], v[184:187], v[164:167], v[68:71]
    v_add_u32 v25, s49, v16
    s_add_u32 s33, s33, 122880
    v_mfma_f32_16x16x32_bf16 v[72:75], v[184:187], v[168:171], v[72:75]
    s_sub_u32 s48, s48, 15360
    s_cselect_b32 s48, 46080, s48
    v_mfma_f32_16x16x32_bf16 v[76:79], v[184:187], v[172:175], v[76:79]
    v_mfma_f32_16x16x32_bf16 v[80:83], v[188:191], v[160:163], v[80:83]
    v_mfma_f32_16x16x32_bf16 v[84:87], v[188:191], v[164:167], v[84:87]
    s_add_u32 s35, s35, 2
    s_bitcmp1_b32 s78, s35
    s_cbranch_scc0 G1QA_loop
    s_cmp_eq_u32 s35, s28
    s_cbranch_scc0 G1QA_h0
    v_mfma_f32_16x16x32_bf16 v[200:203], v[28:31], v[176:179], v[200:203]
    v_mfma_f32_16x16x32_bf16 v[204:207], v[28:31], v[180:183], v[204:207]
G1QA_hz:
    s_waitcnt lgkmcnt(0)
    s_nop 3
    v_mfma_f32_16x16x32_bf16 v[200:203], v[28:31], v[144:147], v[200:203]
    v_mfma_f32_16x16x32_bf16 v[204:207], v[28:31], v[148:151], v[204:207]
    s_and_b32 s40, s28, 6
    s_lshl_b32 s40, s40, 7
    s_and_b32 s41, s28, 8
    s_add_u32 s40, s40, s41
    s_add_u32 s40, s40, s29
    s_mov_b64 exec, 0xffff
    s_nop 6
    v_mov_b32 v201, s76
    v_cvt_pk_bf16_f32 v200, v200, v204
    buffer_store_dwordx2 v[200:201], v4, s[64:67], s40 offen sc1
    s_mov_b64 exec, -1
    s_cmp_eq_u32 s35, 0
    s_cbranch_scc1 G1QA_ent
G1QA_h0:
    s_cmp_eq_u32 s35, 4
    s_cbranch_scc0 G1QA_h2
    v_mov_b32 v239, s76
    v_mov_b32 v233, 0
    s_mov_b64 exec, 1
    buffer_store_dwordx2 v[238:239], v233, s[64:67], s68 offen sc1
    s_mov_b64 exec, -1
    s_cmp_eq_u32 s51, 0
    s_cbranch_scc1 PP_no
    v_lshrrev_b32 v208, 4, v2
    v_bfe_u32 v209, v2, 2, 2
    v_and_b32 v210, 3, v2
    v_lshlrev_b32 v210, 3, v210
    v_lshl_add_u32 v210, v208, 11, v210
    v_mul_u32_u24 v209, 288, v209
    v_add_u32 v210, v210, v209
    v_and_b32 v208, 1, v208
    v_lshl_add_u32 v210, v208, 7, v210
    v_add_u32 v208, s60, v210
    v_xor_b32 v209, 32, v208
    v_xor_b32 v210, 64, v208
    v_xor_b32 v211, 96, v208
    v_xor_b32 v212, 128, v208
    v_xor_b32 v213, 160, v208
    v_xor_b32 v214, 192, v208
    v_xor_b32 v215, 224, v208
    ds_read_b64_tr_b16 v[96:97], v208 offset:0
    ds_read_b64_tr_b16 v[98:99], v208 offset:1024
    ds_read_b64_tr_b16 v[100:101], v209 offset:0
    ds_read_b64_tr_b16 v[102:103], v209 offset:1024
    ds_read_b64_tr_b16 v[104:105], v210 offset:0
    ds_read_b64_tr_b16 v[106:107], v210 offset:1024
    ds_read_b64_tr_b16 v[108:109], v211 offset:0
    ds_read_b64_tr_b16 v[110:111], v211 offset:1024
    ds_read_b64_tr_b16 v[112:113], v212 offset:0
    ds_read_b64_tr_b16 v[114:115], v212 offset:1024
    ds_read_b64_tr_b16 v[116:117], v213 offset:0
    ds_read_b64_tr_b16 v[118:119], v213 offset:1024
    ds_read_b64_tr_b16 v[120:121], v214 offset:0
    ds_read_b64_tr_b16 v[122:123], v214 offset:1024
    ds_read_b64_tr_b16 v[124:125], v215 offset:0
    ds_read_b64_tr_b16 v[126:127], v215 offset:1024
    s_add_u32 s52, s18, 0xa00000
    s_addc_u32 s53, s19, 0
    s_and_b32 s53, s53, 0xffff
    s_mov_b32 s54, 0x2a8000
    s_mov_b32 s55, 0x00020000
    s_and_b32 s54, s54, s61
    s_add_u32 s40, s59, 0
    s_mul_i32 s40, s40, 52
    s_lshr_b32 s40, s40, 8
    s_mul_i32 s40, s40, 343040
    s_add_u32 s40, s40, s58
    s_waitcnt lgkmcnt(14)
    buffer_store_dwordx4 v[96:99], v4, s[52:55], s40 offen offset:0 sc1
    s_add_u32 s40, s59, 1
    s_mul_i32 s40, s40, 52
    s_lshr_b32 s40, s40, 8
    s_mul_i32 s40, s40, 343040
    s_add_u32 s40, s40, s58
    s_waitcnt lgkmcnt(12)
    buffer_store_dwordx4 v[100:103], v4, s[52:55], s40 offen offset:1024 sc1
    s_add_u32 s40, s59, 2
    s_mul_i32 s40, s40, 52
    s_lshr_b32 s40, s40, 8
    s_mul_i32 s40, s40, 343040
    s_add_u32 s40, s40, s58
    s_waitcnt lgkmcnt(10)
    buffer_store_dwordx4 v[104:107], v4, s[52:55], s40 offen offset:2048 sc1
    s_add_u32 s40, s59, 3
    s_mul_i32 s40, s40, 52
    s_lshr_b32 s40, s40, 8
    s_mul_i32 s40, s40, 343040
    s_add_u32 s40, s40, s58
    s_waitcnt lgkmcnt(8)
    buffer_store_dwordx4 v[108:111], v4, s[52:55], s40 offen offset:3072 sc1
    s_add_u32 s40, s59, 4
    s_mul_i32 s40, s40, 52
    s_lshr_b32 s40, s40, 8
    s_mul_i32 s40, s40, 343040
    s_add_u32 s40, s40, s58
    s_add_u32 s40, s40, 4096
    s_waitcnt lgkmcnt(6)
    buffer_store_dwordx4 v[112:115], v4, s[52:55], s40 offen offset:0 sc1
    s_add_u32 s40, s59, 5
    s_mul_i32 s40, s40, 52
    s_lshr_b32 s40, s40, 8
    s_mul_i32 s40, s40, 343040
    s_add_u32 s40, s40, s58
    s_add_u32 s40, s40, 4096
    s_waitcnt lgkmcnt(4)
    buffer_store_dwordx4 v[116:119], v4, s[52:55], s40 offen offset:1024 sc1
    s_add_u32 s40, s59, 6
    s_mul_i32 s40, s40, 52
    s_lshr_b32 s40, s40, 8
    s_mul_i32 s40, s40, 343040
    s_add_u32 s40, s40, s58
    s_add_u32 s40, s40, 4096
    s_waitcnt lgkmcnt(2)
    buffer_store_dwordx4 v[120:123], v4, s[52:55], s40 offen offset:2048 sc1
    s_add_u32 s40, s59, 7
    s_mul_i32 s40, s40, 52
    s_lshr_b32 s40, s40, 8
    s_mul_i32 s40, s40, 343040
    s_add_u32 s40, s40, s58
    s_add_u32 s40, s40, 4096
    s_waitcnt lgkmcnt(0)
    buffer_store_dwordx4 v[124:127], v4, s[52:55], s40 offen offset:3072 sc1
PP_no:
    s_branch G1QA_loop
G1QA_h2:
    s_cmp_eq_u32 s35, 8
    s_cbranch_scc0 G1QA_h3
    v_mov_b32 v233, 0
    s_mov_b64 exec, 1
    buffer_store_dword v239, v233, s[64:67], s79 offen sc1
    s_mov_b64 exec, -1
    s_branch G1QA_loop
G1QA_h3:
    s_cmp_eq_u32 s35, 14
    s_cbranch_scc1 G1QA_end
    s_cmp_eq_u32 s35, 12
    s_cbranch_scc0 G1QA_loop
    buffer_load_dwordx2 v[238:239], v237, s[64:67], 0 offen sc1
    buffer_load_dword v230, v231, s[64:67], 0 offen sc1
    s_branch G1QA_loop
G1QA_sp:
    s_sleep 2
    buffer_load_dwordx2 v[238:239], v237, s[64:67], 0 offen sc1
    buffer_load_dword v230, v231, s[64:67], 0 offen sc1
    s_waitcnt vmcnt(0)
    s_add_u32 s35, s35, 1
    s_cmp_lt_u32 s35, 0x40000
    s_cbranch_scc1 G1QA_vf
    s_branch G1QA_so
G1QA_cs:
    s_sleep 2
    buffer_load_dwordx4 v[252:255], v4, s[64:67], s29 offen sc1
    s_waitcnt vmcnt(0)
    s_add_u32 s35, s35, 1
    s_cmp_lt_u32 s35, 0x40000
    s_cbranch_scc1 G1QA_cv
    s_branch G1QA_co
G1QA_end:
    v_mfma_f32_16x16x32_bf16 v[88:91], v[188:191], v[168:171], v[88:91]
    v_mfma_f32_16x16x32_bf16 v[92:95], v[188:191], v[172:175], v[92:95]
    s_waitcnt vmcnt(6) lgkmcnt(0)
G1QA_vf:
    v_cmp_ne_u32 vcc, s76, v239
    v_cmp_ne_u32 s[40:41], s76, v230
    s_or_b64 vcc, vcc, s[40:41]
    s_cbranch_scc1 G1QA_sp
G1QA_so:
    s_barrier
    v_mfma_f32_16x16x32_bf16 v[32:35], v[144:147], v[128:131], v[32:35]
    ds_read_b128 v[160:163], v22 offset:2048
    ds_read_b128 v[164:167], v22 offset:4096
    s_add_u32 s40, s30, s36
    v_mfma_f32_16x16x32_bf16 v[36:39], v[144:147], v[132:135], v[36:39]
    ds_read_b128 v[168:171], v22 offset:6144
    ds_read_b128 v[172:175], v22 offset:8192
    s_add_u32 m0, s40, 9216
    s_nop 0
    buffer_load_dwordx4 v6, s[8:11], s31 offen lds
    v_mfma_f32_16x16x32_bf16 v[40:43], v[144:147], v[136:139], v[40:43]
    ds_read_b64_tr_b16 v[176:177], v24 offset:0
    ds_read_b64_tr_b16 v[178:179], v24 offset:3840
    v_mfma_f32_16x16x32_bf16 v[44:47], v[144:147], v[140:143], v[44:47]
    ds_read_b64_tr_b16 v[180:181], v24 offset:32
    ds_read_b64_tr_b16 v[182:183], v24 offset:3872
    s_add_u32 s40, s30, s48
    v_mfma_f32_16x16x32_bf16 v[48:51], v[148:151], v[128:131], v[48:51]
    ds_read_b64_tr_b16 v[184:185], v25 offset:0
    ds_read_b64_tr_b16 v[186:187], v25 offset:3840
    s_add_u32 m0, s40, 55296
    s_nop 0
    buffer_load_dwordx4 v7, s[12:15], s33 offen lds
    v_mfma_f32_16x16x32_bf16 v[52:55], v[148:151], v[132:135], v[52:55]
    ds_read_b64_tr_b16 v[188:189], v25 offset:32
    ds_read_b64_tr_b16 v[190:191], v25 offset:3872
    s_add_u32 s40, s40, 62464
    s_add_u32 s41, s36, 17408
    v_mfma_f32_16x16x32_bf16 v[56:59], v[148:151], v[136:139], v[56:59]
    s_add_u32 s37, s37, 18432
    s_add_u32 s42, s34, 102400
    s_cmp_eq_u32 s22, 0
    s_cselect_b32 m0, s41, s40
    s_cselect_b32 s41, s42, s33
    v_mfma_f32_16x16x32_bf16 v[60:63], v[148:151], v[140:143], v[60:63]
    s_cmp_eq_u32 s37, 55296
    s_cselect_b32 s37, 0, s37
    buffer_load_dwordx4 v9, s[44:47], s41 offen lds
    v_mfma_f32_16x16x32_bf16 v[64:67], v[152:155], v[128:131], v[64:67]
    s_sub_u32 s49, s49, 15360
    s_cselect_b32 s49, 46080, s49
    s_add_u32 s33, s33, 122880
    s_sub_u32 s48, s48, 15360
    s_cselect_b32 s48, 46080, s48
    s_add_u32 s32, s32, 128
    s_add_u32 s31, s31, 128
    s_add_u32 s34, s34, 128
    s_add_u32 s36, s36, 18432
    s_cmp_eq_u32 s36, 55296
    s_cselect_b32 s36, 0, s36
    v_mov_b32 v112, v238
    s_add_u32 s52, s18, 0xa00000
    s_addc_u32 s53, s19, 0
    s_and_b32 s53, s53, 0xffff
    s_mov_b32 s54, 0x2a8000
    s_mov_b32 s55, 0x00020000
    s_lshr_b32 s59, s2, 6
    s_cmp_eq_u32 s59, 3
    s_cselect_b32 s59, 0, s59
    s_lshl_b32 s59, s59, 10
    s_add_u32 s60, s59, 1024
    s_cmp_eq_u32 s60, 3072
    s_cselect_b32 s60, 0, s60
    s_add_u32 s61, s60, 1024
    s_cmp_eq_u32 s61, 3072
    s_cselect_b32 s61, 0, s61
    s_bfe_u32 s74, s2, 0x30003
    s_mul_i32 s74, s74, 68*5120
    s_mul_i32 s73, s22, 6*5120
    s_add_u32 s73, s73, s74
    s_add_u32 s73, s73, 20*5120
    s_mul_i32 s70, s59, 5
    s_add_u32 s70, s70, s73
    v_mfma_f32_16x16x32_bf16 v[68:71], v[152:155], v[132:135], v[68:71]
    v_add_u32 v22, s37, v10
    s_mul_i32 s71, s60, 5
    s_add_u32 s71, s71, s73
    s_mul_i32 s72, s61, 5
    s_add_u32 s72, s72, s73
    s_and_b32 s73, s22, 3
    s_mul_i32 s73, s73, 5*5120
    s_add_u32 s40, s73, s74
    s_mov_b32 s41, s70
    s_mov_b32 s75, s71
    s_mov_b32 s43, s72
    s_cmp_lt_u32 s22, 4
    s_cselect_b32 s70, s41, s40
    s_cmp_lt_u32 s22, 4
    s_cselect_b32 s71, s41, s40
    s_cselect_b32 s35, 15, 5
    s_lshl_b32 s35, s35, 10
    s_add_u32 s71, s71, s35
    s_cmp_lt_u32 s22, 4
    s_cselect_b32 s72, s75, s40
    s_cselect_b32 s35, 0, 10240
    s_add_u32 s72, s72, s35
    s_cmp_lt_u32 s22, 4
    s_cselect_b32 s73, s75, s41
    s_cselect_b32 s35, 15360, 0
    s_add_u32 s73, s73, s35
    s_cmp_lt_u32 s22, 4
    s_cselect_b32 s74, s43, s41
    s_cselect_b32 s35, 0, 15360
    s_add_u32 s74, s74, s35
    s_cmp_lt_u32 s22, 4
    s_cselect_b32 s80, s43, s75
    s_cselect_b32 s35, 15360, 0
    s_add_u32 s80, s80, s35
    s_cmp_lt_u32 s22, 4
    s_cselect_b32 s81, s40, s75
    s_add_u32 s81, s81, 15360
    s_cmp_lt_u32 s22, 4
    s_cselect_b32 s82, s40, s43
    s_cselect_b32 s35, 20480, 0
    s_add_u32 s82, s82, s35
    s_add_u32 s83, s43, 15360
    v_mfma_f32_16x16x32_bf16 v[72:75], v[152:155], v[136:139], v[72:75]
    v_add_u32 v24, s49, v15
    s_add_u32 m0, s30, 155648
    s_add_u32 s40, s73, 4096
    buffer_load_dwordx4 v4, s[52:55], s40 offen lds
    v_mfma_f32_16x16x32_bf16 v[76:79], v[152:155], v[140:143], v[76:79]
    v_add_u32 v25, s49, v16
    v_mfma_f32_16x16x32_bf16 v[80:83], v[156:159], v[128:131], v[80:83]
    v_mfma_f32_16x16x32_bf16 v[84:87], v[156:159], v[132:135], v[84:87]
    s_add_u32 m0, s30, 147456
    s_add_u32 s40, s73, 3072
    buffer_load_dwordx4 v4, s[52:55], s40 offen lds
    v_mfma_f32_16x16x32_bf16 v[88:91], v[156:159], v[136:139], v[88:91]
    v_mfma_f32_16x16x32_bf16 v[92:95], v[156:159], v[140:143], v[92:95]
    s_waitcnt vmcnt(8) lgkmcnt(0)
    s_barrier
    v_mfma_f32_16x16x32_bf16 v[32:35], v[176:179], v[160:163], v[32:35]
    ds_read_b128 v[128:131], v22 offset:2048
    s_add_u32 s40, s30, s48
    v_mfma_f32_16x16x32_bf16 v[36:39], v[176:179], v[164:167], v[36:39]
    ds_read_b128 v[132:135], v22 offset:4096
    s_add_u32 m0, s40, 55296
    s_nop 0
    buffer_load_dwordx4 v7, s[12:15], s33 offen lds
    v_mfma_f32_16x16x32_bf16 v[40:43], v[176:179], v[168:171], v[40:43]
    ds_read_b128 v[136:139], v22 offset:6144
    s_add_u32 s40, s40, 62464
    s_add_u32 s41, s36, 8192
    v_mfma_f32_16x16x32_bf16 v[44:47], v[176:179], v[172:175], v[44:47]
    ds_read_b128 v[140:143], v22 offset:8192
    s_add_u32 s42, s34, 0
    s_cmp_eq_u32 s22, 0
    s_cselect_b32 m0, s41, s40
    s_cselect_b32 s41, s42, s33
    v_mfma_f32_16x16x32_bf16 v[48:51], v[180:183], v[160:163], v[48:51]
    ds_read_b64_tr_b16 v[144:145], v24 offset:0
    buffer_load_dwordx4 v8, s[44:47], s41 offen lds
    v_mfma_f32_16x16x32_bf16 v[200:203], v[176:179], v[28:31], 0
    ds_read_b64_tr_b16 v[146:147], v24 offset:3840
    v_mfma_f32_16x16x32_bf16 v[52:55], v[180:183], v[164:167], v[52:55]
    ds_read_b64_tr_b16 v[148:149], v24 offset:32
    v_mfma_f32_16x16x32_bf16 v[56:59], v[180:183], v[168:171], v[56:59]
    ds_read_b64_tr_b16 v[150:151], v24 offset:3872
    s_add_u32 m0, s30, 139264
    s_add_u32 s40, s73, 2048
    buffer_load_dwordx4 v4, s[52:55], s40 offen lds
    v_mfma_f32_16x16x32_bf16 v[60:63], v[180:183], v[172:175], v[60:63]
    ds_read_b64_tr_b16 v[152:153], v25 offset:0
    v_mfma_f32_16x16x32_bf16 v[64:67], v[184:187], v[160:163], v[64:67]
    ds_read_b64_tr_b16 v[154:155], v25 offset:3840
    s_add_u32 m0, s30, 131072
    s_add_u32 s40, s73, 1024
    buffer_load_dwordx4 v4, s[52:55], s40 offen lds
    v_mfma_f32_16x16x32_bf16 v[68:71], v[184:187], v[164:167], v[68:71]
    ds_read_b64_tr_b16 v[156:157], v25 offset:32
    v_mfma_f32_16x16x32_bf16 v[204:207], v[180:183], v[28:31], 0
    ds_read_b64_tr_b16 v[158:159], v25 offset:3872
    v_mfma_f32_16x16x32_bf16 v[72:75], v[184:187], v[168:171], v[72:75]
    s_sub_u32 s49, s49, 15360
    s_cselect_b32 s49, 46080, s49
    s_add_u32 m0, s30, 122880
    s_add_u32 s40, s73, 0
    buffer_load_dwordx4 v4, s[52:55], s40 offen lds
    v_mfma_f32_16x16x32_bf16 v[76:79], v[184:187], v[172:175], v[76:79]
    v_add_u32 v22, s37, v11
    v_mfma_f32_16x16x32_bf16 v[80:83], v[188:191], v[160:163], v[80:83]
    v_add_u32 v24, s49, v15
    v_mfma_f32_16x16x32_bf16 v[84:87], v[188:191], v[164:167], v[84:87]
    v_add_u32 v25, s49, v16
    s_add_u32 s40, s70, 4096
    buffer_load_dwordx4 v[208:211], v4, s[52:55], s40 offen
    v_mfma_f32_16x16x32_bf16 v[88:91], v[188:191], v[168:171], v[88:91]
    v_mfma_f32_16x16x32_bf16 v[92:95], v[188:191], v[172:175], v[92:95]
    s_waitcnt vmcnt(11) lgkmcnt(0)
    s_barrier
    v_mfma_f32_16x16x32_bf16 v[32:35], v[144:147], v[128:131], v[32:35]
    ds_read_b128 v[160:163], v22 offset:2048
    v_mfma_f32_16x16x32_bf16 v[36:39], v[144:147], v[132:135], v[36:39]
    ds_read_b128 v[164:167], v22 offset:4096
    buffer_load_dwordx4 v[252:255], v4, s[64:67], s29 offen sc1
    v_mfma_f32_16x16x32_bf16 v[40:43], v[144:147], v[136:139], v[40:43]
    ds_read_b128 v[168:171], v22 offset:6144
    s_add_u32 s8, s18, 0xd00000
    s_addc_u32 s9, s19, 0
    s_and_b32 s9, s9, 0xffff
    s_mov_b32 s10, 0x880000
    s_mov_b32 s11, 0x00020000
    v_mfma_f32_16x16x32_bf16 v[44:47], v[144:147], v[140:143], v[44:47]
    ds_read_b128 v[172:175], v22 offset:8192
    v_and_b32 v13, 15, v2
    v_lshrrev_b32 v14, 4, v2
    v_lshlrev_b32 v17, 2, v14
    v_sub_u32 v18, v13, v17
    v_mfma_f32_16x16x32_bf16 v[48:51], v[148:151], v[128:131], v[48:51]
    ds_read_b64_tr_b16 v[176:177], v24 offset:0
    s_add_u32 m0, s30, 114688
    s_add_u32 s40, s74, 4096
    buffer_load_dwordx4 v4, s[52:55], s40 offen lds
    v_mfma_f32_16x16x32_bf16 v[200:203], v[144:147], v[28:31], v[200:203]
    ds_read_b64_tr_b16 v[178:179], v24 offset:3840
    s_mov_b32 s24, 0xf0000000
    v_mov_b32 v114, v18
    v_add_u32 v118, 8, v18
    v_subrev_u32 v115, 1, v18
    v_mfma_f32_16x16x32_bf16 v[52:55], v[148:151], v[132:135], v[52:55]
    ds_read_b64_tr_b16 v[180:181], v24 offset:32
    v_add_u32 v119, 7, v18
    v_subrev_u32 v116, 2, v18
    v_add_u32 v120, 6, v18
    v_subrev_u32 v117, 3, v18
    v_mfma_f32_16x16x32_bf16 v[56:59], v[148:151], v[136:139], v[56:59]
    ds_read_b64_tr_b16 v[182:183], v24 offset:3872
    s_add_u32 m0, s30, 106496
    s_add_u32 s40, s74, 3072
    buffer_load_dwordx4 v4, s[52:55], s40 offen lds
    v_mfma_f32_16x16x32_bf16 v[60:63], v[148:151], v[140:143], v[60:63]
    ds_read_b64_tr_b16 v[184:185], v25 offset:0
    v_add_u32 v121, 5, v18
    v_lshrrev_b32 v114, 3, v114
    v_ashrrev_i32 v118, 31, v118
    v_lshrrev_b32 v115, 3, v115
    v_ashrrev_i32 v119, 31, v119
    v_lshrrev_b32 v116, 3, v116
    v_ashrrev_i32 v120, 31, v120
    v_lshrrev_b32 v117, 3, v117
    v_mfma_f32_16x16x32_bf16 v[64:67], v[152:155], v[128:131], v[64:67]
    ds_read_b64_tr_b16 v[186:187], v25 offset:3840
    buffer_load_dwordx4 v[212:215], v4, s[52:55], s71 offen offset:0
    v_mfma_f32_16x16x32_bf16 v[68:71], v[152:155], v[132:135], v[68:71]
    ds_read_b64_tr_b16 v[188:189], v25 offset:32
    v_ashrrev_i32 v121, 31, v121
    v_min_u32 v114, 1, v114
    v_bfi_b32 v118, v118, 0, s24
    v_min_u32 v115, 1, v115
    v_mfma_f32_16x16x32_bf16 v[204:207], v[148:151], v[28:31], v[204:207]
    ds_read_b64_tr_b16 v[190:191], v25 offset:3872
    v_bfi_b32 v119, v119, 0, s24
    v_min_u32 v116, 1, v116
    v_bfi_b32 v120, v120, 0, s24
    v_min_u32 v117, 1, v117
    v_mfma_f32_16x16x32_bf16 v[72:75], v[152:155], v[136:139], v[72:75]
    s_add_u32 s37, s37, 18432
    s_cmp_eq_u32 s37, 55296
    s_cselect_b32 s37, 0, s37
    buffer_load_dwordx4 v[216:219], v4, s[52:55], s71 offen offset:1024
    v_mfma_f32_16x16x32_bf16 v[76:79], v[152:155], v[140:143], v[76:79]
    s_sub_u32 s49, s49, 15360
    s_cselect_b32 s49, 46080, s49
    v_add_u32 v22, s37, v10
    v_bfi_b32 v121, v121, 0, s24
    v_mul_lo_u32 v114, v114, s24
    v_mul_lo_u32 v115, v115, s24
    v_mul_lo_u32 v116, v116, s24
    v_mfma_f32_16x16x32_bf16 v[80:83], v[156:159], v[128:131], v[80:83]
    v_add_u32 v24, s49, v15
    v_add_u32 v25, s49, v16
    v_mul_lo_u32 v117, v117, s24
    s_bfe_u32 s62, s22, 0x10001
    s_or_b32 s63, s62, s21
    s_cselect_b32 s25, 0, s24
    v_or_b32 v122, s25, v118
    v_mfma_f32_16x16x32_bf16 v[84:87], v[156:159], v[132:135], v[84:87]
    buffer_load_dwordx4 v[220:223], v4, s[52:55], s71 offen offset:2048
    v_mfma_f32_16x16x32_bf16 v[88:91], v[156:159], v[136:139], v[88:91]
    v_mfma_f32_16x16x32_bf16 v[92:95], v[156:159], v[140:143], v[92:95]
    s_waitcnt vmcnt(14) lgkmcnt(0)
    s_barrier
    v_mfma_f32_16x16x32_bf16 v[32:35], v[176:179], v[160:163], v[32:35]
    ds_read_b128 v[128:131], v22 offset:2048
    v_or_b32 v123, s25, v119
    v_or_b32 v124, s25, v120
    v_or_b32 v125, s25, v121
    v_cvt_pk_bf16_f32 v126, v118, v119
    v_mfma_f32_16x16x32_bf16 v[36:39], v[176:179], v[164:167], v[36:39]
    ds_read_b128 v[132:135], v22 offset:4096
    v_cvt_pk_bf16_f32 v127, v120, v121
    v_pk_ashrrev_i16 v126, 15, v126 op_sel_hi:[0,1]
    v_pk_ashrrev_i16 v127, 15, v127 op_sel_hi:[0,1]
    v_add_u32 v5, 16, v2
    v_mfma_f32_16x16x32_bf16 v[40:43], v[176:179], v[168:171], v[40:43]
    ds_read_b128 v[136:139], v22 offset:6144
    s_add_u32 m0, s30, 98304
    s_add_u32 s40, s74, 2048
    buffer_load_dwordx4 v4, s[52:55], s40 offen lds
    v_mfma_f32_16x16x32_bf16 v[44:47], v[176:179], v[172:175], v[44:47]
    ds_read_b128 v[140:143], v22 offset:8192
    v_bfe_i32 v5, v5, 6, 1
    s_and_b32 s78, s22, 1
    s_lshl_b32 s63, s62, 2
    s_add_u32 s63, s63, s78
    v_mfma_f32_16x16x32_bf16 v[48:51], v[180:183], v[160:163], v[48:51]
    ds_read_b64_tr_b16 v[144:145], v24 offset:0
    s_mul_i32 s63, s63, 7808
    s_lshr_b32 s77, s22, 2
    s_mul_i32 s26, s77, 10240
    s_mul_i32 s77, s77, 80
    s_add_u32 s63, s63, s77
    v_mfma_f32_16x16x32_bf16 v[200:203], v[176:179], v[28:31], v[200:203]
    ds_read_b64_tr_b16 v[146:147], v24 offset:3840
    buffer_load_dwordx4 v[224:227], v4, s[52:55], s71 offen offset:3072
    v_mfma_f32_16x16x32_bf16 v[52:55], v[180:183], v[164:167], v[52:55]
    ds_read_b64_tr_b16 v[148:149], v24 offset:32
    s_mul_i32 s77, s78, 3904
    s_sub_u32 s77, 58560, s77
    s_cmp_eq_u32 s62, 0
    s_cselect_b32 s77, s77, 0xffffc300
    v_mul_u32_u24 v6, 488, v13
    v_mfma_f32_16x16x32_bf16 v[56:59], v[180:183], v[168:171], v[56:59]
    ds_read_b64_tr_b16 v[150:151], v24 offset:3872
    v_lshl_add_u32 v6, v14, 3, v6
    v_add_u32 v6, s63, v6
    v_add_u32 v7, s77, v6
    v_lshrrev_b32 v18, 2, v2
    v_mul_u32_u24 v18, 488, v18
    v_mfma_f32_16x16x32_bf16 v[60:63], v[180:183], v[172:175], v[60:63]
    ds_read_b64_tr_b16 v[152:153], v25 offset:0
    s_add_u32 s40, s71, 4096
    buffer_load_dwordx4 v[228:231], v4, s[52:55], s40 offen
    v_mfma_f32_16x16x32_bf16 v[64:67], v[184:187], v[160:163], v[64:67]
    ds_read_b64_tr_b16 v[154:155], v25 offset:3840
    v_add_u32 v26, s63, v18
    v_add_u32 v27, s77, v26
    v_and_b32 v18, 3, v2
    v_lshl_add_u32 v8, v18, 3, v26
    v_mfma_f32_16x16x32_bf16 v[68:71], v[184:187], v[164:167], v[68:71]
    ds_read_b64_tr_b16 v[156:157], v25 offset:32
    v_add_u32 v9, s77, v8
    s_lshl_b32 s63, s21, 3
    s_lshl_b32 s62, s62, 2
    s_add_u32 s63, s63, s62
    s_add_u32 s63, s63, s78
    v_mfma_f32_16x16x32_bf16 v[204:207], v[180:183], v[28:31], v[204:207]
    ds_read_b64_tr_b16 v[158:159], v25 offset:3872
    buffer_load_dwordx4 v[232:235], v4, s[52:55], s72 offen offset:0
    v_mfma_f32_16x16x32_bf16 v[72:75], v[184:187], v[168:171], v[72:75]
    s_sub_u32 s49, s49, 15360
    s_cselect_b32 s49, 46080, s49
    s_mul_i32 s63, s63, 69632
    s_add_u32 s26, s26, s63
    s_mul_i32 s63, s3, 1280
    s_add_u32 s26, s26, s63
    v_mfma_f32_16x16x32_bf16 v[76:79], v[184:187], v[172:175], v[76:79]
    v_add_u32 v22, s37, v11
    s_add_u32 s27, s26, 2*69632
    v_mul_u32_u24 v23, 139264, v14
    v_lshl_add_u32 v23, v13, 4, v23
    s_mov_b32 s24, 0x3ea52b5c
    s_mov_b32 s25, 0x3ea52b5c
    v_mfma_f32_16x16x32_bf16 v[80:83], v[188:191], v[160:163], v[80:83]
    v_add_u32 v24, s49, v15
    buffer_load_dwordx4 v[236:239], v4, s[52:55], s72 offen offset:1024
    v_mfma_f32_16x16x32_bf16 v[84:87], v[188:191], v[164:167], v[84:87]
    v_add_u32 v25, s49, v16
    v_mfma_f32_16x16x32_bf16 v[88:91], v[188:191], v[168:171], v[88:91]
    v_mfma_f32_16x16x32_bf16 v[92:95], v[188:191], v[172:175], v[92:95]
    s_waitcnt vmcnt(10) lgkmcnt(0)
    s_barrier
    v_mfma_f32_16x16x32_bf16 v[32:35], v[144:147], v[128:131], v[32:35]
    ds_read_b128 v[160:163], v22 offset:2048
    v_lshrrev_b32 v10, 4, v2
    v_mfma_f32_16x16x32_bf16 v[36:39], v[144:147], v[132:135], v[36:39]
    ds_read_b128 v[164:167], v22 offset:4096
    v_lshlrev_b32 v12, 4, v10
    v_add_u32 v18, 70656, v12
    v_mfma_f32_16x16x32_bf16 v[40:43], v[144:147], v[136:139], v[40:43]
G1QA_cv:
    v_cmp_ne_u32 vcc, s76, v253
    v_cmp_ne_u32 s[40:41], s76, v255
    s_or_b64 vcc, vcc, s[40:41]
    s_cbranch_scc1 G1QA_cs
G1QA_co:
    v_and_b32 v255, s50, v252
    v_lshlrev_b32 v253, 16, v254
    ds_read_b128 v[168:171], v22 offset:6144
    v_lshl_add_u32 v18, v1, 7, v18
    v_xor_b32 v17, 512, v18
    v_mfma_f32_16x16x32_bf16 v[44:47], v[144:147], v[140:143], v[44:47]
    v_lshlrev_b32 v252, 16, v252
    v_and_b32 v254, s50, v254
    ds_read_b128 v[172:175], v22 offset:8192
    buffer_load_dwordx4 v[240:243], v4, s[52:55], s72 offen offset:2048
    v_mfma_f32_16x16x32_bf16 v[48:51], v[148:151], v[128:131], v[48:51]
    ds_read_b64_tr_b16 v[176:177], v24 offset:0
    v_mfma_f32_16x16x32_bf16 v[200:203], v[144:147], v[28:31], v[200:203]
    ds_read_b64_tr_b16 v[178:179], v24 offset:3840
    v_and_b32 v11, 15, v2
    v_mfma_f32_16x16x32_bf16 v[52:55], v[148:151], v[132:135], v[52:55]
    ds_read_b64_tr_b16 v[180:181], v24 offset:32
    v_lshlrev_b32 v19, 2, v11
    v_lshrrev_b32 v13, 2, v1
    v_mfma_f32_16x16x32_bf16 v[56:59], v[148:151], v[136:139], v[56:59]
    ds_read_b64_tr_b16 v[182:183], v24 offset:3872
    v_lshl_add_u32 v11, v13, 6, v11
    v_and_b32 v13, 3, v1
    v_mfma_f32_16x16x32_bf16 v[60:63], v[148:151], v[140:143], v[60:63]
    v_mfma_f32_16x16x16_bf16 v[200:203], v[252:253], v[28:29], v[200:203]
    ds_read_b64_tr_b16 v[184:185], v25 offset:0
    buffer_load_dwordx4 v[244:247], v4, s[52:55], s72 offen offset:3072
    v_mfma_f32_16x16x32_bf16 v[64:67], v[152:155], v[128:131], v[64:67]
    ds_read_b64_tr_b16 v[186:187], v25 offset:3840
    v_mul_u32_u24 v14, 488, v11
    v_mfma_f32_16x16x32_bf16 v[68:71], v[152:155], v[132:135], v[68:71]
    ds_read_b64_tr_b16 v[188:189], v25 offset:32
    v_lshl_add_u32 v14, v10, 3, v14
    v_mfma_f32_16x16x32_bf16 v[204:207], v[148:151], v[28:31], v[204:207]
    ds_read_b64_tr_b16 v[190:191], v25 offset:3872
    v_lshl_add_u32 v14, v13, 7, v14
    v_mfma_f32_16x16x32_bf16 v[72:75], v[152:155], v[136:139], v[72:75]
    v_add_u32 v20, s56, v14
    v_mfma_f32_16x16x32_bf16 v[76:79], v[152:155], v[140:143], v[76:79]
    v_add_u32 v21, s57, v14
    v_mfma_f32_16x16x32_bf16 v[80:83], v[156:159], v[128:131], v[80:83]
    v_mfma_f32_16x16x16_bf16 v[204:207], v[254:255], v[28:29], v[204:207]
    s_add_u32 s40, s72, 4096
    buffer_load_dwordx4 v[248:251], v4, s[52:55], s40 offen
    v_mfma_f32_16x16x32_bf16 v[84:87], v[156:159], v[132:135], v[84:87]
    v_mfma_f32_16x16x32_bf16 v[88:91], v[156:159], v[136:139], v[88:91]
    v_mfma_f32_16x16x32_bf16 v[92:95], v[156:159], v[140:143], v[92:95]
    s_waitcnt lgkmcnt(0)
    s_setprio 3
    s_barrier
    v_mfma_f32_16x16x32_bf16 v[200:203], v[176:179], v[28:31], v[200:203]
    v_mfma_f32_16x16x32_bf16 v[204:207], v[180:183], v[28:31], v[204:207]
    v_mfma_f32_16x16x32_bf16 v[32:35], v[176:179], v[160:163], v[32:35]
    ds_bpermute_b32 v129, v19, v112 offset:0
    ds_bpermute_b32 v133, v19, v112 offset:64
    v_mfma_f32_16x16x32_bf16 v[36:39], v[176:179], v[164:167], v[36:39]
    ds_bpermute_b32 v137, v19, v112 offset:128
    ds_bpermute_b32 v141, v19, v112 offset:192
    v_mfma_f32_16x16x32_bf16 v[40:43], v[176:179], v[168:171], v[40:43]
    s_add_u32 m0, s30, 90112
    s_add_u32 s40, s74, 1024
    buffer_load_dwordx4 v4, s[52:55], s40 offen lds
    s_add_u32 m0, s30, 81920
    s_add_u32 s40, s74, 0
    buffer_load_dwordx4 v4, s[52:55], s40 offen lds
    v_mfma_f32_16x16x32_bf16 v[44:47], v[176:179], v[172:175], v[44:47]
    s_add_u32 m0, s30, 73728
    s_add_u32 s40, s80, 4096
    buffer_load_dwordx4 v4, s[52:55], s40 offen lds
    s_mov_b32 exec_lo, 0x00010001
    s_mov_b32 exec_hi, 0x00010001
    ds_write_b128 v17, v[200:203] offset:0
    ds_write_b128 v17, v[204:207] offset:64
    s_mov_b64 exec, -1
    v_mfma_f32_16x16x32_bf16 v[48:51], v[180:183], v[160:163], v[48:51]
    v_mfma_f32_16x16x32_bf16 v[52:55], v[180:183], v[164:167], v[52:55]
    v_mfma_f32_16x16x32_bf16 v[56:59], v[180:183], v[168:171], v[56:59]
    s_waitcnt lgkmcnt(0)
    s_barrier
    v_mfma_f32_16x16x32_bf16 v[60:63], v[180:183], v[172:175], v[60:63]
    ds_read_b128 v[148:151], v18 offset:0
    ds_read_b128 v[152:155], v18 offset:64
    v_mfma_f32_16x16x32_bf16 v[64:67], v[184:187], v[160:163], v[64:67]
    v_lshlrev_b32 v128, 16, v129
    v_and_b32 v130, s50, v129
    v_mfma_f32_16x16x32_bf16 v[68:71], v[184:187], v[164:167], v[68:71]
    v_rcp_f32 v130, v130
    v_lshlrev_b32 v132, 16, v133
    v_mfma_f32_16x16x32_bf16 v[72:75], v[184:187], v[168:171], v[72:75]
    v_and_b32 v134, s50, v133
    v_rcp_f32 v134, v134
    v_mfma_f32_16x16x32_bf16 v[76:79], v[184:187], v[172:175], v[76:79]
    v_lshlrev_b32 v136, 16, v137
    v_and_b32 v138, s50, v137
    v_mfma_f32_16x16x32_bf16 v[80:83], v[188:191], v[160:163], v[80:83]
    v_rcp_f32 v138, v138
    v_lshlrev_b32 v140, 16, v141
    v_mfma_f32_16x16x32_bf16 v[84:87], v[188:191], v[164:167], v[84:87]
    v_and_b32 v142, s50, v141
    v_rcp_f32 v142, v142
    v_mfma_f32_16x16x32_bf16 v[88:91], v[188:191], v[168:171], v[88:91]
    v_mfma_f32_16x16x32_bf16 v[92:95], v[188:191], v[172:175], v[92:95]
    s_waitcnt lgkmcnt(0)
    v_pk_fma_f32 v[32:33], v[200:201], v[128:129], v[32:33] op_sel:[0,0,0] op_sel_hi:[1,0,1] neg_lo:[0,1,0] neg_hi:[0,1,0]
    v_pk_fma_f32 v[34:35], v[202:203], v[128:129], v[34:35] op_sel:[0,0,0] op_sel_hi:[1,0,1] neg_lo:[0,1,0] neg_hi:[0,1,0]
    v_pk_mul_f32 v[32:33], v[32:33], v[130:131] op_sel:[0,0] op_sel_hi:[1,0]
    v_pk_mul_f32 v[34:35], v[34:35], v[130:131] op_sel:[0,0] op_sel_hi:[1,0]
    v_cvt_pk_bf16_f32 v32, v32, v33
    v_cvt_pk_bf16_f32 v33, v34, v35
    ds_write_b64 v20, v[32:33] offset:0
    v_pk_fma_f32 v[36:37], v[200:201], v[132:133], v[36:37] op_sel:[0,0,0] op_sel_hi:[1,0,1] neg_lo:[0,1,0] neg_hi:[0,1,0]
    v_pk_fma_f32 v[38:39], v[202:203], v[132:133], v[38:39] op_sel:[0,0,0] op_sel_hi:[1,0,1] neg_lo:[0,1,0] neg_hi:[0,1,0]
    v_pk_mul_f32 v[36:37], v[36:37], v[134:135] op_sel:[0,0] op_sel_hi:[1,0]
    v_pk_mul_f32 v[38:39], v[38:39], v[134:135] op_sel:[0,0] op_sel_hi:[1,0]
    v_cvt_pk_bf16_f32 v36, v36, v37
    v_cvt_pk_bf16_f32 v37, v38, v39
    ds_write_b64 v20, v[36:37] offset:7808
    v_pk_fma_f32 v[40:41], v[200:201], v[136:137], v[40:41] op_sel:[0,0,0] op_sel_hi:[1,0,1] neg_lo:[0,1,0] neg_hi:[0,1,0]
    v_pk_fma_f32 v[42:43], v[202:203], v[136:137], v[42:43] op_sel:[0,0,0] op_sel_hi:[1,0,1] neg_lo:[0,1,0] neg_hi:[0,1,0]
    v_pk_mul_f32 v[40:41], v[40:41], v[138:139] op_sel:[0,0] op_sel_hi:[1,0]
    v_pk_mul_f32 v[42:43], v[42:43], v[138:139] op_sel:[0,0] op_sel_hi:[1,0]
    v_cvt_pk_bf16_f32 v40, v40, v41
    v_cvt_pk_bf16_f32 v41, v42, v43
    ds_write_b64 v20, v[40:41] offset:15616
    v_pk_fma_f32 v[44:45], v[200:201], v[140:141], v[44:45] op_sel:[0,0,0] op_sel_hi:[1,0,1] neg_lo:[0,1,0] neg_hi:[0,1,0]
    v_pk_fma_f32 v[46:47], v[202:203], v[140:141], v[46:47] op_sel:[0,0,0] op_sel_hi:[1,0,1] neg_lo:[0,1,0] neg_hi:[0,1,0]
    v_pk_mul_f32 v[44:45], v[44:45], v[142:143] op_sel:[0,0] op_sel_hi:[1,0]
    v_pk_mul_f32 v[46:47], v[46:47], v[142:143] op_sel:[0,0] op_sel_hi:[1,0]
    v_cvt_pk_bf16_f32 v44, v44, v45
    v_cvt_pk_bf16_f32 v45, v46, v47
    ds_write_b64 v20, v[44:45] offset:23424
    buffer_load_dwordx4 v[192:195], v4, s[52:55], s70 offen offset:0
    v_pk_fma_f32 v[48:49], v[204:205], v[128:129], v[48:49] op_sel:[0,0,0] op_sel_hi:[1,0,1] neg_lo:[0,1,0] neg_hi:[0,1,0]
    v_pk_fma_f32 v[50:51], v[206:207], v[128:129], v[50:51] op_sel:[0,0,0] op_sel_hi:[1,0,1] neg_lo:[0,1,0] neg_hi:[0,1,0]
    v_pk_mul_f32 v[48:49], v[48:49], v[130:131] op_sel:[0,0] op_sel_hi:[1,0]
    v_pk_mul_f32 v[50:51], v[50:51], v[130:131] op_sel:[0,0] op_sel_hi:[1,0]
    v_cvt_pk_bf16_f32 v48, v48, v49
    v_cvt_pk_bf16_f32 v49, v50, v51
    ds_write_b64 v20, v[48:49] offset:32
    v_pk_fma_f32 v[52:53], v[204:205], v[132:133], v[52:53] op_sel:[0,0,0] op_sel_hi:[1,0,1] neg_lo:[0,1,0] neg_hi:[0,1,0]
    v_pk_fma_f32 v[54:55], v[206:207], v[132:133], v[54:55] op_sel:[0,0,0] op_sel_hi:[1,0,1] neg_lo:[0,1,0] neg_hi:[0,1,0]
    v_pk_mul_f32 v[52:53], v[52:53], v[134:135] op_sel:[0,0] op_sel_hi:[1,0]
    v_pk_mul_f32 v[54:55], v[54:55], v[134:135] op_sel:[0,0] op_sel_hi:[1,0]
    v_cvt_pk_bf16_f32 v52, v52, v53
    v_cvt_pk_bf16_f32 v53, v54, v55
    ds_write_b64 v20, v[52:53] offset:7840
    v_pk_fma_f32 v[56:57], v[204:205], v[136:137], v[56:57] op_sel:[0,0,0] op_sel_hi:[1,0,1] neg_lo:[0,1,0] neg_hi:[0,1,0]
    v_pk_fma_f32 v[58:59], v[206:207], v[136:137], v[58:59] op_sel:[0,0,0] op_sel_hi:[1,0,1] neg_lo:[0,1,0] neg_hi:[0,1,0]
    v_pk_mul_f32 v[56:57], v[56:57], v[138:139] op_sel:[0,0] op_sel_hi:[1,0]
    v_pk_mul_f32 v[58:59], v[58:59], v[138:139] op_sel:[0,0] op_sel_hi:[1,0]
    v_cvt_pk_bf16_f32 v56, v56, v57
    v_cvt_pk_bf16_f32 v57, v58, v59
    ds_write_b64 v20, v[56:57] offset:15648
    v_pk_fma_f32 v[60:61], v[204:205], v[140:141], v[60:61] op_sel:[0,0,0] op_sel_hi:[1,0,1] neg_lo:[0,1,0] neg_hi:[0,1,0]
    v_pk_fma_f32 v[62:63], v[206:207], v[140:141], v[62:63] op_sel:[0,0,0] op_sel_hi:[1,0,1] neg_lo:[0,1,0] neg_hi:[0,1,0]
    v_pk_mul_f32 v[60:61], v[60:61], v[142:143] op_sel:[0,0] op_sel_hi:[1,0]
    v_pk_mul_f32 v[62:63], v[62:63], v[142:143] op_sel:[0,0] op_sel_hi:[1,0]
    v_cvt_pk_bf16_f32 v60, v60, v61
    v_cvt_pk_bf16_f32 v61, v62, v63
    ds_write_b64 v20, v[60:61] offset:23456
    buffer_load_dwordx4 v[196:199], v4, s[52:55], s70 offen offset:1024
    v_pk_fma_f32 v[64:65], v[148:149], v[128:129], v[64:65] op_sel:[0,0,0] op_sel_hi:[1,0,1] neg_lo:[0,1,0] neg_hi:[0,1,0]
    v_pk_fma_f32 v[66:67], v[150:151], v[128:129], v[66:67] op_sel:[0,0,0] op_sel_hi:[1,0,1] neg_lo:[0,1,0] neg_hi:[0,1,0]
    v_pk_mul_f32 v[64:65], v[64:65], v[130:131] op_sel:[0,0] op_sel_hi:[1,0]
    v_pk_mul_f32 v[66:67], v[66:67], v[130:131] op_sel:[0,0] op_sel_hi:[1,0]
    v_cvt_pk_bf16_f32 v64, v64, v65
    v_cvt_pk_bf16_f32 v65, v66, v67
    ds_write_b64 v21, v[64:65] offset:0
    v_pk_fma_f32 v[68:69], v[148:149], v[132:133], v[68:69] op_sel:[0,0,0] op_sel_hi:[1,0,1] neg_lo:[0,1,0] neg_hi:[0,1,0]
    v_pk_fma_f32 v[70:71], v[150:151], v[132:133], v[70:71] op_sel:[0,0,0] op_sel_hi:[1,0,1] neg_lo:[0,1,0] neg_hi:[0,1,0]
    v_pk_mul_f32 v[68:69], v[68:69], v[134:135] op_sel:[0,0] op_sel_hi:[1,0]
    v_pk_mul_f32 v[70:71], v[70:71], v[134:135] op_sel:[0,0] op_sel_hi:[1,0]
    v_cvt_pk_bf16_f32 v68, v68, v69
    v_cvt_pk_bf16_f32 v69, v70, v71
    ds_write_b64 v21, v[68:69] offset:7808
    v_pk_fma_f32 v[72:73], v[148:149], v[136:137], v[72:73] op_sel:[0,0,0] op_sel_hi:[1,0,1] neg_lo:[0,1,0] neg_hi:[0,1,0]
    v_pk_fma_f32 v[74:75], v[150:151], v[136:137], v[74:75] op_sel:[0,0,0] op_sel_hi:[1,0,1] neg_lo:[0,1,0] neg_hi:[0,1,0]
    v_pk_mul_f32 v[72:73], v[72:73], v[138:139] op_sel:[0,0] op_sel_hi:[1,0]
    v_pk_mul_f32 v[74:75], v[74:75], v[138:139] op_sel:[0,0] op_sel_hi:[1,0]
    v_cvt_pk_bf16_f32 v72, v72, v73
    v_cvt_pk_bf16_f32 v73, v74, v75
    ds_write_b64 v21, v[72:73] offset:15616
    v_pk_fma_f32 v[76:77], v[148:149], v[140:141], v[76:77] op_sel:[0,0,0] op_sel_hi:[1,0,1] neg_lo:[0,1,0] neg_hi:[0,1,0]
    v_pk_fma_f32 v[78:79], v[150:151], v[140:141], v[78:79] op_sel:[0,0,0] op_sel_hi:[1,0,1] neg_lo:[0,1,0] neg_hi:[0,1,0]
    v_pk_mul_f32 v[76:77], v[76:77], v[142:143] op_sel:[0,0] op_sel_hi:[1,0]
    v_pk_mul_f32 v[78:79], v[78:79], v[142:143] op_sel:[0,0] op_sel_hi:[1,0]
    v_cvt_pk_bf16_f32 v76, v76, v77
    v_cvt_pk_bf16_f32 v77, v78, v79
    ds_write_b64 v21, v[76:77] offset:23424
    v_pk_fma_f32 v[80:81], v[152:153], v[128:129], v[80:81] op_sel:[0,0,0] op_sel_hi:[1,0,1] neg_lo:[0,1,0] neg_hi:[0,1,0]
    v_pk_fma_f32 v[82:83], v[154:155], v[128:129], v[82:83] op_sel:[0,0,0] op_sel_hi:[1,0,1] neg_lo:[0,1,0] neg_hi:[0,1,0]
    v_pk_mul_f32 v[80:81], v[80:81], v[130:131] op_sel:[0,0] op_sel_hi:[1,0]
    v_pk_mul_f32 v[82:83], v[82:83], v[130:131] op_sel:[0,0] op_sel_hi:[1,0]
    v_cvt_pk_bf16_f32 v80, v80, v81
    v_cvt_pk_bf16_f32 v81, v82, v83
    ds_write_b64 v21, v[80:81] offset:32
    v_pk_fma_f32 v[84:85], v[152:153], v[132:133], v[84:85] op_sel:[0,0,0] op_sel_hi:[1,0,1] neg_lo:[0,1,0] neg_hi:[0,1,0]
    v_pk_fma_f32 v[86:87], v[154:155], v[132:133], v[86:87] op_sel:[0,0,0] op_sel_hi:[1,0,1] neg_lo:[0,1,0] neg_hi:[0,1,0]
    v_pk_mul_f32 v[84:85], v[84:85], v[134:135] op_sel:[0,0] op_sel_hi:[1,0]
    v_pk_mul_f32 v[86:87], v[86:87], v[134:135] op_sel:[0,0] op_sel_hi:[1,0]
    v_cvt_pk_bf16_f32 v84, v84, v85
    v_cvt_pk_bf16_f32 v85, v86, v87
    ds_write_b64 v21, v[84:85] offset:7840
    v_pk_fma_f32 v[88:89], v[152:153], v[136:137], v[88:89] op_sel:[0,0,0] op_sel_hi:[1,0,1] neg_lo:[0,1,0] neg_hi:[0,1,0]
    v_pk_fma_f32 v[90:91], v[154:155], v[136:137], v[90:91] op_sel:[0,0,0] op_sel_hi:[1,0,1] neg_lo:[0,1,0] neg_hi:[0,1,0]
    v_pk_mul_f32 v[88:89], v[88:89], v[138:139] op_sel:[0,0] op_sel_hi:[1,0]
    v_pk_mul_f32 v[90:91], v[90:91], v[138:139] op_sel:[0,0] op_sel_hi:[1,0]
    v_cvt_pk_bf16_f32 v88, v88, v89
    v_cvt_pk_bf16_f32 v89, v90, v91
    ds_write_b64 v21, v[88:89] offset:15648
    v_pk_fma_f32 v[92:93], v[152:153], v[140:141], v[92:93] op_sel:[0,0,0] op_sel_hi:[1,0,1] neg_lo:[0,1,0] neg_hi:[0,1,0]
    v_pk_fma_f32 v[94:95], v[154:155], v[140:141], v[94:95] op_sel:[0,0,0] op_sel_hi:[1,0,1] neg_lo:[0,1,0] neg_hi:[0,1,0]
    v_pk_mul_f32 v[92:93], v[92:93], v[142:143] op_sel:[0,0] op_sel_hi:[1,0]
    v_pk_mul_f32 v[94:95], v[94:95], v[142:143] op_sel:[0,0] op_sel_hi:[1,0]
    v_cvt_pk_bf16_f32 v92, v92, v93
    v_cvt_pk_bf16_f32 v93, v94, v95
    ds_write_b64 v21, v[92:93] offset:23456
    s_branch G1_att
G1_vB:
    s_add_u32 s40, s30, s36
    s_add_u32 m0, s40, 0
    s_nop 0
    buffer_load_dwordx4 v5, s[8:11], s32 offen lds
    s_cmp_lg_u32 s22, 0
    s_cbranch_scc1 1f
    s_add_u32 m0, s36, 8192
    s_nop 0
    buffer_load_dwordx4 v8, s[44:47], s34 offen lds
1:
    s_add_u32 s40, s30, s36
    s_add_u32 m0, s40, 9216
    s_nop 0
    buffer_load_dwordx4 v6, s[8:11], s31 offen lds
    s_add_u32 s40, s30, s48
    s_add_u32 m0, s40, 55296
    s_nop 0
    buffer_load_dwordx4 v7, s[12:15], s33 offen lds
    s_add_u32 s40, s40, 62464
    s_add_u32 s41, s36, 17408
    s_add_u32 s42, s34, 102400
    s_cmp_eq_u32 s22, 0
    s_cselect_b32 m0, s41, s40
    s_cselect_b32 s41, s42, s33
    buffer_load_dwordx4 v9, s[44:47], s41 offen lds
    s_add_u32 s33, s33, 122880
    s_sub_u32 s48, s48, 15360
    s_cselect_b32 s48, 46080, s48
    s_add_u32 s32, s32, 128
    s_add_u32 s31, s31, 128
    s_add_u32 s34, s34, 128
    s_add_u32 s36, s36, 18432
    s_cmp_eq_u32 s36, 55296
    s_cselect_b32 s36, 0, s36
    v_lshrrev_b32 v14, 2, v1
    v_lshl_add_u32 v10, v14, 13, v3
    v_xor_b32 v11, 64, v10
    v_lshrrev_b32 v16, 5, v2
    v_bfe_u32 v17, v2, 4, 1
    v_bfe_u32 v18, v2, 2, 2
    v_lshl_add_u32 v18, v16, 4, v18
    v_lshl_add_u32 v18, v17, 2, v18
    v_mul_u32_u24 v18, 480, v18
    v_and_b32 v17, 3, v2
    v_lshl_add_u32 v18, v17, 3, v18
    v_and_b32 v17, 3, v1
    v_lshl_add_u32 v18, v17, 7, v18
    v_add_u32 v18, 55296, v18
    s_lshr_b32 s56, s22, 2
    s_lshl_b32 s56, s56, 6
    s_cmp_eq_u32 s22, 7
    s_cselect_b32 s56, 0, s56
    s_xor_b32 s57, s56, 64
    v_add_u32 v15, s56, v18
    v_add_u32 v16, s57, v18
    v_mov_b32 v32, 0
    v_mov_b32 v33, 0
    v_mov_b32 v34, 0
    v_mov_b32 v35, 0
    v_mov_b32 v36, 0
    v_mov_b32 v37, 0
    v_mov_b32 v38, 0
    v_mov_b32 v39, 0
    v_mov_b32 v40, 0
    v_mov_b32 v41, 0
    v_mov_b32 v42, 0
    v_mov_b32 v43, 0
    v_mov_b32 v44, 0
    v_mov_b32 v45, 0
    v_mov_b32 v46, 0
    v_mov_b32 v47, 0
    v_mov_b32 v48, 0
    v_mov_b32 v49, 0
    v_mov_b32 v50, 0
    v_mov_b32 v51, 0
    v_mov_b32 v52, 0
    v_mov_b32 v53, 0
    v_mov_b32 v54, 0
    v_mov_b32 v55, 0
    v_mov_b32 v56, 0
    v_mov_b32 v57, 0
    v_mov_b32 v58, 0
    v_mov_b32 v59, 0
    v_mov_b32 v60, 0
    v_mov_b32 v61, 0
    v_mov_b32 v62, 0
    v_mov_b32 v63, 0
    v_mov_b32 v64, 0
    v_mov_b32 v65, 0
    v_mov_b32 v66, 0
    v_mov_b32 v67, 0
    v_mov_b32 v68, 0
    v_mov_b32 v69, 0
    v_mov_b32 v70, 0
    v_mov_b32 v71, 0
    v_mov_b32 v72, 0
    v_mov_b32 v73, 0
    v_mov_b32 v74, 0
    v_mov_b32 v75, 0
    v_mov_b32 v76, 0
    v_mov_b32 v77, 0
    v_mov_b32 v78, 0
    v_mov_b32 v79, 0
    v_mov_b32 v80, 0
    v_mov_b32 v81, 0
    v_mov_b32 v82, 0
    v_mov_b32 v83, 0
    v_mov_b32 v84, 0
    v_mov_b32 v85, 0
    v_mov_b32 v86, 0
    v_mov_b32 v87, 0
    v_mov_b32 v88, 0
    v_mov_b32 v89, 0
    v_mov_b32 v90, 0
    v_mov_b32 v91, 0
    v_mov_b32 v92, 0
    v_mov_b32 v93, 0
    v_mov_b32 v94, 0
    v_mov_b32 v95, 0
    v_mov_b32 v96, 0
    v_mov_b32 v97, 0
    v_mov_b32 v98, 0
    v_mov_b32 v99, 0
    v_mov_b32 v100, 0
    v_mov_b32 v101, 0
    v_mov_b32 v102, 0
    v_mov_b32 v103, 0
    v_mov_b32 v104, 0
    v_mov_b32 v105, 0
    v_mov_b32 v106, 0
    v_mov_b32 v107, 0
    v_mov_b32 v108, 0
    v_mov_b32 v109, 0
    v_mov_b32 v110, 0
    v_mov_b32 v111, 0
    v_mov_b32 v200, 0
    v_mov_b32 v201, 0
    v_mov_b32 v202, 0
    v_mov_b32 v203, 0
    v_mov_b32 v204, 0
    v_mov_b32 v205, 0
    v_mov_b32 v206, 0
    v_mov_b32 v207, 0
    v_mov_b32 v28, 0x3f803f80
    v_mov_b32 v29, 0x3f803f80
    v_mov_b32 v30, 0x3f803f80
    v_mov_b32 v31, 0x3f803f80
    s_mov_b32 s35, 0
    s_sub_u32 s28, 14, s21
    s_bitcmp1_b32 s21, 0
    s_cselect_b32 s28, 31, s28
    s_bitset1_b32 s78, s28
    s_lshl_b32 s29, s3, 3
    s_add_u32 s29, s29, s22
    s_lshl_b32 s29, s29, 11
    s_add_u32 s29, s29, 282624
    s_add_u32 s40, s30, s36
    s_add_u32 m0, s40, 0
    s_nop 0
    buffer_load_dwordx4 v5, s[8:11], s32 offen lds
    s_add_u32 s40, s30, s48
    s_add_u32 m0, s40, 55296
    s_nop 0
    buffer_load_dwordx4 v7, s[12:15], s33 offen lds
    s_add_u32 s40, s40, 62464
    s_add_u32 s41, s36, 8192
    s_add_u32 s42, s34, 0
    s_cmp_eq_u32 s22, 0
    s_cselect_b32 m0, s41, s40
    s_cselect_b32 s41, s42, s33
    buffer_load_dwordx4 v8, s[44:47], s41 offen lds
    s_add_u32 s33, s33, 122880
    s_sub_u32 s48, s48, 15360
    s_cselect_b32 s48, 46080, s48
    s_add_u32 s40, s30, s36
    s_add_u32 m0, s40, 9216
    s_nop 0
    buffer_load_dwordx4 v6, s[8:11], s31 offen lds
    s_add_u32 s40, s30, s48
    s_add_u32 m0, s40, 55296
    s_nop 0
    buffer_load_dwordx4 v7, s[12:15], s33 offen lds
    s_add_u32 s40, s40, 62464
    s_add_u32 s41, s36, 17408
    s_add_u32 s42, s34, 102400
    s_cmp_eq_u32 s22, 0
    s_cselect_b32 m0, s41, s40
    s_cselect_b32 s41, s42, s33
    buffer_load_dwordx4 v9, s[44:47], s41 offen lds
    s_add_u32 s33, s33, 122880
    s_sub_u32 s48, s48, 15360
    s_cselect_b32 s48, 46080, s48
    s_add_u32 s32, s32, 128
    s_add_u32 s31, s31, 128
    s_add_u32 s34, s34, 128
    s_add_u32 s36, s36, 18432
    s_cmp_eq_u32 s36, 55296
    s_cselect_b32 s36, 0, s36
    s_waitcnt vmcnt(10)
    v_lshlrev_b32 v134, 16, v128
    v_and_b32 v135, s50, v128
    v_lshlrev_b32 v136, 16, v129
    v_and_b32 v137, s50, v129
    v_lshlrev_b32 v138, 16, v130
    v_and_b32 v139, s50, v130
    v_lshlrev_b32 v140, 16, v131
    v_and_b32 v141, s50, v131
    v_lshlrev_b32 v142, 16, v132
    v_and_b32 v143, s50, v132
    v_add_f32 v144, v134, v135
    v_add_f32 v145, v136, v137
    v_add_f32 v144, v144, v138
    v_add_f32 v145, v145, v139
    v_add_f32 v144, v144, v140
    v_add_f32 v145, v145, v141
    v_add_f32 v144, v144, v142
    v_add_f32 v145, v145, v143
    v_add_f32 v144, v144, v145
    s_nop 1
    v_add_f32_dpp v144, v144, v144 row_ror:8 row_mask:0xf bank_mask:0xf
    s_nop 1
    v_add_f32_dpp v144, v144, v144 row_ror:4 row_mask:0xf bank_mask:0xf
    s_nop 1
    v_add_f32_dpp v144, v144, v144 row_ror:2 row_mask:0xf bank_mask:0xf
    s_nop 1
    v_add_f32_dpp v144, v144, v144 row_ror:1 row_mask:0xf bank_mask:0xf
    s_nop 1
    v_add_f32_dpp v144, v144, v144 row_bcast:15 row_mask:0xa bank_mask:0xf
    s_nop 1
    v_add_f32_dpp v144, v144, v144 row_bcast:31 row_mask:0xc bank_mask:0xf
    s_nop 1
    v_readlane_b32 s40, v144, 63
    v_mov_b32 v146, 0x3acccccd
    s_nop 0
    v_mul_f32 v147, s40, v146
    v_sub_f32 v134, v134, v147
    v_sub_f32 v135, v135, v147
    v_sub_f32 v136, v136, v147
    v_sub_f32 v137, v137, v147
    v_sub_f32 v138, v138, v147
    v_sub_f32 v139, v139, v147
    v_sub_f32 v140, v140, v147
    v_sub_f32 v141, v141, v147
    v_sub_f32 v142, v142, v147
    v_sub_f32 v143, v143, v147
    v_mul_f32 v144, v134, v134
    v_mul_f32 v145, v135, v135
    v_fmac_f32 v144, v136, v136
    v_fmac_f32 v145, v137, v137
    v_fmac_f32 v144, v138, v138
    v_fmac_f32 v145, v139, v139
    v_fmac_f32 v144, v140, v140
    v_fmac_f32 v145, v141, v141
    v_fmac_f32 v144, v142, v142
    v_fmac_f32 v145, v143, v143
    v_add_f32 v144, v144, v145
    s_nop 1
    v_add_f32_dpp v144, v144, v144 row_ror:8 row_mask:0xf bank_mask:0xf
    s_nop 1
    v_add_f32_dpp v144, v144, v144 row_ror:4 row_mask:0xf bank_mask:0xf
    s_nop 1
    v_add_f32_dpp v144, v144, v144 row_ror:2 row_mask:0xf bank_mask:0xf
    s_nop 1
    v_add_f32_dpp v144, v144, v144 row_ror:1 row_mask:0xf bank_mask:0xf
    s_nop 1
    v_add_f32_dpp v144, v144, v144 row_bcast:15 row_mask:0xa bank_mask:0xf
    s_nop 1
    v_add_f32_dpp v144, v144, v144 row_bcast:31 row_mask:0xc bank_mask:0xf
    s_nop 1
    v_readlane_b32 s40, v144, 63
    s_nop 1
    v_mul_f32 v148, s40, v146
    v_cvt_pk_bf16_f32 v148, v148, v148
    v_lshlrev_b32 v148, 16, v148
    v_add_f32 v148, 0x3727c5ac, v148
    v_cvt_pk_bf16_f32 v148, v148, v148
    v_lshlrev_b32 v148, 16, v148
    v_sqrt_f32 v148, v148
    s_nop 0
    v_cvt_pk_bf16_f32 v238, v147, v148
    s_waitcnt vmcnt(6) lgkmcnt(0)
    s_add_u32 s76, s76, 0x9e3779b9
    v_add_u32 v22, s37, v10
    v_add_u32 v24, s49, v15
    v_add_u32 v25, s49, v16
    s_barrier
    ds_read_b128 v[128:131], v22 offset:2048
    ds_read_b128 v[132:135], v22 offset:4096
    ds_read_b128 v[136:139], v22 offset:6144
    ds_read_b128 v[140:143], v22 offset:8192
    ds_read_b128 v[144:147], v22 offset:0
    ds_read_b64_tr_b16 v[148:149], v24 offset:0
    ds_read_b64_tr_b16 v[150:151], v24 offset:3840
    ds_read_b64_tr_b16 v[152:153], v24 offset:32
    ds_read_b64_tr_b16 v[154:155], v24 offset:3872
    ds_read_b64_tr_b16 v[156:157], v25 offset:0
    ds_read_b64_tr_b16 v[158:159], v25 offset:3840
    ds_read_b64_tr_b16 v[160:161], v25 offset:32
    ds_read_b64_tr_b16 v[162:163], v25 offset:3872
    s_add_u32 s40, s30, s36
    s_add_u32 m0, s40, 0
    s_nop 0
    buffer_load_dwordx4 v5, s[8:11], s32 offen lds
    s_add_u32 s40, s30, s48
    s_add_u32 m0, s40, 55296
    s_nop 0
    buffer_load_dwordx4 v7, s[12:15], s33 offen lds
    s_add_u32 s40, s40, 62464
    s_add_u32 s41, s36, 8192
    s_add_u32 s42, s34, 0
    s_cmp_eq_u32 s22, 0
    s_cselect_b32 m0, s41, s40
    s_cselect_b32 s41, s42, s33
    buffer_load_dwordx4 v8, s[44:47], s41 offen lds
    s_add_u32 s33, s33, 122880
    s_sub_u32 s48, s48, 15360
    s_cselect_b32 s48, 46080, s48
    s_sub_u32 s49, s49, 15360
    s_cselect_b32 s49, 46080, s49
    v_add_u32 v22, s37, v11
    v_add_u32 v24, s49, v15
    v_add_u32 v25, s49, v16
    s_cmp_eq_u32 s28, 0
    s_cbranch_scc1 G1QB_hz
    s_branch G1QB_ent
G1QB_loop:
    v_mfma_f32_16x16x32_bf16 v[104:107], v[192:195], v[180:183], v[104:107]
    v_mfma_f32_16x16x32_bf16 v[108:111], v[196:199], v[180:183], v[108:111]
G1QB_ent:
    s_waitcnt vmcnt(6) lgkmcnt(0)
    s_barrier
    v_mfma_f32_16x16x32_bf16 v[32:35], v[148:151], v[128:131], v[32:35]
    ds_read_b128 v[164:167], v22 offset:2048
    s_add_u32 s40, s30, s36
    v_mfma_f32_16x16x32_bf16 v[36:39], v[148:151], v[132:135], v[36:39]
    ds_read_b128 v[168:171], v22 offset:4096
    s_add_u32 m0, s40, 9216
    s_nop 0
    buffer_load_dwordx4 v6, s[8:11], s31 offen lds
    v_mfma_f32_16x16x32_bf16 v[40:43], v[148:151], v[136:139], v[40:43]
    ds_read_b128 v[172:175], v22 offset:6144
    s_add_u32 s40, s30, s48
    v_mfma_f32_16x16x32_bf16 v[44:47], v[148:151], v[140:143], v[44:47]
    ds_read_b128 v[176:179], v22 offset:8192
    s_add_u32 m0, s40, 55296
    s_nop 0
    buffer_load_dwordx4 v7, s[12:15], s33 offen lds
    v_mfma_f32_16x16x32_bf16 v[48:51], v[152:155], v[128:131], v[48:51]
    ds_read_b128 v[180:183], v22 offset:0
    s_add_u32 s40, s40, 62464
    v_mfma_f32_16x16x32_bf16 v[52:55], v[152:155], v[132:135], v[52:55]
    ds_read_b64_tr_b16 v[184:185], v24 offset:0
    s_add_u32 s41, s36, 17408
    v_mfma_f32_16x16x32_bf16 v[56:59], v[152:155], v[136:139], v[56:59]
    ds_read_b64_tr_b16 v[186:187], v24 offset:3840
    s_add_u32 s42, s34, 102400
    v_mfma_f32_16x16x32_bf16 v[60:63], v[152:155], v[140:143], v[60:63]
    ds_read_b64_tr_b16 v[188:189], v24 offset:32
    s_cmp_eq_u32 s22, 0
    s_cselect_b32 m0, s41, s40
    s_cselect_b32 s41, s42, s33
    v_mfma_f32_16x16x32_bf16 v[64:67], v[156:159], v[128:131], v[64:67]
    ds_read_b64_tr_b16 v[190:191], v24 offset:3872
    buffer_load_dwordx4 v9, s[44:47], s41 offen lds
    v_mfma_f32_16x16x32_bf16 v[68:71], v[156:159], v[132:135], v[68:71]
    ds_read_b64_tr_b16 v[192:193], v25 offset:0
    s_add_u32 s33, s33, 122880
    v_mfma_f32_16x16x32_bf16 v[72:75], v[156:159], v[136:139], v[72:75]
    ds_read_b64_tr_b16 v[194:195], v25 offset:3840
    s_sub_u32 s48, s48, 15360
    s_cselect_b32 s48, 46080, s48
    v_mfma_f32_16x16x32_bf16 v[76:79], v[156:159], v[140:143], v[76:79]
    ds_read_b64_tr_b16 v[196:197], v25 offset:32
    s_add_u32 s32, s32, 128
    v_mfma_f32_16x16x32_bf16 v[80:83], v[160:163], v[128:131], v[80:83]
    ds_read_b64_tr_b16 v[198:199], v25 offset:3872
    s_add_u32 s31, s31, 128
    v_mfma_f32_16x16x32_bf16 v[84:87], v[160:163], v[132:135], v[84:87]
    s_add_u32 s37, s37, 18432
    s_cmp_eq_u32 s37, 55296
    s_cselect_b32 s37, 0, s37
    s_add_u32 s34, s34, 128
    v_mfma_f32_16x16x32_bf16 v[88:91], v[160:163], v[136:139], v[88:91]
    s_sub_u32 s49, s49, 15360
    s_cselect_b32 s49, 46080, s49
    v_add_u32 v22, s37, v10
    s_add_u32 s36, s36, 18432
    v_mfma_f32_16x16x32_bf16 v[92:95], v[160:163], v[140:143], v[92:95]
    v_add_u32 v24, s49, v15
    v_add_u32 v25, s49, v16
    s_cmp_eq_u32 s36, 55296
    s_cselect_b32 s36, 0, s36
    v_mfma_f32_16x16x32_bf16 v[96:99], v[148:151], v[144:147], v[96:99]
    v_mfma_f32_16x16x32_bf16 v[100:103], v[152:155], v[144:147], v[100:103]
    v_mfma_f32_16x16x32_bf16 v[104:107], v[156:159], v[144:147], v[104:107]
    v_mfma_f32_16x16x32_bf16 v[108:111], v[160:163], v[144:147], v[108:111]
    s_waitcnt vmcnt(6) lgkmcnt(0)
    s_barrier
    v_mfma_f32_16x16x32_bf16 v[32:35], v[184:187], v[164:167], v[32:35]
    ds_read_b128 v[128:131], v22 offset:2048
    s_add_u32 s40, s30, s36
    v_mfma_f32_16x16x32_bf16 v[36:39], v[184:187], v[168:171], v[36:39]
    ds_read_b128 v[132:135], v22 offset:4096
    s_add_u32 m0, s40, 0
    s_nop 0
    buffer_load_dwordx4 v5, s[8:11], s32 offen lds
    v_mfma_f32_16x16x32_bf16 v[40:43], v[184:187], v[172:175], v[40:43]
    ds_read_b128 v[136:139], v22 offset:6144
    s_add_u32 s40, s30, s48
    v_mfma_f32_16x16x32_bf16 v[44:47], v[184:187], v[176:179], v[44:47]
    ds_read_b128 v[140:143], v22 offset:8192
    s_add_u32 m0, s40, 55296
    s_nop 0
    buffer_load_dwordx4 v7, s[12:15], s33 offen lds
    v_mfma_f32_16x16x32_bf16 v[48:51], v[188:191], v[164:167], v[48:51]
    ds_read_b128 v[144:147], v22 offset:0
    s_add_u32 s40, s40, 62464
    v_mfma_f32_16x16x32_bf16 v[52:55], v[188:191], v[168:171], v[52:55]
    ds_read_b64_tr_b16 v[148:149], v24 offset:0
    s_add_u32 s41, s36, 8192
    v_mfma_f32_16x16x32_bf16 v[56:59], v[188:191], v[172:175], v[56:59]
    ds_read_b64_tr_b16 v[150:151], v24 offset:3840
    s_add_u32 s42, s34, 0
    v_mfma_f32_16x16x32_bf16 v[60:63], v[188:191], v[176:179], v[60:63]
    ds_read_b64_tr_b16 v[152:153], v24 offset:32
    s_cmp_eq_u32 s22, 0
    s_cselect_b32 m0, s41, s40
    s_cselect_b32 s41, s42, s33
    v_mfma_f32_16x16x32_bf16 v[64:67], v[192:195], v[164:167], v[64:67]
    ds_read_b64_tr_b16 v[154:155], v24 offset:3872
    buffer_load_dwordx4 v8, s[44:47], s41 offen lds
    v_mfma_f32_16x16x32_bf16 v[68:71], v[192:195], v[168:171], v[68:71]
    ds_read_b64_tr_b16 v[156:157], v25 offset:0
    s_add_u32 s33, s33, 122880
    v_mfma_f32_16x16x32_bf16 v[72:75], v[192:195], v[172:175], v[72:75]
    ds_read_b64_tr_b16 v[158:159], v25 offset:3840
    s_sub_u32 s48, s48, 15360
    s_cselect_b32 s48, 46080, s48
    v_mfma_f32_16x16x32_bf16 v[76:79], v[192:195], v[176:179], v[76:79]
    ds_read_b64_tr_b16 v[160:161], v25 offset:32
    v_mfma_f32_16x16x32_bf16 v[80:83], v[196:199], v[164:167], v[80:83]
    ds_read_b64_tr_b16 v[162:163], v25 offset:3872
    v_mfma_f32_16x16x32_bf16 v[84:87], v[196:199], v[168:171], v[84:87]
    s_sub_u32 s49, s49, 15360
    s_cselect_b32 s49, 46080, s49
    v_mfma_f32_16x16x32_bf16 v[88:91], v[196:199], v[172:175], v[88:91]
    v_add_u32 v22, s37, v11
    v_mfma_f32_16x16x32_bf16 v[92:95], v[196:199], v[176:179], v[92:95]
    v_add_u32 v24, s49, v15
    v_mfma_f32_16x16x32_bf16 v[96:99], v[184:187], v[180:183], v[96:99]
    v_add_u32 v25, s49, v16
    v_mfma_f32_16x16x32_bf16 v[100:103], v[188:191], v[180:183], v[100:103]
    s_add_u32 s35, s35, 2
    s_bitcmp1_b32 s78, s35
    s_cbranch_scc0 G1QB_loop
    s_cmp_eq_u32 s35, s28
    s_cbranch_scc0 G1QB_h0
    v_mfma_f32_16x16x32_bf16 v[200:203], v[28:31], v[184:187], v[200:203]
    v_mfma_f32_16x16x32_bf16 v[204:207], v[28:31], v[188:191], v[204:207]
G1QB_hz:
    s_waitcnt lgkmcnt(0)
    s_nop 3
    v_mfma_f32_16x16x32_bf16 v[200:203], v[28:31], v[148:151], v[200:203]
    v_mfma_f32_16x16x32_bf16 v[204:207], v[28:31], v[152:155], v[204:207]
    s_and_b32 s40, s28, 6
    s_lshl_b32 s40, s40, 7
    s_and_b32 s41, s28, 8
    s_add_u32 s40, s40, s41
    s_add_u32 s40, s40, s29
    s_mov_b64 exec, 0xffff
    s_nop 6
    v_mov_b32 v201, s76
    v_cvt_pk_bf16_f32 v200, v200, v204
    buffer_store_dwordx2 v[200:201], v4, s[64:67], s40 offen sc1
    s_mov_b64 exec, -1
    s_cmp_eq_u32 s35, 0
    s_cbranch_scc1 G1QB_ent
G1QB_h0:
    s_cmp_eq_u32 s35, 4
    s_cbranch_scc0 G1QB_h2
    v_mov_b32 v239, s76
    v_mov_b32 v233, 0
    s_mov_b64 exec, 1
    buffer_store_dwordx2 v[238:239], v233, s[64:67], s68 offen sc1
    s_mov_b64 exec, -1
    s_branch G1QB_loop
G1QB_h2:
    s_cmp_eq_u32 s35, 14
    s_cbranch_scc1 G1QB_end
    s_cmp_eq_u32 s35, 12
    s_cbranch_scc0 G1QB_loop
    buffer_load_dwordx2 v[238:239], v237, s[64:67], 0 offen sc1
    buffer_load_dwordx2 v[234:235], v236, s[64:67], 0 offen sc1
    buffer_load_dword v230, v231, s[64:67], 0 offen sc1
    s_branch G1QB_loop
G1QB_sp:
    s_sleep 2
    buffer_load_dwordx2 v[238:239], v237, s[64:67], 0 offen sc1
    buffer_load_dwordx2 v[234:235], v236, s[64:67], 0 offen sc1
    buffer_load_dword v230, v231, s[64:67], 0 offen sc1
    s_waitcnt vmcnt(0)
    s_add_u32 s35, s35, 1
    s_cmp_lt_u32 s35, 0x40000
    s_cbranch_scc1 G1QB_vf
    s_branch G1QB_so
G1QB_cs:
    s_sleep 2
    buffer_load_dwordx4 v[252:255], v4, s[64:67], s29 offen sc1
    s_waitcnt vmcnt(0)
    s_add_u32 s35, s35, 1
    s_cmp_lt_u32 s35, 0x40000
    s_cbranch_scc1 G1QB_cv
    s_branch G1QB_co
G1QB_end:
    v_mfma_f32_16x16x32_bf16 v[104:107], v[192:195], v[180:183], v[104:107]
    v_mfma_f32_16x16x32_bf16 v[108:111], v[196:199], v[180:183], v[108:111]
    s_waitcnt vmcnt(6) lgkmcnt(0)
G1QB_vf:
    v_cmp_ne_u32 vcc, s76, v239
    v_cmp_ne_u32 s[40:41], s76, v230
    s_or_b64 vcc, vcc, s[40:41]
    v_cmp_ne_u32 s[40:41], s76, v235
    s_or_b64 vcc, vcc, s[40:41]
    s_cbranch_scc1 G1QB_sp
G1QB_so:
    s_barrier
    v_mfma_f32_16x16x32_bf16 v[32:35], v[148:151], v[128:131], v[32:35]
    ds_read_b128 v[164:167], v22 offset:2048
    s_add_u32 s40, s30, s36
    s_add_u32 m0, s40, 9216
    s_nop 0
    buffer_load_dwordx4 v6, s[8:11], s31 offen lds
    v_mfma_f32_16x16x32_bf16 v[36:39], v[148:151], v[132:135], v[36:39]
    ds_read_b128 v[168:171], v22 offset:4096
    v_mfma_f32_16x16x32_bf16 v[40:43], v[148:151], v[136:139], v[40:43]
    ds_read_b128 v[172:175], v22 offset:6144
    v_mfma_f32_16x16x32_bf16 v[44:47], v[148:151], v[140:143], v[44:47]
    ds_read_b128 v[176:179], v22 offset:8192
    s_add_u32 s40, s30, s48
    v_mfma_f32_16x16x32_bf16 v[48:51], v[152:155], v[128:131], v[48:51]
    ds_read_b128 v[180:183], v22 offset:0
    s_add_u32 m0, s40, 55296
    s_nop 0
    buffer_load_dwordx4 v7, s[12:15], s33 offen lds
    v_mfma_f32_16x16x32_bf16 v[52:55], v[152:155], v[132:135], v[52:55]
    ds_read_b64_tr_b16 v[184:185], v24 offset:0
    s_add_u32 s40, s40, 62464
    s_add_u32 s41, s36, 17408
    v_mfma_f32_16x16x32_bf16 v[56:59], v[152:155], v[136:139], v[56:59]
    ds_read_b64_tr_b16 v[186:187], v24 offset:3840
    s_add_u32 s42, s34, 102400
    s_cmp_eq_u32 s22, 0
    s_cselect_b32 m0, s41, s40
    s_cselect_b32 s41, s42, s33
    v_mfma_f32_16x16x32_bf16 v[60:63], v[152:155], v[140:143], v[60:63]
    ds_read_b64_tr_b16 v[188:189], v24 offset:32
    buffer_load_dwordx4 v9, s[44:47], s41 offen lds
    v_mfma_f32_16x16x32_bf16 v[64:67], v[156:159], v[128:131], v[64:67]
    ds_read_b64_tr_b16 v[190:191], v24 offset:3872
    s_add_u32 s33, s33, 122880
    s_sub_u32 s48, s48, 15360
    s_cselect_b32 s48, 46080, s48
    s_add_u32 s32, s32, 128
    s_add_u32 s31, s31, 128
    s_add_u32 s34, s34, 128
    s_add_u32 s36, s36, 18432
    s_cmp_eq_u32 s36, 55296
    s_cselect_b32 s36, 0, s36
    v_mov_b32 v112, v238
    v_mov_b32 v113, v234
    s_add_u32 s52, s18, 0xa00000
    s_addc_u32 s53, s19, 0
    s_and_b32 s53, s53, 0xffff
    s_mov_b32 s54, 0x2a8000
    s_mov_b32 s55, 0x00020000
    s_lshr_b32 s59, s2, 6
    s_cmp_eq_u32 s59, 3
    s_cselect_b32 s59, 0, s59
    s_lshl_b32 s59, s59, 10
    s_add_u32 s60, s59, 1024
    s_cmp_eq_u32 s60, 3072
    s_cselect_b32 s60, 0, s60
    v_mfma_f32_16x16x32_bf16 v[68:71], v[156:159], v[132:135], v[68:71]
    ds_read_b64_tr_b16 v[192:193], v25 offset:0
    s_add_u32 s61, s60, 1024
    s_cmp_eq_u32 s61, 3072
    s_cselect_b32 s61, 0, s61
    s_bfe_u32 s74, s2, 0x30003
    s_mul_i32 s74, s74, 68*5120
    s_mul_i32 s73, s22, 6*5120
    s_add_u32 s73, s73, s74
    s_add_u32 s73, s73, 20*5120
    s_mul_i32 s70, s59, 5
    s_add_u32 s70, s70, s73
    s_mul_i32 s71, s60, 5
    s_add_u32 s71, s71, s73
    s_mul_i32 s72, s61, 5
    s_add_u32 s72, s72, s73
    s_and_b32 s73, s22, 3
    s_mul_i32 s73, s73, 5*5120
    s_add_u32 s40, s73, s74
    s_mov_b32 s41, s70
    s_mov_b32 s75, s71
    v_mfma_f32_16x16x32_bf16 v[72:75], v[156:159], v[136:139], v[72:75]
    ds_read_b64_tr_b16 v[194:195], v25 offset:3840
    s_mov_b32 s43, s72
    s_cmp_lt_u32 s22, 4
    s_cselect_b32 s70, s41, s40
    s_cmp_lt_u32 s22, 4
    s_cselect_b32 s71, s41, s40
    s_cselect_b32 s35, 15, 5
    s_lshl_b32 s35, s35, 10
    s_add_u32 s71, s71, s35
    s_cmp_lt_u32 s22, 4
    s_cselect_b32 s72, s75, s40
    s_cselect_b32 s35, 0, 10240
    s_add_u32 s72, s72, s35
    s_cmp_lt_u32 s22, 4
    s_cselect_b32 s73, s75, s41
    s_cselect_b32 s35, 15360, 0
    s_add_u32 s73, s73, s35
    s_cmp_lt_u32 s22, 4
    s_cselect_b32 s74, s43, s41
    s_cselect_b32 s35, 0, 15360
    s_add_u32 s74, s74, s35
    s_cmp_lt_u32 s22, 4
    s_cselect_b32 s80, s43, s75
    s_cselect_b32 s35, 15360, 0
    s_add_u32 s80, s80, s35
    s_cmp_lt_u32 s22, 4
    s_cselect_b32 s81, s40, s75
    s_add_u32 s81, s81, 15360
    s_cmp_lt_u32 s22, 4
    s_cselect_b32 s82, s40, s43
    s_cselect_b32 s35, 20480, 0
    s_add_u32 s82, s82, s35
    s_add_u32 s83, s43, 15360
    v_mfma_f32_16x16x32_bf16 v[76:79], v[156:159], v[140:143], v[76:79]
    ds_read_b64_tr_b16 v[196:197], v25 offset:32
    s_add_u32 m0, s30, 155648
    s_add_u32 s40, s73, 4096
    buffer_load_dwordx4 v4, s[52:55], s40 offen lds
    v_mfma_f32_16x16x32_bf16 v[80:83], v[160:163], v[128:131], v[80:83]
    ds_read_b64_tr_b16 v[198:199], v25 offset:3872
    v_mfma_f32_16x16x32_bf16 v[84:87], v[160:163], v[132:135], v[84:87]
    s_add_u32 s37, s37, 18432
    s_cmp_eq_u32 s37, 55296
    s_cselect_b32 s37, 0, s37
    v_mfma_f32_16x16x32_bf16 v[88:91], v[160:163], v[136:139], v[88:91]
    s_sub_u32 s49, s49, 15360
    s_cselect_b32 s49, 46080, s49
    v_add_u32 v22, s37, v10
    s_add_u32 m0, s30, 147456
    s_add_u32 s40, s73, 3072
    buffer_load_dwordx4 v4, s[52:55], s40 offen lds
    v_mfma_f32_16x16x32_bf16 v[92:95], v[160:163], v[140:143], v[92:95]
    v_add_u32 v24, s49, v15
    v_add_u32 v25, s49, v16
    v_mfma_f32_16x16x32_bf16 v[96:99], v[148:151], v[144:147], v[96:99]
    v_mfma_f32_16x16x32_bf16 v[100:103], v[152:155], v[144:147], v[100:103]
    v_mfma_f32_16x16x32_bf16 v[104:107], v[156:159], v[144:147], v[104:107]
    v_mfma_f32_16x16x32_bf16 v[108:111], v[160:163], v[144:147], v[108:111]
    s_waitcnt vmcnt(8) lgkmcnt(0)
    s_barrier
    v_mfma_f32_16x16x32_bf16 v[32:35], v[184:187], v[164:167], v[32:35]
    ds_read_b128 v[128:131], v22 offset:2048
    s_add_u32 s40, s30, s48
    s_add_u32 m0, s40, 55296
    s_nop 0
    buffer_load_dwordx4 v7, s[12:15], s33 offen lds
    v_mfma_f32_16x16x32_bf16 v[36:39], v[184:187], v[168:171], v[36:39]
    ds_read_b128 v[132:135], v22 offset:4096
    s_add_u32 s40, s40, 62464
    s_add_u32 s41, s36, 8192
    v_mfma_f32_16x16x32_bf16 v[40:43], v[184:187], v[172:175], v[40:43]
    ds_read_b128 v[136:139], v22 offset:6144
    s_add_u32 s42, s34, 0
    s_cmp_eq_u32 s22, 0
    s_cselect_b32 m0, s41, s40
    s_cselect_b32 s41, s42, s33
    v_mfma_f32_16x16x32_bf16 v[44:47], v[184:187], v[176:179], v[44:47]
    ds_read_b128 v[140:143], v22 offset:8192
    buffer_load_dwordx4 v8, s[44:47], s41 offen lds
    v_mfma_f32_16x16x32_bf16 v[48:51], v[188:191], v[164:167], v[48:51]
    ds_read_b128 v[144:147], v22 offset:0
    v_mfma_f32_16x16x32_bf16 v[52:55], v[188:191], v[168:171], v[52:55]
    ds_read_b64_tr_b16 v[148:149], v24 offset:0
    v_mfma_f32_16x16x32_bf16 v[200:203], v[184:187], v[28:31], 0
    ds_read_b64_tr_b16 v[150:151], v24 offset:3840
    v_mfma_f32_16x16x32_bf16 v[56:59], v[188:191], v[172:175], v[56:59]
    ds_read_b64_tr_b16 v[152:153], v24 offset:32
    s_add_u32 m0, s30, 139264
    s_add_u32 s40, s73, 2048
    buffer_load_dwordx4 v4, s[52:55], s40 offen lds
    v_mfma_f32_16x16x32_bf16 v[60:63], v[188:191], v[176:179], v[60:63]
    ds_read_b64_tr_b16 v[154:155], v24 offset:3872
    v_mfma_f32_16x16x32_bf16 v[64:67], v[192:195], v[164:167], v[64:67]
    ds_read_b64_tr_b16 v[156:157], v25 offset:0
    v_mfma_f32_16x16x32_bf16 v[68:71], v[192:195], v[168:171], v[68:71]
    ds_read_b64_tr_b16 v[158:159], v25 offset:3840
    s_add_u32 m0, s30, 131072
    s_add_u32 s40, s73, 1024
    buffer_load_dwordx4 v4, s[52:55], s40 offen lds
    v_mfma_f32_16x16x32_bf16 v[72:75], v[192:195], v[172:175], v[72:75]
    ds_read_b64_tr_b16 v[160:161], v25 offset:32
    v_mfma_f32_16x16x32_bf16 v[76:79], v[192:195], v[176:179], v[76:79]
    ds_read_b64_tr_b16 v[162:163], v25 offset:3872
    v_mfma_f32_16x16x32_bf16 v[80:83], v[196:199], v[164:167], v[80:83]
    s_sub_u32 s49, s49, 15360
    s_cselect_b32 s49, 46080, s49
    s_add_u32 m0, s30, 122880
    s_add_u32 s40, s73, 0
    buffer_load_dwordx4 v4, s[52:55], s40 offen lds
    v_mfma_f32_16x16x32_bf16 v[204:207], v[188:191], v[28:31], 0
    v_add_u32 v22, s37, v11
    v_mfma_f32_16x16x32_bf16 v[84:87], v[196:199], v[168:171], v[84:87]
    v_add_u32 v24, s49, v15
    v_mfma_f32_16x16x32_bf16 v[88:91], v[196:199], v[172:175], v[88:91]
    v_add_u32 v25, s49, v16
    v_mfma_f32_16x16x32_bf16 v[92:95], v[196:199], v[176:179], v[92:95]
    s_add_u32 s40, s70, 4096
    buffer_load_dwordx4 v[208:211], v4, s[52:55], s40 offen
    v_mfma_f32_16x16x32_bf16 v[96:99], v[184:187], v[180:183], v[96:99]
    v_mfma_f32_16x16x32_bf16 v[100:103], v[188:191], v[180:183], v[100:103]
    v_mfma_f32_16x16x32_bf16 v[104:107], v[192:195], v[180:183], v[104:107]
    v_mfma_f32_16x16x32_bf16 v[108:111], v[196:199], v[180:183], v[108:111]
    s_waitcnt vmcnt(11) lgkmcnt(0)
    s_barrier
    v_mfma_f32_16x16x32_bf16 v[32:35], v[148:151], v[128:131], v[32:35]
    ds_read_b128 v[164:167], v22 offset:2048
    buffer_load_dwordx4 v[252:255], v4, s[64:67], s29 offen sc1
    v_mfma_f32_16x16x32_bf16 v[36:39], v[148:151], v[132:135], v[36:39]
    ds_read_b128 v[168:171], v22 offset:4096
    s_add_u32 s8, s18, 0xd00000
    s_addc_u32 s9, s19, 0
    s_and_b32 s9, s9, 0xffff
    s_mov_b32 s10, 0x880000
    s_mov_b32 s11, 0x00020000
    v_mfma_f32_16x16x32_bf16 v[40:43], v[148:151], v[136:139], v[40:43]
    ds_read_b128 v[172:175], v22 offset:6144
    v_and_b32 v13, 15, v2
    v_lshrrev_b32 v14, 4, v2
    v_lshlrev_b32 v17, 2, v14
    v_sub_u32 v18, v13, v17
    v_mfma_f32_16x16x32_bf16 v[44:47], v[148:151], v[140:143], v[44:47]
    ds_read_b128 v[176:179], v22 offset:8192
    s_add_u32 m0, s30, 114688
    s_add_u32 s40, s74, 4096
    buffer_load_dwordx4 v4, s[52:55], s40 offen lds
    v_mfma_f32_16x16x32_bf16 v[48:51], v[152:155], v[128:131], v[48:51]
    ds_read_b128 v[180:183], v22 offset:0
    s_mov_b32 s24, 0xf0000000
    v_mov_b32 v114, v18
    v_mfma_f32_16x16x32_bf16 v[52:55], v[152:155], v[132:135], v[52:55]
    ds_read_b64_tr_b16 v[184:185], v24 offset:0
    v_add_u32 v118, 8, v18
    v_subrev_u32 v115, 1, v18
    v_add_u32 v119, 7, v18
    v_mfma_f32_16x16x32_bf16 v[200:203], v[148:151], v[28:31], v[200:203]
    ds_read_b64_tr_b16 v[186:187], v24 offset:3840
    v_subrev_u32 v116, 2, v18
    v_add_u32 v120, 6, v18
    v_subrev_u32 v117, 3, v18
    v_mfma_f32_16x16x32_bf16 v[56:59], v[152:155], v[136:139], v[56:59]
    ds_read_b64_tr_b16 v[188:189], v24 offset:32
    s_add_u32 m0, s30, 106496
    s_add_u32 s40, s74, 3072
    buffer_load_dwordx4 v4, s[52:55], s40 offen lds
    v_mfma_f32_16x16x32_bf16 v[60:63], v[152:155], v[140:143], v[60:63]
    ds_read_b64_tr_b16 v[190:191], v24 offset:3872
    v_add_u32 v121, 5, v18
    v_lshrrev_b32 v114, 3, v114
    v_ashrrev_i32 v118, 31, v118
    v_lshrrev_b32 v115, 3, v115
    v_mfma_f32_16x16x32_bf16 v[64:67], v[156:159], v[128:131], v[64:67]
    ds_read_b64_tr_b16 v[192:193], v25 offset:0
    v_ashrrev_i32 v119, 31, v119
    v_lshrrev_b32 v116, 3, v116
    v_ashrrev_i32 v120, 31, v120
    v_lshrrev_b32 v117, 3, v117
    v_mfma_f32_16x16x32_bf16 v[68:71], v[156:159], v[132:135], v[68:71]
    ds_read_b64_tr_b16 v[194:195], v25 offset:3840
    buffer_load_dwordx4 v[212:215], v4, s[52:55], s71 offen offset:0
    v_mfma_f32_16x16x32_bf16 v[72:75], v[156:159], v[136:139], v[72:75]
    ds_read_b64_tr_b16 v[196:197], v25 offset:32
    v_ashrrev_i32 v121, 31, v121
    v_min_u32 v114, 1, v114
    v_bfi_b32 v118, v118, 0, s24
    v_min_u32 v115, 1, v115
    v_mfma_f32_16x16x32_bf16 v[76:79], v[156:159], v[140:143], v[76:79]
    ds_read_b64_tr_b16 v[198:199], v25 offset:3872
    v_bfi_b32 v119, v119, 0, s24
    v_min_u32 v116, 1, v116
    v_bfi_b32 v120, v120, 0, s24
    v_min_u32 v117, 1, v117
    v_mfma_f32_16x16x32_bf16 v[80:83], v[160:163], v[128:131], v[80:83]
    s_add_u32 s37, s37, 18432
    buffer_load_dwordx4 v[216:219], v4, s[52:55], s71 offen offset:1024
    v_mfma_f32_16x16x32_bf16 v[204:207], v[152:155], v[28:31], v[204:207]
    s_cmp_eq_u32 s37, 55296
    s_cselect_b32 s37, 0, s37
    v_bfi_b32 v121, v121, 0, s24
    v_mul_lo_u32 v114, v114, s24
    v_mfma_f32_16x16x32_bf16 v[84:87], v[160:163], v[132:135], v[84:87]
    s_sub_u32 s49, s49, 15360
    s_cselect_b32 s49, 46080, s49
    v_mul_lo_u32 v115, v115, s24
    v_mul_lo_u32 v116, v116, s24
    v_mul_lo_u32 v117, v117, s24
    v_mfma_f32_16x16x32_bf16 v[88:91], v[160:163], v[136:139], v[88:91]
    v_add_u32 v22, s37, v10
    s_bfe_u32 s62, s22, 0x10001
    s_or_b32 s63, s62, s21
    s_cselect_b32 s25, 0, s24
    v_or_b32 v122, s25, v118
    v_mfma_f32_16x16x32_bf16 v[92:95], v[160:163], v[140:143], v[92:95]
    v_add_u32 v24, s49, v15
    buffer_load_dwordx4 v[220:223], v4, s[52:55], s71 offen offset:2048
    v_mfma_f32_16x16x32_bf16 v[96:99], v[148:151], v[144:147], v[96:99]
    v_add_u32 v25, s49, v16
    v_mfma_f32_16x16x32_bf16 v[100:103], v[152:155], v[144:147], v[100:103]
    v_mfma_f32_16x16x32_bf16 v[104:107], v[156:159], v[144:147], v[104:107]
    v_mfma_f32_16x16x32_bf16 v[108:111], v[160:163], v[144:147], v[108:111]
    s_waitcnt vmcnt(14) lgkmcnt(0)
    s_barrier
    v_mfma_f32_16x16x32_bf16 v[32:35], v[184:187], v[164:167], v[32:35]
    ds_read_b128 v[128:131], v22 offset:2048
    v_or_b32 v123, s25, v119
    v_or_b32 v124, s25, v120
    v_or_b32 v125, s25, v121
    v_cvt_pk_bf16_f32 v126, v118, v119
    v_cvt_pk_bf16_f32 v127, v120, v121
    v_pk_ashrrev_i16 v126, 15, v126 op_sel_hi:[0,1]
    v_pk_ashrrev_i16 v127, 15, v127 op_sel_hi:[0,1]
    v_add_u32 v5, 16, v2
    s_add_u32 m0, s30, 98304
    s_add_u32 s40, s74, 2048
    buffer_load_dwordx4 v4, s[52:55], s40 offen lds
    v_mfma_f32_16x16x32_bf16 v[36:39], v[184:187], v[168:171], v[36:39]
    ds_read_b128 v[132:135], v22 offset:4096
    v_bfe_i32 v5, v5, 6, 1
    s_and_b32 s78, s22, 1
    s_lshl_b32 s63, s62, 2
    v_mfma_f32_16x16x32_bf16 v[40:43], v[184:187], v[172:175], v[40:43]
    ds_read_b128 v[136:139], v22 offset:6144
    s_add_u32 s63, s63, s78
    s_mul_i32 s63, s63, 7808
    s_lshr_b32 s77, s22, 2
    v_mfma_f32_16x16x32_bf16 v[44:47], v[184:187], v[176:179], v[44:47]
    ds_read_b128 v[140:143], v22 offset:8192
    s_mul_i32 s26, s77, 10240
    s_mul_i32 s77, s77, 80
    s_add_u32 s63, s63, s77
    v_mfma_f32_16x16x32_bf16 v[48:51], v[188:191], v[164:167], v[48:51]
    ds_read_b128 v[144:147], v22 offset:0
    buffer_load_dwordx4 v[224:227], v4, s[52:55], s71 offen offset:3072
    v_mfma_f32_16x16x32_bf16 v[52:55], v[188:191], v[168:171], v[52:55]
    ds_read_b64_tr_b16 v[148:149], v24 offset:0
    s_mul_i32 s77, s78, 3904
    s_sub_u32 s77, 58560, s77
    s_cmp_eq_u32 s62, 0
    s_cselect_b32 s77, s77, 0xffffc300
    v_mfma_f32_16x16x32_bf16 v[200:203], v[184:187], v[28:31], v[200:203]
    ds_read_b64_tr_b16 v[150:151], v24 offset:3840
    v_mul_u32_u24 v6, 488, v13
    v_lshl_add_u32 v6, v14, 3, v6
    v_add_u32 v6, s63, v6
    v_mfma_f32_16x16x32_bf16 v[56:59], v[188:191], v[172:175], v[56:59]
    ds_read_b64_tr_b16 v[152:153], v24 offset:32
    v_add_u32 v7, s77, v6
    v_lshrrev_b32 v18, 2, v2
    v_mul_u32_u24 v18, 488, v18
    v_mfma_f32_16x16x32_bf16 v[60:63], v[188:191], v[176:179], v[60:63]
    ds_read_b64_tr_b16 v[154:155], v24 offset:3872
    s_add_u32 s40, s71, 4096
    buffer_load_dwordx4 v[228:231], v4, s[52:55], s40 offen
    v_mfma_f32_16x16x32_bf16 v[64:67], v[192:195], v[164:167], v[64:67]
    ds_read_b64_tr_b16 v[156:157], v25 offset:0
    v_add_u32 v26, s63, v18
    v_add_u32 v27, s77, v26
    v_and_b32 v18, 3, v2
    v_mfma_f32_16x16x32_bf16 v[68:71], v[192:195], v[168:171], v[68:71]
    ds_read_b64_tr_b16 v[158:159], v25 offset:3840
    v_lshl_add_u32 v8, v18, 3, v26
    v_add_u32 v9, s77, v8
    s_lshl_b32 s63, s21, 3
    v_mfma_f32_16x16x32_bf16 v[72:75], v[192:195], v[172:175], v[72:75]
    ds_read_b64_tr_b16 v[160:161], v25 offset:32
    s_lshl_b32 s62, s62, 2
    s_add_u32 s63, s63, s62
    s_add_u32 s63, s63, s78
    v_mfma_f32_16x16x32_bf16 v[76:79], v[192:195], v[176:179], v[76:79]
    ds_read_b64_tr_b16 v[162:163], v25 offset:3872
    buffer_load_dwordx4 v[232:235], v4, s[52:55], s72 offen offset:0
    v_mfma_f32_16x16x32_bf16 v[80:83], v[196:199], v[164:167], v[80:83]
    s_sub_u32 s49, s49, 15360
    s_cselect_b32 s49, 46080, s49
    s_mul_i32 s63, s63, 69632
    s_add_u32 s26, s26, s63
    s_mul_i32 s63, s3, 1280
    v_mfma_f32_16x16x32_bf16 v[204:207], v[188:191], v[28:31], v[204:207]
    v_add_u32 v22, s37, v11
    s_add_u32 s26, s26, s63
    s_add_u32 s27, s26, 2*69632
    v_mul_u32_u24 v23, 139264, v14
    v_mfma_f32_16x16x32_bf16 v[84:87], v[196:199], v[168:171], v[84:87]
    v_add_u32 v24, s49, v15
    v_lshl_add_u32 v23, v13, 4, v23
    s_mov_b32 s24, 0x3ea52b5c
    s_mov_b32 s25, 0x3ea52b5c
    v_mfma_f32_16x16x32_bf16 v[88:91], v[196:199], v[172:175], v[88:91]
    v_add_u32 v25, s49, v16
    buffer_load_dwordx4 v[236:239], v4, s[52:55], s72 offen offset:1024
    v_mfma_f32_16x16x32_bf16 v[92:95], v[196:199], v[176:179], v[92:95]
    v_mfma_f32_16x16x32_bf16 v[96:99], v[184:187], v[180:183], v[96:99]
    v_mfma_f32_16x16x32_bf16 v[100:103], v[188:191], v[180:183], v[100:103]
    v_mfma_f32_16x16x32_bf16 v[104:107], v[192:195], v[180:183], v[104:107]
    v_mfma_f32_16x16x32_bf16 v[108:111], v[196:199], v[180:183], v[108:111]
    s_waitcnt vmcnt(10) lgkmcnt(0)
    s_barrier
    v_mfma_f32_16x16x32_bf16 v[32:35], v[148:151], v[128:131], v[32:35]
    ds_read_b128 v[164:167], v22 offset:2048
    v_lshrrev_b32 v10, 4, v2
    v_lshlrev_b32 v12, 4, v10
    v_add_u32 v18, 70656, v12
    v_lshl_add_u32 v18, v1, 7, v18
    v_xor_b32 v17, 512, v18
    v_mfma_f32_16x16x32_bf16 v[36:39], v[148:151], v[132:135], v[36:39]
    ds_read_b128 v[168:171], v22 offset:4096
    buffer_load_dwordx4 v[240:243], v4, s[52:55], s72 offen offset:2048
    v_mfma_f32_16x16x32_bf16 v[40:43], v[148:151], v[136:139], v[40:43]
G1QB_cv:
    v_cmp_ne_u32 vcc, s76, v253
    v_cmp_ne_u32 s[40:41], s76, v255
    s_or_b64 vcc, vcc, s[40:41]
    s_cbranch_scc1 G1QB_cs
G1QB_co:
    v_and_b32 v255, s50, v252
    v_lshlrev_b32 v253, 16, v254
    ds_read_b128 v[172:175], v22 offset:6144
    v_and_b32 v11, 15, v2
    v_mfma_f32_16x16x32_bf16 v[44:47], v[148:151], v[140:143], v[44:47]
    v_lshlrev_b32 v252, 16, v252
    v_and_b32 v254, s50, v254
    ds_read_b128 v[176:179], v22 offset:8192
    v_lshlrev_b32 v19, 2, v11
    v_mfma_f32_16x16x32_bf16 v[48:51], v[152:155], v[128:131], v[48:51]
    ds_read_b128 v[180:183], v22 offset:0
    v_lshrrev_b32 v13, 2, v1
    v_mfma_f32_16x16x32_bf16 v[52:55], v[152:155], v[132:135], v[52:55]
    ds_read_b64_tr_b16 v[184:185], v24 offset:0
    v_lshl_add_u32 v11, v13, 6, v11
    v_mfma_f32_16x16x32_bf16 v[200:203], v[148:151], v[28:31], v[200:203]
    ds_read_b64_tr_b16 v[186:187], v24 offset:3840
    v_and_b32 v13, 3, v1
    v_mfma_f32_16x16x32_bf16 v[56:59], v[152:155], v[136:139], v[56:59]
    ds_read_b64_tr_b16 v[188:189], v24 offset:32
    buffer_load_dwordx4 v[244:247], v4, s[52:55], s72 offen offset:3072
    v_mfma_f32_16x16x32_bf16 v[60:63], v[152:155], v[140:143], v[60:63]
    ds_read_b64_tr_b16 v[190:191], v24 offset:3872
    v_mfma_f32_16x16x32_bf16 v[64:67], v[156:159], v[128:131], v[64:67]
    v_mfma_f32_16x16x16_bf16 v[200:203], v[252:253], v[28:29], v[200:203]
    ds_read_b64_tr_b16 v[192:193], v25 offset:0
    v_mul_u32_u24 v14, 488, v11
    v_mfma_f32_16x16x32_bf16 v[68:71], v[156:159], v[132:135], v[68:71]
    ds_read_b64_tr_b16 v[194:195], v25 offset:3840
    v_lshl_add_u32 v14, v10, 3, v14
    v_mfma_f32_16x16x32_bf16 v[72:75], v[156:159], v[136:139], v[72:75]
    ds_read_b64_tr_b16 v[196:197], v25 offset:32
    v_lshl_add_u32 v14, v13, 7, v14
    v_mfma_f32_16x16x32_bf16 v[76:79], v[156:159], v[140:143], v[76:79]
    ds_read_b64_tr_b16 v[198:199], v25 offset:3872
    v_add_u32 v20, s56, v14
    v_mfma_f32_16x16x32_bf16 v[80:83], v[160:163], v[128:131], v[80:83]
    v_add_u32 v21, s57, v14
    v_mfma_f32_16x16x32_bf16 v[204:207], v[152:155], v[28:31], v[204:207]
    s_add_u32 s40, s72, 4096
    buffer_load_dwordx4 v[248:251], v4, s[52:55], s40 offen
    v_mfma_f32_16x16x32_bf16 v[84:87], v[160:163], v[132:135], v[84:87]
    v_mfma_f32_16x16x32_bf16 v[88:91], v[160:163], v[136:139], v[88:91]
    v_mfma_f32_16x16x32_bf16 v[92:95], v[160:163], v[140:143], v[92:95]
    v_mfma_f32_16x16x16_bf16 v[204:207], v[254:255], v[28:29], v[204:207]
    v_mfma_f32_16x16x32_bf16 v[96:99], v[148:151], v[144:147], v[96:99]
    v_mfma_f32_16x16x32_bf16 v[100:103], v[152:155], v[144:147], v[100:103]
    v_mfma_f32_16x16x32_bf16 v[104:107], v[156:159], v[144:147], v[104:107]
    v_mfma_f32_16x16x32_bf16 v[108:111], v[160:163], v[144:147], v[108:111]
    s_waitcnt lgkmcnt(0)
    s_setprio 3
    s_barrier
    v_mfma_f32_16x16x32_bf16 v[200:203], v[184:187], v[28:31], v[200:203]
    v_mfma_f32_16x16x32_bf16 v[204:207], v[188:191], v[28:31], v[204:207]
    v_mfma_f32_16x16x32_bf16 v[32:35], v[184:187], v[164:167], v[32:35]
    ds_bpermute_b32 v129, v19, v112 offset:0
    v_mfma_f32_16x16x32_bf16 v[36:39], v[184:187], v[168:171], v[36:39]
    ds_bpermute_b32 v133, v19, v112 offset:64
    v_mfma_f32_16x16x32_bf16 v[40:43], v[184:187], v[172:175], v[40:43]
    ds_bpermute_b32 v137, v19, v112 offset:128
    v_mfma_f32_16x16x32_bf16 v[44:47], v[184:187], v[176:179], v[44:47]
    ds_bpermute_b32 v141, v19, v112 offset:192
    v_mfma_f32_16x16x32_bf16 v[48:51], v[188:191], v[164:167], v[48:51]
    s_add_u32 m0, s30, 90112
    s_add_u32 s40, s74, 1024
    buffer_load_dwordx4 v4, s[52:55], s40 offen lds
    v_mfma_f32_16x16x32_bf16 v[52:55], v[188:191], v[168:171], v[52:55]
    s_add_u32 m0, s30, 81920
    s_add_u32 s40, s74, 0
    buffer_load_dwordx4 v4, s[52:55], s40 offen lds
    v_mfma_f32_16x16x32_bf16 v[56:59], v[188:191], v[172:175], v[56:59]
    s_add_u32 m0, s30, 73728
    s_add_u32 s40, s80, 4096
    buffer_load_dwordx4 v4, s[52:55], s40 offen lds
    v_mfma_f32_16x16x32_bf16 v[60:63], v[188:191], v[176:179], v[60:63]
    s_mov_b32 exec_lo, 0x00010001
    s_mov_b32 exec_hi, 0x00010001
    ds_write_b128 v17, v[200:203] offset:0
    ds_write_b128 v17, v[204:207] offset:64
    s_mov_b64 exec, -1
    v_mfma_f32_16x16x32_bf16 v[64:67], v[192:195], v[164:167], v[64:67]
    s_waitcnt lgkmcnt(0)
    s_barrier
    v_mfma_f32_16x16x32_bf16 v[68:71], v[192:195], v[168:171], v[68:71]
    ds_read_b128 v[148:151], v18 offset:0
    ds_read_b128 v[152:155], v18 offset:64
    v_mfma_f32_16x16x32_bf16 v[72:75], v[192:195], v[172:175], v[72:75]
    v_lshlrev_b32 v128, 16, v129
    v_and_b32 v130, s50, v129
    v_mfma_f32_16x16x32_bf16 v[76:79], v[192:195], v[176:179], v[76:79]
    v_rcp_f32 v130, v130
    v_lshlrev_b32 v132, 16, v133
    v_mfma_f32_16x16x32_bf16 v[80:83], v[196:199], v[164:167], v[80:83]
    v_and_b32 v134, s50, v133
    v_rcp_f32 v134, v134
    v_mfma_f32_16x16x32_bf16 v[84:87], v[196:199], v[168:171], v[84:87]
    v_lshlrev_b32 v136, 16, v137
    v_and_b32 v138, s50, v137
    v_mfma_f32_16x16x32_bf16 v[88:91], v[196:199], v[172:175], v[88:91]
    v_rcp_f32 v138, v138
    v_lshlrev_b32 v140, 16, v141
    v_mfma_f32_16x16x32_bf16 v[92:95], v[196:199], v[176:179], v[92:95]
    v_and_b32 v142, s50, v141
    v_rcp_f32 v142, v142
    v_mfma_f32_16x16x32_bf16 v[96:99], v[184:187], v[180:183], v[96:99]
    v_lshlrev_b32 v144, 16, v113
    v_and_b32 v146, s50, v113
    v_mfma_f32_16x16x32_bf16 v[100:103], v[188:191], v[180:183], v[100:103]
    v_rcp_f32 v146, v146
    v_mfma_f32_16x16x32_bf16 v[104:107], v[192:195], v[180:183], v[104:107]
    v_mfma_f32_16x16x32_bf16 v[108:111], v[196:199], v[180:183], v[108:111]
    s_waitcnt lgkmcnt(0)
    v_pk_fma_f32 v[32:33], v[200:201], v[128:129], v[32:33] op_sel:[0,0,0] op_sel_hi:[1,0,1] neg_lo:[0,1,0] neg_hi:[0,1,0]
    v_pk_fma_f32 v[34:35], v[202:203], v[128:129], v[34:35] op_sel:[0,0,0] op_sel_hi:[1,0,1] neg_lo:[0,1,0] neg_hi:[0,1,0]
    v_pk_mul_f32 v[32:33], v[32:33], v[130:131] op_sel:[0,0] op_sel_hi:[1,0]
    v_pk_mul_f32 v[34:35], v[34:35], v[130:131] op_sel:[0,0] op_sel_hi:[1,0]
    v_cvt_pk_bf16_f32 v32, v32, v33
    v_cvt_pk_bf16_f32 v33, v34, v35
    ds_write_b64 v20, v[32:33] offset:0
    v_pk_fma_f32 v[36:37], v[200:201], v[132:133], v[36:37] op_sel:[0,0,0] op_sel_hi:[1,0,1] neg_lo:[0,1,0] neg_hi:[0,1,0]
    v_pk_fma_f32 v[38:39], v[202:203], v[132:133], v[38:39] op_sel:[0,0,0] op_sel_hi:[1,0,1] neg_lo:[0,1,0] neg_hi:[0,1,0]
    v_pk_mul_f32 v[36:37], v[36:37], v[134:135] op_sel:[0,0] op_sel_hi:[1,0]
    v_pk_mul_f32 v[38:39], v[38:39], v[134:135] op_sel:[0,0] op_sel_hi:[1,0]
    v_cvt_pk_bf16_f32 v36, v36, v37
    v_cvt_pk_bf16_f32 v37, v38, v39
    ds_write_b64 v20, v[36:37] offset:7808
    v_pk_fma_f32 v[40:41], v[200:201], v[136:137], v[40:41] op_sel:[0,0,0] op_sel_hi:[1,0,1] neg_lo:[0,1,0] neg_hi:[0,1,0]
    v_pk_fma_f32 v[42:43], v[202:203], v[136:137], v[42:43] op_sel:[0,0,0] op_sel_hi:[1,0,1] neg_lo:[0,1,0] neg_hi:[0,1,0]
    v_pk_mul_f32 v[40:41], v[40:41], v[138:139] op_sel:[0,0] op_sel_hi:[1,0]
    v_pk_mul_f32 v[42:43], v[42:43], v[138:139] op_sel:[0,0] op_sel_hi:[1,0]
    v_cvt_pk_bf16_f32 v40, v40, v41
    v_cvt_pk_bf16_f32 v41, v42, v43
    ds_write_b64 v20, v[40:41] offset:15616
    v_pk_fma_f32 v[44:45], v[200:201], v[140:141], v[44:45] op_sel:[0,0,0] op_sel_hi:[1,0,1] neg_lo:[0,1,0] neg_hi:[0,1,0]
    v_pk_fma_f32 v[46:47], v[202:203], v[140:141], v[46:47] op_sel:[0,0,0] op_sel_hi:[1,0,1] neg_lo:[0,1,0] neg_hi:[0,1,0]
    v_pk_mul_f32 v[44:45], v[44:45], v[142:143] op_sel:[0,0] op_sel_hi:[1,0]
    v_pk_mul_f32 v[46:47], v[46:47], v[142:143] op_sel:[0,0] op_sel_hi:[1,0]
    v_cvt_pk_bf16_f32 v44, v44, v45
    v_cvt_pk_bf16_f32 v45, v46, v47
    ds_write_b64 v20, v[44:45] offset:23424
    v_pk_fma_f32 v[96:97], v[200:201], v[144:145], v[96:97] op_sel:[0,0,0] op_sel_hi:[1,0,1] neg_lo:[0,1,0] neg_hi:[0,1,0]
    v_pk_fma_f32 v[98:99], v[202:203], v[144:145], v[98:99] op_sel:[0,0,0] op_sel_hi:[1,0,1] neg_lo:[0,1,0] neg_hi:[0,1,0]
    v_pk_mul_f32 v[96:97], v[96:97], v[146:147] op_sel:[0,0] op_sel_hi:[1,0]
    v_pk_mul_f32 v[98:99], v[98:99], v[146:147] op_sel:[0,0] op_sel_hi:[1,0]
    v_cvt_pk_bf16_f32 v96, v96, v97
    v_cvt_pk_bf16_f32 v97, v98, v99
    ds_write_b64 v20, v[96:97] offset:62464
    buffer_load_dwordx4 v[192:195], v4, s[52:55], s70 offen offset:0
    v_pk_fma_f32 v[48:49], v[204:205], v[128:129], v[48:49] op_sel:[0,0,0] op_sel_hi:[1,0,1] neg_lo:[0,1,0] neg_hi:[0,1,0]
    v_pk_fma_f32 v[50:51], v[206:207], v[128:129], v[50:51] op_sel:[0,0,0] op_sel_hi:[1,0,1] neg_lo:[0,1,0] neg_hi:[0,1,0]
    v_pk_mul_f32 v[48:49], v[48:49], v[130:131] op_sel:[0,0] op_sel_hi:[1,0]
    v_pk_mul_f32 v[50:51], v[50:51], v[130:131] op_sel:[0,0] op_sel_hi:[1,0]
    v_cvt_pk_bf16_f32 v48, v48, v49
    v_cvt_pk_bf16_f32 v49, v50, v51
    ds_write_b64 v20, v[48:49] offset:32
    v_pk_fma_f32 v[52:53], v[204:205], v[132:133], v[52:53] op_sel:[0,0,0] op_sel_hi:[1,0,1] neg_lo:[0,1,0] neg_hi:[0,1,0]
    v_pk_fma_f32 v[54:55], v[206:207], v[132:133], v[54:55] op_sel:[0,0,0] op_sel_hi:[1,0,1] neg_lo:[0,1,0] neg_hi:[0,1,0]
    v_pk_mul_f32 v[52:53], v[52:53], v[134:135] op_sel:[0,0] op_sel_hi:[1,0]
    v_pk_mul_f32 v[54:55], v[54:55], v[134:135] op_sel:[0,0] op_sel_hi:[1,0]
    v_cvt_pk_bf16_f32 v52, v52, v53
    v_cvt_pk_bf16_f32 v53, v54, v55
    ds_write_b64 v20, v[52:53] offset:7840
    v_pk_fma_f32 v[56:57], v[204:205], v[136:137], v[56:57] op_sel:[0,0,0] op_sel_hi:[1,0,1] neg_lo:[0,1,0] neg_hi:[0,1,0]
    v_pk_fma_f32 v[58:59], v[206:207], v[136:137], v[58:59] op_sel:[0,0,0] op_sel_hi:[1,0,1] neg_lo:[0,1,0] neg_hi:[0,1,0]
    v_pk_mul_f32 v[56:57], v[56:57], v[138:139] op_sel:[0,0] op_sel_hi:[1,0]
    v_pk_mul_f32 v[58:59], v[58:59], v[138:139] op_sel:[0,0] op_sel_hi:[1,0]
    v_cvt_pk_bf16_f32 v56, v56, v57
    v_cvt_pk_bf16_f32 v57, v58, v59
    ds_write_b64 v20, v[56:57] offset:15648
    v_pk_fma_f32 v[60:61], v[204:205], v[140:141], v[60:61] op_sel:[0,0,0] op_sel_hi:[1,0,1] neg_lo:[0,1,0] neg_hi:[0,1,0]
    v_pk_fma_f32 v[62:63], v[206:207], v[140:141], v[62:63] op_sel:[0,0,0] op_sel_hi:[1,0,1] neg_lo:[0,1,0] neg_hi:[0,1,0]
    v_pk_mul_f32 v[60:61], v[60:61], v[142:143] op_sel:[0,0] op_sel_hi:[1,0]
    v_pk_mul_f32 v[62:63], v[62:63], v[142:143] op_sel:[0,0] op_sel_hi:[1,0]
    v_cvt_pk_bf16_f32 v60, v60, v61
    v_cvt_pk_bf16_f32 v61, v62, v63
    ds_write_b64 v20, v[60:61] offset:23456
    v_pk_fma_f32 v[100:101], v[204:205], v[144:145], v[100:101] op_sel:[0,0,0] op_sel_hi:[1,0,1] neg_lo:[0,1,0] neg_hi:[0,1,0]
    v_pk_fma_f32 v[102:103], v[206:207], v[144:145], v[102:103] op_sel:[0,0,0] op_sel_hi:[1,0,1] neg_lo:[0,1,0] neg_hi:[0,1,0]
    v_pk_mul_f32 v[100:101], v[100:101], v[146:147] op_sel:[0,0] op_sel_hi:[1,0]
    v_pk_mul_f32 v[102:103], v[102:103], v[146:147] op_sel:[0,0] op_sel_hi:[1,0]
    v_cvt_pk_bf16_f32 v100, v100, v101
    v_cvt_pk_bf16_f32 v101, v102, v103
    ds_write_b64 v20, v[100:101] offset:62496
    buffer_load_dwordx4 v[196:199], v4, s[52:55], s70 offen offset:1024
    v_pk_fma_f32 v[64:65], v[148:149], v[128:129], v[64:65] op_sel:[0,0,0] op_sel_hi:[1,0,1] neg_lo:[0,1,0] neg_hi:[0,1,0]
    v_pk_fma_f32 v[66:67], v[150:151], v[128:129], v[66:67] op_sel:[0,0,0] op_sel_hi:[1,0,1] neg_lo:[0,1,0] neg_hi:[0,1,0]
    v_pk_mul_f32 v[64:65], v[64:65], v[130:131] op_sel:[0,0] op_sel_hi:[1,0]
    v_pk_mul_f32 v[66:67], v[66:67], v[130:131] op_sel:[0,0] op_sel_hi:[1,0]
    v_cvt_pk_bf16_f32 v64, v64, v65
    v_cvt_pk_bf16_f32 v65, v66, v67
    ds_write_b64 v21, v[64:65] offset:0
    v_pk_fma_f32 v[68:69], v[148:149], v[132:133], v[68:69] op_sel:[0,0,0] op_sel_hi:[1,0,1] neg_lo:[0,1,0] neg_hi:[0,1,0]
    v_pk_fma_f32 v[70:71], v[150:151], v[132:133], v[70:71] op_sel:[0,0,0] op_sel_hi:[1,0,1] neg_lo:[0,1,0] neg_hi:[0,1,0]
    v_pk_mul_f32 v[68:69], v[68:69], v[134:135] op_sel:[0,0] op_sel_hi:[1,0]
    v_pk_mul_f32 v[70:71], v[70:71], v[134:135] op_sel:[0,0] op_sel_hi:[1,0]
    v_cvt_pk_bf16_f32 v68, v68, v69
    v_cvt_pk_bf16_f32 v69, v70, v71
    ds_write_b64 v21, v[68:69] offset:7808
    v_pk_fma_f32 v[72:73], v[148:149], v[136:137], v[72:73] op_sel:[0,0,0] op_sel_hi:[1,0,1] neg_lo:[0,1,0] neg_hi:[0,1,0]
    v_pk_fma_f32 v[74:75], v[150:151], v[136:137], v[74:75] op_sel:[0,0,0] op_sel_hi:[1,0,1] neg_lo:[0,1,0] neg_hi:[0,1,0]
    v_pk_mul_f32 v[72:73], v[72:73], v[138:139] op_sel:[0,0] op_sel_hi:[1,0]
    v_pk_mul_f32 v[74:75], v[74:75], v[138:139] op_sel:[0,0] op_sel_hi:[1,0]
    v_cvt_pk_bf16_f32 v72, v72, v73
    v_cvt_pk_bf16_f32 v73, v74, v75
    ds_write_b64 v21, v[72:73] offset:15616
    v_pk_fma_f32 v[76:77], v[148:149], v[140:141], v[76:77] op_sel:[0,0,0] op_sel_hi:[1,0,1] neg_lo:[0,1,0] neg_hi:[0,1,0]
    v_pk_fma_f32 v[78:79], v[150:151], v[140:141], v[78:79] op_sel:[0,0,0] op_sel_hi:[1,0,1] neg_lo:[0,1,0] neg_hi:[0,1,0]
    v_pk_mul_f32 v[76:77], v[76:77], v[142:143] op_sel:[0,0] op_sel_hi:[1,0]
    v_pk_mul_f32 v[78:79], v[78:79], v[142:143] op_sel:[0,0] op_sel_hi:[1,0]
    v_cvt_pk_bf16_f32 v76, v76, v77
    v_cvt_pk_bf16_f32 v77, v78, v79
    ds_write_b64 v21, v[76:77] offset:23424
    v_pk_fma_f32 v[104:105], v[148:149], v[144:145], v[104:105] op_sel:[0,0,0] op_sel_hi:[1,0,1] neg_lo:[0,1,0] neg_hi:[0,1,0]
    v_pk_fma_f32 v[106:107], v[150:151], v[144:145], v[106:107] op_sel:[0,0,0] op_sel_hi:[1,0,1] neg_lo:[0,1,0] neg_hi:[0,1,0]
    v_pk_mul_f32 v[104:105], v[104:105], v[146:147] op_sel:[0,0] op_sel_hi:[1,0]
    v_pk_mul_f32 v[106:107], v[106:107], v[146:147] op_sel:[0,0] op_sel_hi:[1,0]
    v_cvt_pk_bf16_f32 v104, v104, v105
    v_cvt_pk_bf16_f32 v105, v106, v107
    ds_write_b64 v21, v[104:105] offset:62464
    v_pk_fma_f32 v[80:81], v[152:153], v[128:129], v[80:81] op_sel:[0,0,0] op_sel_hi:[1,0,1] neg_lo:[0,1,0] neg_hi:[0,1,0]
    v_pk_fma_f32 v[82:83], v[154:155], v[128:129], v[82:83] op_sel:[0,0,0] op_sel_hi:[1,0,1] neg_lo:[0,1,0] neg_hi:[0,1,0]
    v_pk_mul_f32 v[80:81], v[80:81], v[130:131] op_sel:[0,0] op_sel_hi:[1,0]
    v_pk_mul_f32 v[82:83], v[82:83], v[130:131] op_sel:[0,0] op_sel_hi:[1,0]
    v_cvt_pk_bf16_f32 v80, v80, v81
    v_cvt_pk_bf16_f32 v81, v82, v83
    ds_write_b64 v21, v[80:81] offset:32
    v_pk_fma_f32 v[84:85], v[152:153], v[132:133], v[84:85] op_sel:[0,0,0] op_sel_hi:[1,0,1] neg_lo:[0,1,0] neg_hi:[0,1,0]
    v_pk_fma_f32 v[86:87], v[154:155], v[132:133], v[86:87] op_sel:[0,0,0] op_sel_hi:[1,0,1] neg_lo:[0,1,0] neg_hi:[0,1,0]
    v_pk_mul_f32 v[84:85], v[84:85], v[134:135] op_sel:[0,0] op_sel_hi:[1,0]
    v_pk_mul_f32 v[86:87], v[86:87], v[134:135] op_sel:[0,0] op_sel_hi:[1,0]
    v_cvt_pk_bf16_f32 v84, v84, v85
    v_cvt_pk_bf16_f32 v85, v86, v87
    ds_write_b64 v21, v[84:85] offset:7840
    v_pk_fma_f32 v[88:89], v[152:153], v[136:137], v[88:89] op_sel:[0,0,0] op_sel_hi:[1,0,1] neg_lo:[0,1,0] neg_hi:[0,1,0]
    v_pk_fma_f32 v[90:91], v[154:155], v[136:137], v[90:91] op_sel:[0,0,0] op_sel_hi:[1,0,1] neg_lo:[0,1,0] neg_hi:[0,1,0]
    v_pk_mul_f32 v[88:89], v[88:89], v[138:139] op_sel:[0,0] op_sel_hi:[1,0]
    v_pk_mul_f32 v[90:91], v[90:91], v[138:139] op_sel:[0,0] op_sel_hi:[1,0]
    v_cvt_pk_bf16_f32 v88, v88, v89
    v_cvt_pk_bf16_f32 v89, v90, v91
    ds_write_b64 v21, v[88:89] offset:15648
    v_pk_fma_f32 v[92:93], v[152:153], v[140:141], v[92:93] op_sel:[0,0,0] op_sel_hi:[1,0,1] neg_lo:[0,1,0] neg_hi:[0,1,0]
    v_pk_fma_f32 v[94:95], v[154:155], v[140:141], v[94:95] op_sel:[0,0,0] op_sel_hi:[1,0,1] neg_lo:[0,1,0] neg_hi:[0,1,0]
    v_pk_mul_f32 v[92:93], v[92:93], v[142:143] op_sel:[0,0] op_sel_hi:[1,0]
    v_pk_mul_f32 v[94:95], v[94:95], v[142:143] op_sel:[0,0] op_sel_hi:[1,0]
    v_cvt_pk_bf16_f32 v92, v92, v93
    v_cvt_pk_bf16_f32 v93, v94, v95
    ds_write_b64 v21, v[92:93] offset:23456
    v_pk_fma_f32 v[108:109], v[152:153], v[144:145], v[108:109] op_sel:[0,0,0] op_sel_hi:[1,0,1] neg_lo:[0,1,0] neg_hi:[0,1,0]
    v_pk_fma_f32 v[110:111], v[154:155], v[144:145], v[110:111] op_sel:[0,0,0] op_sel_hi:[1,0,1] neg_lo:[0,1,0] neg_hi:[0,1,0]
    v_pk_mul_f32 v[108:109], v[108:109], v[146:147] op_sel:[0,0] op_sel_hi:[1,0]
    v_pk_mul_f32 v[110:111], v[110:111], v[146:147] op_sel:[0,0] op_sel_hi:[1,0]
    v_cvt_pk_bf16_f32 v108, v108, v109
    v_cvt_pk_bf16_f32 v109, v110, v111
    ds_write_b64 v21, v[108:109] offset:62496
    s_branch G1_att
G1_vD:
    s_add_u32 s40, s30, s36
    s_add_u32 m0, s40, 0
    s_nop 0
    buffer_load_dwordx4 v5, s[8:11], s32 offen lds
    s_cmp_lg_u32 s22, 0
    s_cbranch_scc1 1f
    s_add_u32 m0, s36, 8192
    s_nop 0
    buffer_load_dwordx4 v8, s[44:47], s34 offen lds
1:
    s_add_u32 s40, s30, s36
    s_add_u32 m0, s40, 9216
    s_nop 0
    buffer_load_dwordx4 v6, s[8:11], s31 offen lds
    s_add_u32 s40, s30, s48
    s_add_u32 m0, s40, 55296
    s_nop 0
    buffer_load_dwordx4 v7, s[12:15], s33 offen lds
    s_add_u32 s40, s40, 62464
    s_add_u32 s41, s36, 17408
    s_add_u32 s42, s34, 102400
    s_cmp_eq_u32 s22, 0
    s_cselect_b32 m0, s41, s40
    s_cselect_b32 s41, s42, s33
    buffer_load_dwordx4 v9, s[44:47], s41 offen lds
    s_add_u32 s33, s33, 122880
    s_sub_u32 s48, s48, 15360
    s_cselect_b32 s48, 46080, s48
    s_add_u32 s32, s32, 128
    s_add_u32 s31, s31, 128
    s_add_u32 s34, s34, 128
    s_add_u32 s36, s36, 18432
    s_cmp_eq_u32 s36, 55296
    s_cselect_b32 s36, 0, s36
    v_lshrrev_b32 v14, 2, v1
    v_lshl_add_u32 v10, v14, 13, v3
    v_xor_b32 v11, 64, v10
    v_lshrrev_b32 v16, 5, v2
    v_bfe_u32 v17, v2, 4, 1
    v_bfe_u32 v18, v2, 2, 2
    v_lshl_add_u32 v18, v16, 4, v18
    v_lshl_add_u32 v18, v17, 2, v18
    v_mul_u32_u24 v18, 480, v18
    v_and_b32 v17, 3, v2
    v_lshl_add_u32 v18, v17, 3, v18
    v_and_b32 v17, 3, v1
    v_lshl_add_u32 v18, v17, 7, v18
    v_add_u32 v18, 55296, v18
    s_lshr_b32 s56, s22, 2
    s_lshl_b32 s56, s56, 6
    s_cmp_eq_u32 s22, 7
    s_cselect_b32 s56, 0, s56
    s_xor_b32 s57, s56, 64
    v_add_u32 v15, s56, v18
    v_add_u32 v16, s57, v18
    v_mov_b32 v32, 0
    v_mov_b32 v33, 0
    v_mov_b32 v34, 0
    v_mov_b32 v35, 0
    v_mov_b32 v36, 0
    v_mov_b32 v37, 0
    v_mov_b32 v38, 0
    v_mov_b32 v39, 0
    v_mov_b32 v40, 0
    v_mov_b32 v41, 0
    v_mov_b32 v42, 0
    v_mov_b32 v43, 0
    v_mov_b32 v44, 0
    v_mov_b32 v45, 0
    v_mov_b32 v46, 0
    v_mov_b32 v47, 0
    v_mov_b32 v48, 0
    v_mov_b32 v49, 0
    v_mov_b32 v50, 0
    v_mov_b32 v51, 0
    v_mov_b32 v52, 0
    v_mov_b32 v53, 0
    v_mov_b32 v54, 0
    v_mov_b32 v55, 0
    v_mov_b32 v56, 0
    v_mov_b32 v57, 0
    v_mov_b32 v58, 0
    v_mov_b32 v59, 0
    v_mov_b32 v60, 0
    v_mov_b32 v61, 0
    v_mov_b32 v62, 0
    v_mov_b32 v63, 0
    v_mov_b32 v64, 0
    v_mov_b32 v65, 0
    v_mov_b32 v66, 0
    v_mov_b32 v67, 0
    v_mov_b32 v68, 0
    v_mov_b32 v69, 0
    v_mov_b32 v70, 0
    v_mov_b32 v71, 0
    v_mov_b32 v72, 0
    v_mov_b32 v73, 0
    v_mov_b32 v74, 0
    v_mov_b32 v75, 0
    v_mov_b32 v76, 0
    v_mov_b32 v77, 0
    v_mov_b32 v78, 0
    v_mov_b32 v79, 0
    v_mov_b32 v80, 0
    v_mov_b32 v81, 0
    v_mov_b32 v82, 0
    v_mov_b32 v83, 0
    v_mov_b32 v84, 0
    v_mov_b32 v85, 0
    v_mov_b32 v86, 0
    v_mov_b32 v87, 0
    v_mov_b32 v88, 0
    v_mov_b32 v89, 0
    v_mov_b32 v90, 0
    v_mov_b32 v91, 0
    v_mov_b32 v200, 0
    v_mov_b32 v201, 0
    v_mov_b32 v202, 0
    v_mov_b32 v203, 0
    v_mov_b32 v204, 0
    v_mov_b32 v205, 0
    v_mov_b32 v206, 0
    v_mov_b32 v207, 0
    v_mov_b32 v28, 0x3f803f80
    v_mov_b32 v29, 0x3f803f80
    v_mov_b32 v30, 0x3f803f80
    v_mov_b32 v31, 0x3f803f80
    s_mov_b32 s35, 0
    s_sub_u32 s28, 14, s21
    s_bitcmp1_b32 s21, 0
    s_cselect_b32 s28, 31, s28
    s_bitset1_b32 s78, s28
    s_lshl_b32 s29, s3, 3
    s_add_u32 s29, s29, s22
    s_lshl_b32 s29, s29, 11
    s_add_u32 s29, s29, 282624
    s_add_u32 s40, s30, s36
    s_add_u32 m0, s40, 0
    s_nop 0
    buffer_load_dwordx4 v5, s[8:11], s32 offen lds
    s_add_u32 s40, s30, s48
    s_add_u32 m0, s40, 55296
    s_nop 0
    buffer_load_dwordx4 v7, s[12:15], s33 offen lds
    s_add_u32 s40, s40, 62464
    s_add_u32 s41, s36, 8192
    s_add_u32 s42, s34, 0
    s_cmp_eq_u32 s22, 0
    s_cselect_b32 m0, s41, s40
    s_cselect_b32 s41, s42, s33
    buffer_load_dwordx4 v8, s[44:47], s41 offen lds
    s_add_u32 s33, s33, 122880
    s_sub_u32 s48, s48, 15360
    s_cselect_b32 s48, 46080, s48
    s_add_u32 s40, s30, s36
    s_add_u32 m0, s40, 9216
    s_nop 0
    buffer_load_dwordx4 v6, s[8:11], s31 offen lds
    s_add_u32 s40, s30, s48
    s_add_u32 m0, s40, 55296
    s_nop 0
    buffer_load_dwordx4 v7, s[12:15], s33 offen lds
    s_add_u32 s40, s40, 62464
    s_add_u32 s41, s36, 17408
    s_add_u32 s42, s34, 102400
    s_cmp_eq_u32 s22, 0
    s_cselect_b32 m0, s41, s40
    s_cselect_b32 s41, s42, s33
    buffer_load_dwordx4 v9, s[44:47], s41 offen lds
    s_add_u32 s33, s33, 122880
    s_sub_u32 s48, s48, 15360
    s_cselect_b32 s48, 46080, s48
    s_add_u32 s32, s32, 128
    s_add_u32 s31, s31, 128
    s_add_u32 s34, s34, 128
    s_add_u32 s36, s36, 18432
    s_cmp_eq_u32 s36, 55296
    s_cselect_b32 s36, 0, s36
    s_waitcnt vmcnt(10)
    v_lshlrev_b32 v134, 16, v128
    v_and_b32 v135, s50, v128
    v_lshlrev_b32 v136, 16, v129
    v_and_b32 v137, s50, v129
    v_lshlrev_b32 v138, 16, v130
    v_and_b32 v139, s50, v130
    v_lshlrev_b32 v140, 16, v131
    v_and_b32 v141, s50, v131
    v_lshlrev_b32 v142, 16, v132
    v_and_b32 v143, s50, v132
    v_add_f32 v144, v134, v135
    v_add_f32 v145, v136, v137
    v_add_f32 v144, v144, v138
    v_add_f32 v145, v145, v139
    v_add_f32 v144, v144, v140
    v_add_f32 v145, v145, v141
    v_add_f32 v144, v144, v142
    v_add_f32 v145, v145, v143
    v_add_f32 v144, v144, v145
    s_nop 1
    v_add_f32_dpp v144, v144, v144 row_ror:8 row_mask:0xf bank_mask:0xf
    s_nop 1
    v_add_f32_dpp v144, v144, v144 row_ror:4 row_mask:0xf bank_mask:0xf
    s_nop 1
    v_add_f32_dpp v144, v144, v144 row_ror:2 row_mask:0xf bank_mask:0xf
    s_nop 1
    v_add_f32_dpp v144, v144, v144 row_ror:1 row_mask:0xf bank_mask:0xf
    s_nop 1
    v_add_f32_dpp v144, v144, v144 row_bcast:15 row_mask:0xa bank_mask:0xf
    s_nop 1
    v_add_f32_dpp v144, v144, v144 row_bcast:31 row_mask:0xc bank_mask:0xf
    s_nop 1
    v_readlane_b32 s40, v144, 63
    v_mov_b32 v146, 0x3acccccd
    s_nop 0
    v_mul_f32 v147, s40, v146
    v_sub_f32 v134, v134, v147
    v_sub_f32 v135, v135, v147
    v_sub_f32 v136, v136, v147
    v_sub_f32 v137, v137, v147
    v_sub_f32 v138, v138, v147
    v_sub_f32 v139, v139, v147
    v_sub_f32 v140, v140, v147
    v_sub_f32 v141, v141, v147
    v_sub_f32 v142, v142, v147
    v_sub_f32 v143, v143, v147
    v_mul_f32 v144, v134, v134
    v_mul_f32 v145, v135, v135
    v_fmac_f32 v144, v136, v136
    v_fmac_f32 v145, v137, v137
    v_fmac_f32 v144, v138, v138
    v_fmac_f32 v145, v139, v139
    v_fmac_f32 v144, v140, v140
    v_fmac_f32 v145, v141, v141
    v_fmac_f32 v144, v142, v142
    v_fmac_f32 v145, v143, v143
    v_add_f32 v144, v144, v145
    s_nop 1
    v_add_f32_dpp v144, v144, v144 row_ror:8 row_mask:0xf bank_mask:0xf
    s_nop 1
    v_add_f32_dpp v144, v144, v144 row_ror:4 row_mask:0xf bank_mask:0xf
    s_nop 1
    v_add_f32_dpp v144, v144, v144 row_ror:2 row_mask:0xf bank_mask:0xf
    s_nop 1
    v_add_f32_dpp v144, v144, v144 row_ror:1 row_mask:0xf bank_mask:0xf
    s_nop 1
    v_add_f32_dpp v144, v144, v144 row_bcast:15 row_mask:0xa bank_mask:0xf
    s_nop 1
    v_add_f32_dpp v144, v144, v144 row_bcast:31 row_mask:0xc bank_mask:0xf
    s_nop 1
    v_readlane_b32 s40, v144, 63
    s_nop 1
    v_mul_f32 v148, s40, v146
    v_cvt_pk_bf16_f32 v148, v148, v148
    v_lshlrev_b32 v148, 16, v148
    v_add_f32 v148, 0x3727c5ac, v148
    v_cvt_pk_bf16_f32 v148, v148, v148
    v_lshlrev_b32 v148, 16, v148
    v_sqrt_f32 v148, v148
    s_nop 0
    v_cvt_pk_bf16_f32 v238, v147, v148
    s_waitcnt vmcnt(6) lgkmcnt(0)
    s_add_u32 s76, s76, 0x9e3779b9
    v_add_u32 v22, s37, v10
    v_add_u32 v24, s49, v15
    v_add_u32 v25, s49, v16
    s_barrier
    ds_read_b128 v[128:131], v22 offset:2048
    ds_read_b128 v[132:135], v22 offset:4096
    ds_read_b128 v[136:139], v22 offset:6144
    ds_read_b128 v[140:143], v22 offset:8192
    ds_read_b128 v[144:147], v22 offset:0
    ds_read_b64_tr_b16 v[148:149], v24 offset:0
    ds_read_b64_tr_b16 v[150:151], v24 offset:3840
    ds_read_b64_tr_b16 v[152:153], v24 offset:32
    ds_read_b64_tr_b16 v[154:155], v24 offset:3872
    ds_read_b64_tr_b16 v[156:157], v25 offset:0
    ds_read_b64_tr_b16 v[158:159], v25 offset:3840
    s_add_u32 s40, s30, s36
    s_add_u32 m0, s40, 0
    s_nop 0
    buffer_load_dwordx4 v5, s[8:11], s32 offen lds
    s_add_u32 s40, s30, s48
    s_add_u32 m0, s40, 55296
    s_nop 0
    buffer_load_dwordx4 v7, s[12:15], s33 offen lds
    s_add_u32 s40, s40, 62464
    s_add_u32 s41, s36, 8192
    s_add_u32 s42, s34, 0
    s_cmp_eq_u32 s22, 0
    s_cselect_b32 m0, s41, s40
    s_cselect_b32 s41, s42, s33
    buffer_load_dwordx4 v8, s[44:47], s41 offen lds
    s_add_u32 s33, s33, 122880
    s_sub_u32 s48, s48, 15360
    s_cselect_b32 s48, 46080, s48
    s_sub_u32 s49, s49, 15360
    s_cselect_b32 s49, 46080, s49
    v_add_u32 v22, s37, v11
    v_add_u32 v24, s49, v15
    v_add_u32 v25, s49, v16
    s_cmp_eq_u32 s28, 0
    s_cbranch_scc1 G1QD_hz
    s_branch G1QD_ent
G1QD_loop:
    v_mfma_f32_16x16x32_bf16 v[84:87], v[184:187], v[176:179], v[84:87]
    v_mfma_f32_16x16x32_bf16 v[88:91], v[188:191], v[176:179], v[88:91]
G1QD_ent:
    s_waitcnt vmcnt(6) lgkmcnt(0)
    s_barrier
    v_mfma_f32_16x16x32_bf16 v[32:35], v[148:151], v[128:131], v[32:35]
    ds_read_b128 v[160:163], v22 offset:2048
    ds_read_b128 v[164:167], v22 offset:4096
    s_add_u32 s40, s30, s36
    s_add_u32 m0, s40, 9216
    s_nop 0
    buffer_load_dwordx4 v6, s[8:11], s31 offen lds
    v_mfma_f32_16x16x32_bf16 v[36:39], v[148:151], v[132:135], v[36:39]
    ds_read_b128 v[168:171], v22 offset:6144
    ds_read_b128 v[172:175], v22 offset:8192
    s_add_u32 s40, s30, s48
    s_add_u32 m0, s40, 55296
    s_nop 0
    buffer_load_dwordx4 v7, s[12:15], s33 offen lds
    v_mfma_f32_16x16x32_bf16 v[40:43], v[148:151], v[136:139], v[40:43]
    ds_read_b128 v[176:179], v22 offset:0
    ds_read_b64_tr_b16 v[180:181], v24 offset:0
    s_add_u32 s40, s40, 62464
    s_add_u32 s41, s36, 17408
    v_mfma_f32_16x16x32_bf16 v[44:47], v[148:151], v[140:143], v[44:47]
    ds_read_b64_tr_b16 v[182:183], v24 offset:3840
    ds_read_b64_tr_b16 v[184:185], v24 offset:32
    s_add_u32 s42, s34, 102400
    s_cmp_eq_u32 s22, 0
    s_cselect_b32 m0, s41, s40
    s_cselect_b32 s41, s42, s33
    v_mfma_f32_16x16x32_bf16 v[48:51], v[152:155], v[128:131], v[48:51]
    ds_read_b64_tr_b16 v[186:187], v24 offset:3872
    ds_read_b64_tr_b16 v[188:189], v25 offset:0
    buffer_load_dwordx4 v9, s[44:47], s41 offen lds
    s_add_u32 s33, s33, 122880
    v_mfma_f32_16x16x32_bf16 v[52:55], v[152:155], v[132:135], v[52:55]
    ds_read_b64_tr_b16 v[190:191], v25 offset:3840
    s_sub_u32 s48, s48, 15360
    s_cselect_b32 s48, 46080, s48
    s_add_u32 s32, s32, 128
    v_mfma_f32_16x16x32_bf16 v[56:59], v[152:155], v[136:139], v[56:59]
    s_add_u32 s37, s37, 18432
    s_add_u32 s31, s31, 128
    s_add_u32 s34, s34, 128
    v_mfma_f32_16x16x32_bf16 v[60:63], v[152:155], v[140:143], v[60:63]
    s_cmp_eq_u32 s37, 55296
    s_cselect_b32 s37, 0, s37
    s_add_u32 s36, s36, 18432
    s_cmp_eq_u32 s36, 55296
    s_cselect_b32 s36, 0, s36
    v_mfma_f32_16x16x32_bf16 v[64:67], v[156:159], v[128:131], v[64:67]
    s_sub_u32 s49, s49, 15360
    s_cselect_b32 s49, 46080, s49
    v_mfma_f32_16x16x32_bf16 v[68:71], v[156:159], v[132:135], v[68:71]
    v_add_u32 v22, s37, v10
    v_mfma_f32_16x16x32_bf16 v[72:75], v[156:159], v[136:139], v[72:75]
    v_add_u32 v24, s49, v15
    v_mfma_f32_16x16x32_bf16 v[76:79], v[156:159], v[140:143], v[76:79]
    v_add_u32 v25, s49, v16
    v_mfma_f32_16x16x32_bf16 v[80:83], v[148:151], v[144:147], v[80:83]
    v_mfma_f32_16x16x32_bf16 v[84:87], v[152:155], v[144:147], v[84:87]
    v_mfma_f32_16x16x32_bf16 v[88:91], v[156:159], v[144:147], v[88:91]
    s_waitcnt vmcnt(6) lgkmcnt(0)
    s_barrier
    v_mfma_f32_16x16x32_bf16 v[32:35], v[180:183], v[160:163], v[32:35]
    ds_read_b128 v[128:131], v22 offset:2048
    ds_read_b128 v[132:135], v22 offset:4096
    s_add_u32 s40, s30, s36
    v_mfma_f32_16x16x32_bf16 v[36:39], v[180:183], v[164:167], v[36:39]
    ds_read_b128 v[136:139], v22 offset:6144
    ds_read_b128 v[140:143], v22 offset:8192
    s_add_u32 m0, s40, 0
    s_nop 0
    buffer_load_dwordx4 v5, s[8:11], s32 offen lds
    v_mfma_f32_16x16x32_bf16 v[40:43], v[180:183], v[168:171], v[40:43]
    ds_read_b128 v[144:147], v22 offset:0
    ds_read_b64_tr_b16 v[148:149], v24 offset:0
    s_add_u32 s40, s30, s48
    v_mfma_f32_16x16x32_bf16 v[44:47], v[180:183], v[172:175], v[44:47]
    ds_read_b64_tr_b16 v[150:151], v24 offset:3840
    ds_read_b64_tr_b16 v[152:153], v24 offset:32
    s_add_u32 m0, s40, 55296
    s_nop 0
    buffer_load_dwordx4 v7, s[12:15], s33 offen lds
    v_mfma_f32_16x16x32_bf16 v[48:51], v[184:187], v[160:163], v[48:51]
    ds_read_b64_tr_b16 v[154:155], v24 offset:3872
    ds_read_b64_tr_b16 v[156:157], v25 offset:0
    s_add_u32 s40, s40, 62464
    v_mfma_f32_16x16x32_bf16 v[52:55], v[184:187], v[164:167], v[52:55]
    ds_read_b64_tr_b16 v[158:159], v25 offset:3840
    s_add_u32 s41, s36, 8192
    v_mfma_f32_16x16x32_bf16 v[56:59], v[184:187], v[168:171], v[56:59]
    s_sub_u32 s49, s49, 15360
    s_cselect_b32 s49, 46080, s49
    s_add_u32 s42, s34, 0
    v_mfma_f32_16x16x32_bf16 v[60:63], v[184:187], v[172:175], v[60:63]
    v_add_u32 v22, s37, v11
    s_cmp_eq_u32 s22, 0
    s_cselect_b32 m0, s41, s40
    s_cselect_b32 s41, s42, s33
    v_mfma_f32_16x16x32_bf16 v[64:67], v[188:191], v[160:163], v[64:67]
    v_add_u32 v24, s49, v15
    buffer_load_dwordx4 v8, s[44:47], s41 offen lds
    v_mfma_f32_16x16x32_bf16 v[68:71], v[188:191], v[164:167], v[68:71]
    v_add_u32 v25, s49, v16
    s_add_u32 s33, s33, 122880
    v_mfma_f32_16x16x32_bf16 v[72:75], v[188:191], v[168:171], v[72:75]
    s_sub_u32 s48, s48, 15360
    s_cselect_b32 s48, 46080, s48
    v_mfma_f32_16x16x32_bf16 v[76:79], v[188:191], v[172:175], v[76:79]
    v_mfma_f32_16x16x32_bf16 v[80:83], v[180:183], v[176:179], v[80:83]
    s_add_u32 s35, s35, 2
    s_bitcmp1_b32 s78, s35
    s_cbranch_scc0 G1QD_loop
    s_cmp_eq_u32 s35, s28
    s_cbranch_scc0 G1QD_h0
    v_mfma_f32_16x16x32_bf16 v[200:203], v[28:31], v[180:183], v[200:203]
    v_mfma_f32_16x16x32_bf16 v[204:207], v[28:31], v[184:187], v[204:207]
G1QD_hz:
    s_waitcnt lgkmcnt(0)
    s_nop 3
    v_mfma_f32_16x16x32_bf16 v[200:203], v[28:31], v[148:151], v[200:203]
    v_mfma_f32_16x16x32_bf16 v[204:207], v[28:31], v[152:155], v[204:207]
    s_and_b32 s40, s28, 6
    s_lshl_b32 s40, s40, 7
    s_and_b32 s41, s28, 8
    s_add_u32 s40, s40, s41
    s_add_u32 s40, s40, s29
    s_mov_b64 exec, 0xffff
    s_nop 6
    v_mov_b32 v201, s76
    v_cvt_pk_bf16_f32 v200, v200, v204
    buffer_store_dwordx2 v[200:201], v4, s[64:67], s40 offen sc1
    s_mov_b64 exec, -1
    s_cmp_eq_u32 s35, 0
    s_cbranch_scc1 G1QD_ent
G1QD_h0:
    s_cmp_eq_u32 s35, 4
    s_cbranch_scc0 G1QD_h2
    v_mov_b32 v239, s76
    v_mov_b32 v233, 0
    s_mov_b64 exec, 1
    buffer_store_dwordx2 v[238:239], v233, s[64:67], s68 offen sc1
    s_mov_b64 exec, -1
    s_branch G1QD_loop
G1QD_h2:
    s_cmp_eq_u32 s35, 14
    s_cbranch_scc1 G1QD_end
    s_cmp_eq_u32 s35, 12
    s_cbranch_scc0 G1QD_loop
    buffer_load_dwordx2 v[238:239], v237, s[64:67], 0 offen sc1
    buffer_load_dwordx2 v[234:235], v236, s[64:67], 0 offen sc1
    buffer_load_dword v230, v231, s[64:67], 0 offen sc1
    s_branch G1QD_loop
G1QD_sp:
    s_sleep 2
    buffer_load_dwordx2 v[238:239], v237, s[64:67], 0 offen sc1
    buffer_load_dwordx2 v[234:235], v236, s[64:67], 0 offen sc1
    buffer_load_dword v230, v231, s[64:67], 0 offen sc1
    s_waitcnt vmcnt(0)
    s_add_u32 s35, s35, 1
    s_cmp_lt_u32 s35, 0x40000
    s_cbranch_scc1 G1QD_vf
    s_branch G1QD_so
G1QD_cs:
    s_sleep 2
    buffer_load_dwordx4 v[252:255], v4, s[64:67], s29 offen sc1
    s_waitcnt vmcnt(0)
    s_add_u32 s35, s35, 1
    s_cmp_lt_u32 s35, 0x40000
    s_cbranch_scc1 G1QD_cv
    s_branch G1QD_co
G1QD_end:
    v_mfma_f32_16x16x32_bf16 v[84:87], v[184:187], v[176:179], v[84:87]
    v_mfma_f32_16x16x32_bf16 v[88:91], v[188:191], v[176:179], v[88:91]
    s_waitcnt vmcnt(6) lgkmcnt(0)
G1QD_vf:
    v_cmp_ne_u32 vcc, s76, v239
    v_cmp_ne_u32 s[40:41], s76, v230
    s_or_b64 vcc, vcc, s[40:41]
    v_cmp_ne_u32 s[40:41], s76, v235
    s_or_b64 vcc, vcc, s[40:41]
    s_cbranch_scc1 G1QD_sp
G1QD_so:
    s_barrier
    v_mfma_f32_16x16x32_bf16 v[32:35], v[148:151], v[128:131], v[32:35]
    ds_read_b128 v[160:163], v22 offset:2048
    ds_read_b128 v[164:167], v22 offset:4096
    s_add_u32 s40, s30, s36
    s_add_u32 m0, s40, 9216
    s_nop 0
    buffer_load_dwordx4 v6, s[8:11], s31 offen lds
    v_mfma_f32_16x16x32_bf16 v[36:39], v[148:151], v[132:135], v[36:39]
    ds_read_b128 v[168:171], v22 offset:6144
    ds_read_b128 v[172:175], v22 offset:8192
    s_add_u32 s40, s30, s48
    v_mfma_f32_16x16x32_bf16 v[40:43], v[148:151], v[136:139], v[40:43]
    ds_read_b128 v[176:179], v22 offset:0
    ds_read_b64_tr_b16 v[180:181], v24 offset:0
    s_add_u32 m0, s40, 55296
    s_nop 0
    buffer_load_dwordx4 v7, s[12:15], s33 offen lds
    v_mfma_f32_16x16x32_bf16 v[44:47], v[148:151], v[140:143], v[44:47]
    ds_read_b64_tr_b16 v[182:183], v24 offset:3840
    ds_read_b64_tr_b16 v[184:185], v24 offset:32
    s_add_u32 s40, s40, 62464
    s_add_u32 s41, s36, 17408
    v_mfma_f32_16x16x32_bf16 v[48:51], v[152:155], v[128:131], v[48:51]
    ds_read_b64_tr_b16 v[186:187], v24 offset:3872
    ds_read_b64_tr_b16 v[188:189], v25 offset:0
    s_add_u32 s42, s34, 102400
    s_cmp_eq_u32 s22, 0
    s_cselect_b32 m0, s41, s40
    s_cselect_b32 s41, s42, s33
    v_mfma_f32_16x16x32_bf16 v[52:55], v[152:155], v[132:135], v[52:55]
    ds_read_b64_tr_b16 v[190:191], v25 offset:3840
    buffer_load_dwordx4 v9, s[44:47], s41 offen lds
    v_mfma_f32_16x16x32_bf16 v[56:59], v[152:155], v[136:139], v[56:59]
    s_add_u32 s37, s37, 18432
    s_add_u32 s33, s33, 122880
    s_sub_u32 s48, s48, 15360
    s_cselect_b32 s48, 46080, s48
    s_add_u32 s32, s32, 128
    s_add_u32 s31, s31, 128
    s_add_u32 s34, s34, 128
    s_add_u32 s36, s36, 18432
    s_cmp_eq_u32 s36, 55296
    s_cselect_b32 s36, 0, s36
    v_mov_b32 v112, v238
    v_mov_b32 v113, v234
    s_add_u32 s52, s18, 0xa00000
    s_addc_u32 s53, s19, 0
    s_and_b32 s53, s53, 0xffff
    s_mov_b32 s54, 0x2a8000
    s_mov_b32 s55, 0x00020000
    s_lshr_b32 s59, s2, 6
    s_cmp_eq_u32 s59, 3
    s_cselect_b32 s59, 0, s59
    s_lshl_b32 s59, s59, 10
    s_add_u32 s60, s59, 1024
    s_cmp_eq_u32 s60, 3072
    s_cselect_b32 s60, 0, s60
    s_add_u32 s61, s60, 1024
    s_cmp_eq_u32 s61, 3072
    s_cselect_b32 s61, 0, s61
    s_bfe_u32 s74, s2, 0x30003
    s_mul_i32 s74, s74, 68*5120
    s_mul_i32 s73, s22, 6*5120
    s_add_u32 s73, s73, s74
    s_add_u32 s73, s73, 20*5120
    s_mul_i32 s70, s59, 5
    s_add_u32 s70, s70, s73
    v_mfma_f32_16x16x32_bf16 v[60:63], v[152:155], v[140:143], v[60:63]
    s_cmp_eq_u32 s37, 55296
    s_cselect_b32 s37, 0, s37
    s_mul_i32 s71, s60, 5
    s_add_u32 s71, s71, s73
    s_mul_i32 s72, s61, 5
    s_add_u32 s72, s72, s73
    s_and_b32 s73, s22, 3
    s_mul_i32 s73, s73, 5*5120
    s_add_u32 s40, s73, s74
    s_mov_b32 s41, s70
    s_mov_b32 s75, s71
    s_mov_b32 s43, s72
    s_cmp_lt_u32 s22, 4
    s_cselect_b32 s70, s41, s40
    s_cmp_lt_u32 s22, 4
    s_cselect_b32 s71, s41, s40
    s_cselect_b32 s35, 15, 5
    s_lshl_b32 s35, s35, 10
    s_add_u32 s71, s71, s35
    s_cmp_lt_u32 s22, 4
    s_cselect_b32 s72, s75, s40
    s_cselect_b32 s35, 0, 10240
    s_add_u32 s72, s72, s35
    s_cmp_lt_u32 s22, 4
    s_cselect_b32 s73, s75, s41
    s_cselect_b32 s35, 15360, 0
    s_add_u32 s73, s73, s35
    s_cmp_lt_u32 s22, 4
    s_cselect_b32 s74, s43, s41
    s_cselect_b32 s35, 0, 15360
    s_add_u32 s74, s74, s35
    s_cmp_lt_u32 s22, 4
    s_cselect_b32 s80, s43, s75
    s_cselect_b32 s35, 15360, 0
    s_add_u32 s80, s80, s35
    s_cmp_lt_u32 s22, 4
    s_cselect_b32 s81, s40, s75
    s_add_u32 s81, s81, 15360
    s_cmp_lt_u32 s22, 4
    s_cselect_b32 s82, s40, s43
    s_cselect_b32 s35, 20480, 0
    s_add_u32 s82, s82, s35
    s_add_u32 s83, s43, 15360
    v_mfma_f32_16x16x32_bf16 v[64:67], v[156:159], v[128:131], v[64:67]
    s_sub_u32 s49, s49, 15360
    s_cselect_b32 s49, 46080, s49
    s_add_u32 m0, s30, 155648
    s_add_u32 s40, s73, 4096
    buffer_load_dwordx4 v4, s[52:55], s40 offen lds
    v_mfma_f32_16x16x32_bf16 v[68:71], v[156:159], v[132:135], v[68:71]
    v_add_u32 v22, s37, v10
    v_mfma_f32_16x16x32_bf16 v[72:75], v[156:159], v[136:139], v[72:75]
    v_add_u32 v24, s49, v15
    s_add_u32 m0, s30, 147456
    s_add_u32 s40, s73, 3072
    buffer_load_dwordx4 v4, s[52:55], s40 offen lds
    v_mfma_f32_16x16x32_bf16 v[76:79], v[156:159], v[140:143], v[76:79]
    v_add_u32 v25, s49, v16
    v_mfma_f32_16x16x32_bf16 v[80:83], v[148:151], v[144:147], v[80:83]
    v_mfma_f32_16x16x32_bf16 v[84:87], v[152:155], v[144:147], v[84:87]
    v_mfma_f32_16x16x32_bf16 v[88:91], v[156:159], v[144:147], v[88:91]
    s_waitcnt vmcnt(8) lgkmcnt(0)
    s_barrier
    v_mfma_f32_16x16x32_bf16 v[32:35], v[180:183], v[160:163], v[32:35]
    ds_read_b128 v[128:131], v22 offset:2048
    s_add_u32 s40, s30, s48
    s_add_u32 m0, s40, 55296
    s_nop 0
    buffer_load_dwordx4 v7, s[12:15], s33 offen lds
    v_mfma_f32_16x16x32_bf16 v[36:39], v[180:183], v[164:167], v[36:39]
    ds_read_b128 v[132:135], v22 offset:4096
    s_add_u32 s40, s40, 62464
    s_add_u32 s41, s36, 8192
    s_add_u32 s42, s34, 0
    s_cmp_eq_u32 s22, 0
    s_cselect_b32 m0, s41, s40
    s_cselect_b32 s41, s42, s33
    v_mfma_f32_16x16x32_bf16 v[40:43], v[180:183], v[168:171], v[40:43]
    ds_read_b128 v[136:139], v22 offset:6144
    buffer_load_dwordx4 v8, s[44:47], s41 offen lds
    v_mfma_f32_16x16x32_bf16 v[44:47], v[180:183], v[172:175], v[44:47]
    ds_read_b128 v[140:143], v22 offset:8192
    v_mfma_f32_16x16x32_bf16 v[48:51], v[184:187], v[160:163], v[48:51]
    ds_read_b128 v[144:147], v22 offset:0
    v_mfma_f32_16x16x32_bf16 v[200:203], v[180:183], v[28:31], 0
    ds_read_b64_tr_b16 v[148:149], v24 offset:0
    s_add_u32 m0, s30, 139264
    s_add_u32 s40, s73, 2048
    buffer_load_dwordx4 v4, s[52:55], s40 offen lds
    v_mfma_f32_16x16x32_bf16 v[52:55], v[184:187], v[164:167], v[52:55]
    ds_read_b64_tr_b16 v[150:151], v24 offset:3840
    v_mfma_f32_16x16x32_bf16 v[56:59], v[184:187], v[168:171], v[56:59]
    ds_read_b64_tr_b16 v[152:153], v24 offset:32
    s_add_u32 m0, s30, 131072
    s_add_u32 s40, s73, 1024
    buffer_load_dwordx4 v4, s[52:55], s40 offen lds
    v_mfma_f32_16x16x32_bf16 v[60:63], v[184:187], v[172:175], v[60:63]
    ds_read_b64_tr_b16 v[154:155], v24 offset:3872
    v_mfma_f32_16x16x32_bf16 v[64:67], v[188:191], v[160:163], v[64:67]
    ds_read_b64_tr_b16 v[156:157], v25 offset:0
    v_mfma_f32_16x16x32_bf16 v[204:207], v[184:187], v[28:31], 0
    ds_read_b64_tr_b16 v[158:159], v25 offset:3840
    s_add_u32 m0, s30, 122880
    s_add_u32 s40, s73, 0
    buffer_load_dwordx4 v4, s[52:55], s40 offen lds
    v_mfma_f32_16x16x32_bf16 v[68:71], v[188:191], v[164:167], v[68:71]
    s_sub_u32 s49, s49, 15360
    s_cselect_b32 s49, 46080, s49
    v_mfma_f32_16x16x32_bf16 v[72:75], v[188:191], v[168:171], v[72:75]
    v_add_u32 v22, s37, v11
    s_add_u32 s40, s70, 4096
    buffer_load_dwordx4 v[208:211], v4, s[52:55], s40 offen
    v_mfma_f32_16x16x32_bf16 v[76:79], v[188:191], v[172:175], v[76:79]
    v_add_u32 v24, s49, v15
    v_mfma_f32_16x16x32_bf16 v[80:83], v[180:183], v[176:179], v[80:83]
    v_add_u32 v25, s49, v16
    v_mfma_f32_16x16x32_bf16 v[84:87], v[184:187], v[176:179], v[84:87]
    v_mfma_f32_16x16x32_bf16 v[88:91], v[188:191], v[176:179], v[88:91]
    s_waitcnt vmcnt(11) lgkmcnt(0)
    s_barrier
    v_mfma_f32_16x16x32_bf16 v[32:35], v[148:151], v[128:131], v[32:35]
    ds_read_b128 v[160:163], v22 offset:2048
    buffer_load_dwordx4 v[252:255], v4, s[64:67], s29 offen sc1
    v_mfma_f32_16x16x32_bf16 v[36:39], v[148:151], v[132:135], v[36:39]
    ds_read_b128 v[164:167], v22 offset:4096
    s_add_u32 s8, s18, 0xd00000
    s_addc_u32 s9, s19, 0
    s_and_b32 s9, s9, 0xffff
    s_mov_b32 s10, 0x880000
    s_mov_b32 s11, 0x00020000
    v_and_b32 v13, 15, v2
    v_lshrrev_b32 v14, 4, v2
    v_lshlrev_b32 v17, 2, v14
    v_sub_u32 v18, v13, v17
    v_mfma_f32_16x16x32_bf16 v[40:43], v[148:151], v[136:139], v[40:43]
    ds_read_b128 v[168:171], v22 offset:6144
    s_add_u32 m0, s30, 114688
    s_add_u32 s40, s74, 4096
    buffer_load_dwordx4 v4, s[52:55], s40 offen lds
    v_mfma_f32_16x16x32_bf16 v[44:47], v[148:151], v[140:143], v[44:47]
    ds_read_b128 v[172:175], v22 offset:8192
    s_mov_b32 s24, 0xf0000000
    v_mov_b32 v114, v18
    v_add_u32 v118, 8, v18
    v_subrev_u32 v115, 1, v18
    v_mfma_f32_16x16x32_bf16 v[48:51], v[152:155], v[128:131], v[48:51]
    ds_read_b128 v[176:179], v22 offset:0
    v_add_u32 v119, 7, v18
    v_subrev_u32 v116, 2, v18
    v_add_u32 v120, 6, v18
    v_subrev_u32 v117, 3, v18
    v_mfma_f32_16x16x32_bf16 v[200:203], v[148:151], v[28:31], v[200:203]
    ds_read_b64_tr_b16 v[180:181], v24 offset:0
    s_add_u32 m0, s30, 106496
    s_add_u32 s40, s74, 3072
    buffer_load_dwordx4 v4, s[52:55], s40 offen lds
    v_mfma_f32_16x16x32_bf16 v[52:55], v[152:155], v[132:135], v[52:55]
    ds_read_b64_tr_b16 v[182:183], v24 offset:3840
    v_add_u32 v121, 5, v18
    v_lshrrev_b32 v114, 3, v114
    v_ashrrev_i32 v118, 31, v118
    v_lshrrev_b32 v115, 3, v115
    v_ashrrev_i32 v119, 31, v119
    v_lshrrev_b32 v116, 3, v116
    v_ashrrev_i32 v120, 31, v120
    v_lshrrev_b32 v117, 3, v117
    v_mfma_f32_16x16x32_bf16 v[56:59], v[152:155], v[136:139], v[56:59]
    ds_read_b64_tr_b16 v[184:185], v24 offset:32
    buffer_load_dwordx4 v[212:215], v4, s[52:55], s71 offen offset:0
    v_mfma_f32_16x16x32_bf16 v[60:63], v[152:155], v[140:143], v[60:63]
    ds_read_b64_tr_b16 v[186:187], v24 offset:3872
    v_ashrrev_i32 v121, 31, v121
    v_min_u32 v114, 1, v114
    v_bfi_b32 v118, v118, 0, s24
    v_min_u32 v115, 1, v115
    v_mfma_f32_16x16x32_bf16 v[64:67], v[156:159], v[128:131], v[64:67]
    ds_read_b64_tr_b16 v[188:189], v25 offset:0
    v_bfi_b32 v119, v119, 0, s24
    v_min_u32 v116, 1, v116
    v_bfi_b32 v120, v120, 0, s24
    v_min_u32 v117, 1, v117
    v_mfma_f32_16x16x32_bf16 v[204:207], v[152:155], v[28:31], v[204:207]
    ds_read_b64_tr_b16 v[190:191], v25 offset:3840
    buffer_load_dwordx4 v[216:219], v4, s[52:55], s71 offen offset:1024
    v_mfma_f32_16x16x32_bf16 v[68:71], v[156:159], v[132:135], v[68:71]
    s_add_u32 s37, s37, 18432
    s_cmp_eq_u32 s37, 55296
    s_cselect_b32 s37, 0, s37
    v_bfi_b32 v121, v121, 0, s24
    v_mul_lo_u32 v114, v114, s24
    v_mul_lo_u32 v115, v115, s24
    v_mul_lo_u32 v116, v116, s24
    v_mul_lo_u32 v117, v117, s24
    s_bfe_u32 s62, s22, 0x10001
    s_or_b32 s63, s62, s21
    s_cselect_b32 s25, 0, s24
    v_or_b32 v122, s25, v118
    v_mfma_f32_16x16x32_bf16 v[72:75], v[156:159], v[136:139], v[72:75]
    s_sub_u32 s49, s49, 15360
    s_cselect_b32 s49, 46080, s49
    v_add_u32 v22, s37, v10
    buffer_load_dwordx4 v[220:223], v4, s[52:55], s71 offen offset:2048
    v_mfma_f32_16x16x32_bf16 v[76:79], v[156:159], v[140:143], v[76:79]
    v_add_u32 v24, s49, v15
    v_add_u32 v25, s49, v16
    v_mfma_f32_16x16x32_bf16 v[80:83], v[148:151], v[144:147], v[80:83]
    v_mfma_f32_16x16x32_bf16 v[84:87], v[152:155], v[144:147], v[84:87]
    v_mfma_f32_16x16x32_bf16 v[88:91], v[156:159], v[144:147], v[88:91]
    s_waitcnt vmcnt(14) lgkmcnt(0)
    s_barrier
    v_mfma_f32_16x16x32_bf16 v[32:35], v[180:183], v[160:163], v[32:35]
    ds_read_b128 v[128:131], v22 offset:2048
    v_or_b32 v123, s25, v119
    v_or_b32 v124, s25, v120
    v_or_b32 v125, s25, v121
    v_cvt_pk_bf16_f32 v126, v118, v119
    v_cvt_pk_bf16_f32 v127, v120, v121
    v_pk_ashrrev_i16 v126, 15, v126 op_sel_hi:[0,1]
    v_pk_ashrrev_i16 v127, 15, v127 op_sel_hi:[0,1]
    v_add_u32 v5, 16, v2
    s_add_u32 m0, s30, 98304
    s_add_u32 s40, s74, 2048
    buffer_load_dwordx4 v4, s[52:55], s40 offen lds
    v_mfma_f32_16x16x32_bf16 v[36:39], v[180:183], v[164:167], v[36:39]
    ds_read_b128 v[132:135], v22 offset:4096
    v_bfe_i32 v5, v5, 6, 1
    s_and_b32 s78, s22, 1
    s_lshl_b32 s63, s62, 2
    s_add_u32 s63, s63, s78
    v_mfma_f32_16x16x32_bf16 v[40:43], v[180:183], v[168:171], v[40:43]
    ds_read_b128 v[136:139], v22 offset:6144
    s_mul_i32 s63, s63, 7808
    s_lshr_b32 s77, s22, 2
    s_mul_i32 s26, s77, 10240
    s_mul_i32 s77, s77, 80
    s_add_u32 s63, s63, s77
    v_mfma_f32_16x16x32_bf16 v[44:47], v[180:183], v[172:175], v[44:47]
    ds_read_b128 v[140:143], v22 offset:8192
    buffer_load_dwordx4 v[224:227], v4, s[52:55], s71 offen offset:3072
    v_mfma_f32_16x16x32_bf16 v[48:51], v[184:187], v[160:163], v[48:51]
    ds_read_b128 v[144:147], v22 offset:0
    s_mul_i32 s77, s78, 3904
    s_sub_u32 s77, 58560, s77
    s_cmp_eq_u32 s62, 0
    s_cselect_b32 s77, s77, 0xffffc300
    v_mul_u32_u24 v6, 488, v13
    v_mfma_f32_16x16x32_bf16 v[200:203], v[180:183], v[28:31], v[200:203]
    ds_read_b64_tr_b16 v[148:149], v24 offset:0
    v_lshl_add_u32 v6, v14, 3, v6
    v_add_u32 v6, s63, v6
    v_add_u32 v7, s77, v6
    v_lshrrev_b32 v18, 2, v2
    v_mul_u32_u24 v18, 488, v18
    v_mfma_f32_16x16x32_bf16 v[52:55], v[184:187], v[164:167], v[52:55]
    ds_read_b64_tr_b16 v[150:151], v24 offset:3840
    s_add_u32 s40, s71, 4096
    buffer_load_dwordx4 v[228:231], v4, s[52:55], s40 offen
    v_mfma_f32_16x16x32_bf16 v[56:59], v[184:187], v[168:171], v[56:59]
    ds_read_b64_tr_b16 v[152:153], v24 offset:32
    v_add_u32 v26, s63, v18
    v_add_u32 v27, s77, v26
    v_and_b32 v18, 3, v2
    v_lshl_add_u32 v8, v18, 3, v26
    v_mfma_f32_16x16x32_bf16 v[60:63], v[184:187], v[172:175], v[60:63]
    ds_read_b64_tr_b16 v[154:155], v24 offset:3872
    v_add_u32 v9, s77, v8
    s_lshl_b32 s63, s21, 3
    s_lshl_b32 s62, s62, 2
    s_add_u32 s63, s63, s62
    s_add_u32 s63, s63, s78
    v_mfma_f32_16x16x32_bf16 v[64:67], v[188:191], v[160:163], v[64:67]
    ds_read_b64_tr_b16 v[156:157], v25 offset:0
    buffer_load_dwordx4 v[232:235], v4, s[52:55], s72 offen offset:0
    v_mfma_f32_16x16x32_bf16 v[204:207], v[184:187], v[28:31], v[204:207]
    ds_read_b64_tr_b16 v[158:159], v25 offset:3840
    s_mul_i32 s63, s63, 69632
    s_add_u32 s26, s26, s63
    s_mul_i32 s63, s3, 1280
    s_add_u32 s26, s26, s63
    v_mfma_f32_16x16x32_bf16 v[68:71], v[188:191], v[164:167], v[68:71]
    s_sub_u32 s49, s49, 15360
    s_cselect_b32 s49, 46080, s49
    s_add_u32 s27, s26, 2*69632
    v_mul_u32_u24 v23, 139264, v14
    v_lshl_add_u32 v23, v13, 4, v23
    s_mov_b32 s24, 0x3ea52b5c
    s_mov_b32 s25, 0x3ea52b5c
    v_mfma_f32_16x16x32_bf16 v[72:75], v[188:191], v[168:171], v[72:75]
    v_add_u32 v22, s37, v11
    buffer_load_dwordx4 v[236:239], v4, s[52:55], s72 offen offset:1024
    v_mfma_f32_16x16x32_bf16 v[76:79], v[188:191], v[172:175], v[76:79]
    v_add_u32 v24, s49, v15
    v_mfma_f32_16x16x32_bf16 v[80:83], v[180:183], v[176:179], v[80:83]
    v_add_u32 v25, s49, v16
    v_mfma_f32_16x16x32_bf16 v[84:87], v[184:187], v[176:179], v[84:87]
    v_mfma_f32_16x16x32_bf16 v[88:91], v[188:191], v[176:179], v[88:91]
    s_waitcnt vmcnt(10) lgkmcnt(0)
    s_barrier
    v_mfma_f32_16x16x32_bf16 v[32:35], v[148:151], v[128:131], v[32:35]
    ds_read_b128 v[160:163], v22 offset:2048
    v_lshrrev_b32 v10, 4, v2
    v_lshlrev_b32 v12, 4, v10
    v_add_u32 v18, 70656, v12
    v_lshl_add_u32 v18, v1, 7, v18
    v_xor_b32 v17, 512, v18
    buffer_load_dwordx4 v[240:243], v4, s[52:55], s72 offen offset:2048
    v_mfma_f32_16x16x32_bf16 v[36:39], v[148:151], v[132:135], v[36:39]
    ds_read_b128 v[164:167], v22 offset:4096
    v_mfma_f32_16x16x32_bf16 v[40:43], v[148:151], v[136:139], v[40:43]
G1QD_cv:
    v_cmp_ne_u32 vcc, s76, v253
    v_cmp_ne_u32 s[40:41], s76, v255
    s_or_b64 vcc, vcc, s[40:41]
    s_cbranch_scc1 G1QD_cs
G1QD_co:
    v_and_b32 v255, s50, v252
    v_lshlrev_b32 v253, 16, v254
    ds_read_b128 v[168:171], v22 offset:6144
    v_and_b32 v11, 15, v2
    v_mfma_f32_16x16x32_bf16 v[44:47], v[148:151], v[140:143], v[44:47]
    v_lshlrev_b32 v252, 16, v252
    v_and_b32 v254, s50, v254
    ds_read_b128 v[172:175], v22 offset:8192
    v_lshlrev_b32 v19, 2, v11
    v_lshrrev_b32 v13, 2, v1
    v_mfma_f32_16x16x32_bf16 v[48:51], v[152:155], v[128:131], v[48:51]
    ds_read_b128 v[176:179], v22 offset:0
    v_lshl_add_u32 v11, v13, 6, v11
    v_and_b32 v13, 3, v1
    v_mfma_f32_16x16x32_bf16 v[200:203], v[148:151], v[28:31], v[200:203]
    ds_read_b64_tr_b16 v[180:181], v24 offset:0
    buffer_load_dwordx4 v[244:247], v4, s[52:55], s72 offen offset:3072
    v_mfma_f32_16x16x32_bf16 v[52:55], v[152:155], v[132:135], v[52:55]
    ds_read_b64_tr_b16 v[182:183], v24 offset:3840
    v_mfma_f32_16x16x32_bf16 v[56:59], v[152:155], v[136:139], v[56:59]
    ds_read_b64_tr_b16 v[184:185], v24 offset:32
    v_mul_u32_u24 v14, 488, v11
    v_mfma_f32_16x16x32_bf16 v[60:63], v[152:155], v[140:143], v[60:63]
    v_mfma_f32_16x16x16_bf16 v[200:203], v[252:253], v[28:29], v[200:203]
    ds_read_b64_tr_b16 v[186:187], v24 offset:3872
    v_lshl_add_u32 v14, v10, 3, v14
    v_lshl_add_u32 v14, v13, 7, v14
    v_mfma_f32_16x16x32_bf16 v[64:67], v[156:159], v[128:131], v[64:67]
    ds_read_b64_tr_b16 v[188:189], v25 offset:0
    v_add_u32 v20, s56, v14
    v_add_u32 v21, s57, v14
    v_mfma_f32_16x16x32_bf16 v[204:207], v[152:155], v[28:31], v[204:207]
    ds_read_b64_tr_b16 v[190:191], v25 offset:3840
    s_add_u32 s40, s72, 4096
    buffer_load_dwordx4 v[248:251], v4, s[52:55], s40 offen
    v_mfma_f32_16x16x32_bf16 v[68:71], v[156:159], v[132:135], v[68:71]
    v_mfma_f32_16x16x32_bf16 v[72:75], v[156:159], v[136:139], v[72:75]
    v_mfma_f32_16x16x32_bf16 v[76:79], v[156:159], v[140:143], v[76:79]
    v_mfma_f32_16x16x16_bf16 v[204:207], v[254:255], v[28:29], v[204:207]
    v_mfma_f32_16x16x32_bf16 v[80:83], v[148:151], v[144:147], v[80:83]
    v_mfma_f32_16x16x32_bf16 v[84:87], v[152:155], v[144:147], v[84:87]
    v_mfma_f32_16x16x32_bf16 v[88:91], v[156:159], v[144:147], v[88:91]
    s_waitcnt lgkmcnt(0)
    s_setprio 3
    s_barrier
    v_mfma_f32_16x16x32_bf16 v[200:203], v[180:183], v[28:31], v[200:203]
    v_mfma_f32_16x16x32_bf16 v[204:207], v[184:187], v[28:31], v[204:207]
    v_mfma_f32_16x16x32_bf16 v[32:35], v[180:183], v[160:163], v[32:35]
    ds_bpermute_b32 v129, v19, v112 offset:0
    ds_bpermute_b32 v133, v19, v112 offset:64
    v_mfma_f32_16x16x32_bf16 v[36:39], v[180:183], v[164:167], v[36:39]
    ds_bpermute_b32 v137, v19, v112 offset:128
    ds_bpermute_b32 v141, v19, v112 offset:192
    v_mfma_f32_16x16x32_bf16 v[40:43], v[180:183], v[168:171], v[40:43]
    s_add_u32 m0, s30, 90112
    s_add_u32 s40, s74, 1024
    buffer_load_dwordx4 v4, s[52:55], s40 offen lds
    s_add_u32 m0, s30, 81920
    s_add_u32 s40, s74, 0
    buffer_load_dwordx4 v4, s[52:55], s40 offen lds
    v_mfma_f32_16x16x32_bf16 v[44:47], v[180:183], v[172:175], v[44:47]
    s_add_u32 m0, s30, 73728
    s_add_u32 s40, s80, 4096
    buffer_load_dwordx4 v4, s[52:55], s40 offen lds
    s_mov_b32 exec_lo, 0x00010001
    s_mov_b32 exec_hi, 0x00010001
    ds_write_b128 v17, v[200:203] offset:0
    ds_write_b128 v17, v[204:207] offset:64
    s_mov_b64 exec, -1
    v_mfma_f32_16x16x32_bf16 v[48:51], v[184:187], v[160:163], v[48:51]
    v_mfma_f32_16x16x32_bf16 v[52:55], v[184:187], v[164:167], v[52:55]
    s_waitcnt lgkmcnt(0)
    s_barrier
    v_mfma_f32_16x16x32_bf16 v[56:59], v[184:187], v[168:171], v[56:59]
    ds_read_b128 v[148:151], v18 offset:0
    v_lshlrev_b32 v128, 16, v129
    v_mfma_f32_16x16x32_bf16 v[60:63], v[184:187], v[172:175], v[60:63]
    v_and_b32 v130, s50, v129
    v_rcp_f32 v130, v130
    v_mfma_f32_16x16x32_bf16 v[64:67], v[188:191], v[160:163], v[64:67]
    v_lshlrev_b32 v132, 16, v133
    v_and_b32 v134, s50, v133
    v_mfma_f32_16x16x32_bf16 v[68:71], v[188:191], v[164:167], v[68:71]
    v_rcp_f32 v134, v134
    v_lshlrev_b32 v136, 16, v137
    v_mfma_f32_16x16x32_bf16 v[72:75], v[188:191], v[168:171], v[72:75]
    v_and_b32 v138, s50, v137
    v_rcp_f32 v138, v138
    v_mfma_f32_16x16x32_bf16 v[76:79], v[188:191], v[172:175], v[76:79]
    v_lshlrev_b32 v140, 16, v141
    v_and_b32 v142, s50, v141
    v_mfma_f32_16x16x32_bf16 v[80:83], v[180:183], v[176:179], v[80:83]
    v_rcp_f32 v142, v142
    v_lshlrev_b32 v144, 16, v113
    v_mfma_f32_16x16x32_bf16 v[84:87], v[184:187], v[176:179], v[84:87]
    v_and_b32 v146, s50, v113
    v_rcp_f32 v146, v146
    v_mfma_f32_16x16x32_bf16 v[88:91], v[188:191], v[176:179], v[88:91]
    s_waitcnt lgkmcnt(0)
    v_pk_fma_f32 v[32:33], v[200:201], v[128:129], v[32:33] op_sel:[0,0,0] op_sel_hi:[1,0,1] neg_lo:[0,1,0] neg_hi:[0,1,0]
    v_pk_fma_f32 v[34:35], v[202:203], v[128:129], v[34:35] op_sel:[0,0,0] op_sel_hi:[1,0,1] neg_lo:[0,1,0] neg_hi:[0,1,0]
    v_pk_mul_f32 v[32:33], v[32:33], v[130:131] op_sel:[0,0] op_sel_hi:[1,0]
    v_pk_mul_f32 v[34:35], v[34:35], v[130:131] op_sel:[0,0] op_sel_hi:[1,0]
    v_cvt_pk_bf16_f32 v32, v32, v33
    v_cvt_pk_bf16_f32 v33, v34, v35
    ds_write_b64 v20, v[32:33] offset:0
    v_pk_fma_f32 v[36:37], v[200:201], v[132:133], v[36:37] op_sel:[0,0,0] op_sel_hi:[1,0,1] neg_lo:[0,1,0] neg_hi:[0,1,0]
    v_pk_fma_f32 v[38:39], v[202:203], v[132:133], v[38:39] op_sel:[0,0,0] op_sel_hi:[1,0,1] neg_lo:[0,1,0] neg_hi:[0,1,0]
    v_pk_mul_f32 v[36:37], v[36:37], v[134:135] op_sel:[0,0] op_sel_hi:[1,0]
    v_pk_mul_f32 v[38:39], v[38:39], v[134:135] op_sel:[0,0] op_sel_hi:[1,0]
    v_cvt_pk_bf16_f32 v36, v36, v37
    v_cvt_pk_bf16_f32 v37, v38, v39
    ds_write_b64 v20, v[36:37] offset:7808
    v_pk_fma_f32 v[40:41], v[200:201], v[136:137], v[40:41] op_sel:[0,0,0] op_sel_hi:[1,0,1] neg_lo:[0,1,0] neg_hi:[0,1,0]
    v_pk_fma_f32 v[42:43], v[202:203], v[136:137], v[42:43] op_sel:[0,0,0] op_sel_hi:[1,0,1] neg_lo:[0,1,0] neg_hi:[0,1,0]
    v_pk_mul_f32 v[40:41], v[40:41], v[138:139] op_sel:[0,0] op_sel_hi:[1,0]
    v_pk_mul_f32 v[42:43], v[42:43], v[138:139] op_sel:[0,0] op_sel_hi:[1,0]
    v_cvt_pk_bf16_f32 v40, v40, v41
    v_cvt_pk_bf16_f32 v41, v42, v43
    ds_write_b64 v20, v[40:41] offset:15616
    v_pk_fma_f32 v[44:45], v[200:201], v[140:141], v[44:45] op_sel:[0,0,0] op_sel_hi:[1,0,1] neg_lo:[0,1,0] neg_hi:[0,1,0]
    v_pk_fma_f32 v[46:47], v[202:203], v[140:141], v[46:47] op_sel:[0,0,0] op_sel_hi:[1,0,1] neg_lo:[0,1,0] neg_hi:[0,1,0]
    v_pk_mul_f32 v[44:45], v[44:45], v[142:143] op_sel:[0,0] op_sel_hi:[1,0]
    v_pk_mul_f32 v[46:47], v[46:47], v[142:143] op_sel:[0,0] op_sel_hi:[1,0]
    v_cvt_pk_bf16_f32 v44, v44, v45
    v_cvt_pk_bf16_f32 v45, v46, v47
    ds_write_b64 v20, v[44:45] offset:23424
    v_pk_fma_f32 v[80:81], v[200:201], v[144:145], v[80:81] op_sel:[0,0,0] op_sel_hi:[1,0,1] neg_lo:[0,1,0] neg_hi:[0,1,0]
    v_pk_fma_f32 v[82:83], v[202:203], v[144:145], v[82:83] op_sel:[0,0,0] op_sel_hi:[1,0,1] neg_lo:[0,1,0] neg_hi:[0,1,0]
    v_pk_mul_f32 v[80:81], v[80:81], v[146:147] op_sel:[0,0] op_sel_hi:[1,0]
    v_pk_mul_f32 v[82:83], v[82:83], v[146:147] op_sel:[0,0] op_sel_hi:[1,0]
    v_cvt_pk_bf16_f32 v80, v80, v81
    v_cvt_pk_bf16_f32 v81, v82, v83
    ds_write_b64 v20, v[80:81] offset:62464
    buffer_load_dwordx4 v[192:195], v4, s[52:55], s70 offen offset:0
    v_pk_fma_f32 v[48:49], v[204:205], v[128:129], v[48:49] op_sel:[0,0,0] op_sel_hi:[1,0,1] neg_lo:[0,1,0] neg_hi:[0,1,0]
    v_pk_fma_f32 v[50:51], v[206:207], v[128:129], v[50:51] op_sel:[0,0,0] op_sel_hi:[1,0,1] neg_lo:[0,1,0] neg_hi:[0,1,0]
    v_pk_mul_f32 v[48:49], v[48:49], v[130:131] op_sel:[0,0] op_sel_hi:[1,0]
    v_pk_mul_f32 v[50:51], v[50:51], v[130:131] op_sel:[0,0] op_sel_hi:[1,0]
    v_cvt_pk_bf16_f32 v48, v48, v49
    v_cvt_pk_bf16_f32 v49, v50, v51
    ds_write_b64 v20, v[48:49] offset:32
    v_pk_fma_f32 v[52:53], v[204:205], v[132:133], v[52:53] op_sel:[0,0,0] op_sel_hi:[1,0,1] neg_lo:[0,1,0] neg_hi:[0,1,0]
    v_pk_fma_f32 v[54:55], v[206:207], v[132:133], v[54:55] op_sel:[0,0,0] op_sel_hi:[1,0,1] neg_lo:[0,1,0] neg_hi:[0,1,0]
    v_pk_mul_f32 v[52:53], v[52:53], v[134:135] op_sel:[0,0] op_sel_hi:[1,0]
    v_pk_mul_f32 v[54:55], v[54:55], v[134:135] op_sel:[0,0] op_sel_hi:[1,0]
    v_cvt_pk_bf16_f32 v52, v52, v53
    v_cvt_pk_bf16_f32 v53, v54, v55
    ds_write_b64 v20, v[52:53] offset:7840
    v_pk_fma_f32 v[56:57], v[204:205], v[136:137], v[56:57] op_sel:[0,0,0] op_sel_hi:[1,0,1] neg_lo:[0,1,0] neg_hi:[0,1,0]
    v_pk_fma_f32 v[58:59], v[206:207], v[136:137], v[58:59] op_sel:[0,0,0] op_sel_hi:[1,0,1] neg_lo:[0,1,0] neg_hi:[0,1,0]
    v_pk_mul_f32 v[56:57], v[56:57], v[138:139] op_sel:[0,0] op_sel_hi:[1,0]
    v_pk_mul_f32 v[58:59], v[58:59], v[138:139] op_sel:[0,0] op_sel_hi:[1,0]
    v_cvt_pk_bf16_f32 v56, v56, v57
    v_cvt_pk_bf16_f32 v57, v58, v59
    ds_write_b64 v20, v[56:57] offset:15648
    v_pk_fma_f32 v[60:61], v[204:205], v[140:141], v[60:61] op_sel:[0,0,0] op_sel_hi:[1,0,1] neg_lo:[0,1,0] neg_hi:[0,1,0]
    v_pk_fma_f32 v[62:63], v[206:207], v[140:141], v[62:63] op_sel:[0,0,0] op_sel_hi:[1,0,1] neg_lo:[0,1,0] neg_hi:[0,1,0]
    v_pk_mul_f32 v[60:61], v[60:61], v[142:143] op_sel:[0,0] op_sel_hi:[1,0]
    v_pk_mul_f32 v[62:63], v[62:63], v[142:143] op_sel:[0,0] op_sel_hi:[1,0]
    v_cvt_pk_bf16_f32 v60, v60, v61
    v_cvt_pk_bf16_f32 v61, v62, v63
    ds_write_b64 v20, v[60:61] offset:23456
    v_pk_fma_f32 v[84:85], v[204:205], v[144:145], v[84:85] op_sel:[0,0,0] op_sel_hi:[1,0,1] neg_lo:[0,1,0] neg_hi:[0,1,0]
    v_pk_fma_f32 v[86:87], v[206:207], v[144:145], v[86:87] op_sel:[0,0,0] op_sel_hi:[1,0,1] neg_lo:[0,1,0] neg_hi:[0,1,0]
    v_pk_mul_f32 v[84:85], v[84:85], v[146:147] op_sel:[0,0] op_sel_hi:[1,0]
    v_pk_mul_f32 v[86:87], v[86:87], v[146:147] op_sel:[0,0] op_sel_hi:[1,0]
    v_cvt_pk_bf16_f32 v84, v84, v85
    v_cvt_pk_bf16_f32 v85, v86, v87
    ds_write_b64 v20, v[84:85] offset:62496
    buffer_load_dwordx4 v[196:199], v4, s[52:55], s70 offen offset:1024
    v_pk_fma_f32 v[64:65], v[148:149], v[128:129], v[64:65] op_sel:[0,0,0] op_sel_hi:[1,0,1] neg_lo:[0,1,0] neg_hi:[0,1,0]
    v_pk_fma_f32 v[66:67], v[150:151], v[128:129], v[66:67] op_sel:[0,0,0] op_sel_hi:[1,0,1] neg_lo:[0,1,0] neg_hi:[0,1,0]
    v_pk_mul_f32 v[64:65], v[64:65], v[130:131] op_sel:[0,0] op_sel_hi:[1,0]
    v_pk_mul_f32 v[66:67], v[66:67], v[130:131] op_sel:[0,0] op_sel_hi:[1,0]
    v_cvt_pk_bf16_f32 v64, v64, v65
    v_cvt_pk_bf16_f32 v65, v66, v67
    ds_write_b64 v21, v[64:65] offset:0
    v_pk_fma_f32 v[68:69], v[148:149], v[132:133], v[68:69] op_sel:[0,0,0] op_sel_hi:[1,0,1] neg_lo:[0,1,0] neg_hi:[0,1,0]
    v_pk_fma_f32 v[70:71], v[150:151], v[132:133], v[70:71] op_sel:[0,0,0] op_sel_hi:[1,0,1] neg_lo:[0,1,0] neg_hi:[0,1,0]
    v_pk_mul_f32 v[68:69], v[68:69], v[134:135] op_sel:[0,0] op_sel_hi:[1,0]
    v_pk_mul_f32 v[70:71], v[70:71], v[134:135] op_sel:[0,0] op_sel_hi:[1,0]
    v_cvt_pk_bf16_f32 v68, v68, v69
    v_cvt_pk_bf16_f32 v69, v70, v71
    ds_write_b64 v21, v[68:69] offset:7808
    v_pk_fma_f32 v[72:73], v[148:149], v[136:137], v[72:73] op_sel:[0,0,0] op_sel_hi:[1,0,1] neg_lo:[0,1,0] neg_hi:[0,1,0]
    v_pk_fma_f32 v[74:75], v[150:151], v[136:137], v[74:75] op_sel:[0,0,0] op_sel_hi:[1,0,1] neg_lo:[0,1,0] neg_hi:[0,1,0]
    v_pk_mul_f32 v[72:73], v[72:73], v[138:139] op_sel:[0,0] op_sel_hi:[1,0]
    v_pk_mul_f32 v[74:75], v[74:75], v[138:139] op_sel:[0,0] op_sel_hi:[1,0]
    v_cvt_pk_bf16_f32 v72, v72, v73
    v_cvt_pk_bf16_f32 v73, v74, v75
    ds_write_b64 v21, v[72:73] offset:15616
    v_pk_fma_f32 v[76:77], v[148:149], v[140:141], v[76:77] op_sel:[0,0,0] op_sel_hi:[1,0,1] neg_lo:[0,1,0] neg_hi:[0,1,0]
    v_pk_fma_f32 v[78:79], v[150:151], v[140:141], v[78:79] op_sel:[0,0,0] op_sel_hi:[1,0,1] neg_lo:[0,1,0] neg_hi:[0,1,0]
    v_pk_mul_f32 v[76:77], v[76:77], v[142:143] op_sel:[0,0] op_sel_hi:[1,0]
    v_pk_mul_f32 v[78:79], v[78:79], v[142:143] op_sel:[0,0] op_sel_hi:[1,0]
    v_cvt_pk_bf16_f32 v76, v76, v77
    v_cvt_pk_bf16_f32 v77, v78, v79
    ds_write_b64 v21, v[76:77] offset:23424
    v_pk_fma_f32 v[88:89], v[148:149], v[144:145], v[88:89] op_sel:[0,0,0] op_sel_hi:[1,0,1] neg_lo:[0,1,0] neg_hi:[0,1,0]
    v_pk_fma_f32 v[90:91], v[150:151], v[144:145], v[90:91] op_sel:[0,0,0] op_sel_hi:[1,0,1] neg_lo:[0,1,0] neg_hi:[0,1,0]
    v_pk_mul_f32 v[88:89], v[88:89], v[146:147] op_sel:[0,0] op_sel_hi:[1,0]
    v_pk_mul_f32 v[90:91], v[90:91], v[146:147] op_sel:[0,0] op_sel_hi:[1,0]
    v_cvt_pk_bf16_f32 v88, v88, v89
    v_cvt_pk_bf16_f32 v89, v90, v91
    ds_write_b64 v21, v[88:89] offset:62464
    s_branch G1_att
G1_vE:
    s_add_u32 s40, s30, s36
    s_add_u32 m0, s40, 0
    s_nop 0
    buffer_load_dwordx4 v5, s[8:11], s32 offen lds
    s_cmp_lg_u32 s22, 0
    s_cbranch_scc1 1f
    s_add_u32 m0, s36, 8192
    s_nop 0
    buffer_load_dwordx4 v8, s[44:47], s34 offen lds
1:
    s_add_u32 s40, s30, s36
    s_add_u32 m0, s40, 9216
    s_nop 0
    buffer_load_dwordx4 v6, s[8:11], s31 offen lds
    s_add_u32 s40, s30, s48
    s_add_u32 m0, s40, 55296
    s_nop 0
    buffer_load_dwordx4 v7, s[12:15], s33 offen lds
    s_add_u32 s40, s40, 62464
    s_add_u32 s41, s36, 17408
    s_add_u32 s42, s34, 102400
    s_cmp_eq_u32 s22, 0
    s_cselect_b32 m0, s41, s40
    s_cselect_b32 s41, s42, s33
    buffer_load_dwordx4 v9, s[44:47], s41 offen lds
    s_add_u32 s33, s33, 122880
    s_sub_u32 s48, s48, 15360
    s_cselect_b32 s48, 46080, s48
    s_add_u32 s32, s32, 128
    s_add_u32 s31, s31, 128
    s_add_u32 s34, s34, 128
    s_add_u32 s36, s36, 18432
    s_cmp_eq_u32 s36, 55296
    s_cselect_b32 s36, 0, s36
    v_lshrrev_b32 v14, 2, v1
    v_lshl_add_u32 v10, v14, 13, v3
    v_xor_b32 v11, 64, v10
    v_lshrrev_b32 v16, 5, v2
    v_bfe_u32 v17, v2, 4, 1
    v_bfe_u32 v18, v2, 2, 2
    v_lshl_add_u32 v18, v16, 4, v18
    v_lshl_add_u32 v18, v17, 2, v18
    v_mul_u32_u24 v18, 480, v18
    v_and_b32 v17, 3, v2
    v_lshl_add_u32 v18, v17, 3, v18
    v_and_b32 v17, 3, v1
    v_lshl_add_u32 v18, v17, 7, v18
    v_add_u32 v18, 55296, v18
    s_lshr_b32 s56, s22, 2
    s_lshl_b32 s56, s56, 6
    s_cmp_eq_u32 s22, 7
    s_cselect_b32 s56, 0, s56
    s_xor_b32 s57, s56, 64
    v_add_u32 v15, s56, v18
    v_add_u32 v16, s57, v18
    v_mov_b32 v32, 0
    v_mov_b32 v33, 0
    v_mov_b32 v34, 0
    v_mov_b32 v35, 0
    v_mov_b32 v36, 0
    v_mov_b32 v37, 0
    v_mov_b32 v38, 0
    v_mov_b32 v39, 0
    v_mov_b32 v40, 0
    v_mov_b32 v41, 0
    v_mov_b32 v42, 0
    v_mov_b32 v43, 0
    v_mov_b32 v44, 0
    v_mov_b32 v45, 0
    v_mov_b32 v46, 0
    v_mov_b32 v47, 0
    v_mov_b32 v48, 0
    v_mov_b32 v49, 0
    v_mov_b32 v50, 0
    v_mov_b32 v51, 0
    v_mov_b32 v52, 0
    v_mov_b32 v53, 0
    v_mov_b32 v54, 0
    v_mov_b32 v55, 0
    v_mov_b32 v56, 0
    v_mov_b32 v57, 0
    v_mov_b32 v58, 0
    v_mov_b32 v59, 0
    v_mov_b32 v60, 0
    v_mov_b32 v61, 0
    v_mov_b32 v62, 0
    v_mov_b32 v63, 0
    v_mov_b32 v64, 0
    v_mov_b32 v65, 0
    v_mov_b32 v66, 0
    v_mov_b32 v67, 0
    v_mov_b32 v68, 0
    v_mov_b32 v69, 0
    v_mov_b32 v70, 0
    v_mov_b32 v71, 0
    v_mov_b32 v72, 0
    v_mov_b32 v73, 0
    v_mov_b32 v74, 0
    v_mov_b32 v75, 0
    v_mov_b32 v76, 0
    v_mov_b32 v77, 0
    v_mov_b32 v78, 0
    v_mov_b32 v79, 0
    v_mov_b32 v200, 0
    v_mov_b32 v201, 0
    v_mov_b32 v202, 0
    v_mov_b32 v203, 0
    v_mov_b32 v204, 0
    v_mov_b32 v205, 0
    v_mov_b32 v206, 0
    v_mov_b32 v207, 0
    v_mov_b32 v28, 0x3f803f80
    v_mov_b32 v29, 0x3f803f80
    v_mov_b32 v30, 0x3f803f80
    v_mov_b32 v31, 0x3f803f80
    s_mov_b32 s35, 0
    s_sub_u32 s28, 14, s21
    s_bitcmp1_b32 s21, 0
    s_cselect_b32 s28, 31, s28
    s_bitset1_b32 s78, s28
    s_lshl_b32 s29, s3, 3
    s_add_u32 s29, s29, s22
    s_lshl_b32 s29, s29, 11
    s_add_u32 s29, s29, 282624
    s_add_u32 s40, s30, s36
    s_add_u32 m0, s40, 0
    s_nop 0
    buffer_load_dwordx4 v5, s[8:11], s32 offen lds
    s_add_u32 s40, s30, s48
    s_add_u32 m0, s40, 55296
    s_nop 0
    buffer_load_dwordx4 v7, s[12:15], s33 offen lds
    s_add_u32 s40, s40, 62464
    s_add_u32 s41, s36, 8192
    s_add_u32 s42, s34, 0
    s_cmp_eq_u32 s22, 0
    s_cselect_b32 m0, s41, s40
    s_cselect_b32 s41, s42, s33
    buffer_load_dwordx4 v8, s[44:47], s41 offen lds
    s_add_u32 s33, s33, 122880
    s_sub_u32 s48, s48, 15360
    s_cselect_b32 s48, 46080, s48
    s_add_u32 s40, s30, s36
    s_add_u32 m0, s40, 9216
    s_nop 0
    buffer_load_dwordx4 v6, s[8:11], s31 offen lds
    s_add_u32 s40, s30, s48
    s_add_u32 m0, s40, 55296
    s_nop 0
    buffer_load_dwordx4 v7, s[12:15], s33 offen lds
    s_add_u32 s40, s40, 62464
    s_add_u32 s41, s36, 17408
    s_add_u32 s42, s34, 102400
    s_cmp_eq_u32 s22, 0
    s_cselect_b32 m0, s41, s40
    s_cselect_b32 s41, s42, s33
    buffer_load_dwordx4 v9, s[44:47], s41 offen lds
    s_add_u32 s33, s33, 122880
    s_sub_u32 s48, s48, 15360
    s_cselect_b32 s48, 46080, s48
    s_add_u32 s32, s32, 128
    s_add_u32 s31, s31, 128
    s_add_u32 s34, s34, 128
    s_add_u32 s36, s36, 18432
    s_cmp_eq_u32 s36, 55296
    s_cselect_b32 s36, 0, s36
    s_waitcnt vmcnt(10)
    v_lshlrev_b32 v134, 16, v128
    v_and_b32 v135, s50, v128
    v_lshlrev_b32 v136, 16, v129
    v_and_b32 v137, s50, v129
    v_lshlrev_b32 v138, 16, v130
    v_and_b32 v139, s50, v130
    v_lshlrev_b32 v140, 16, v131
    v_and_b32 v141, s50, v131
    v_lshlrev_b32 v142, 16, v132
    v_and_b32 v143, s50, v132
    v_add_f32 v144, v134, v135
    v_add_f32 v145, v136, v137
    v_add_f32 v144, v144, v138
    v_add_f32 v145, v145, v139
    v_add_f32 v144, v144, v140
    v_add_f32 v145, v145, v141
    v_add_f32 v144, v144, v142
    v_add_f32 v145, v145, v143
    v_add_f32 v144, v144, v145
    s_nop 1
    v_add_f32_dpp v144, v144, v144 row_ror:8 row_mask:0xf bank_mask:0xf
    s_nop 1
    v_add_f32_dpp v144, v144, v144 row_ror:4 row_mask:0xf bank_mask:0xf
    s_nop 1
    v_add_f32_dpp v144, v144, v144 row_ror:2 row_mask:0xf bank_mask:0xf
    s_nop 1
    v_add_f32_dpp v144, v144, v144 row_ror:1 row_mask:0xf bank_mask:0xf
    s_nop 1
    v_add_f32_dpp v144, v144, v144 row_bcast:15 row_mask:0xa bank_mask:0xf
    s_nop 1
    v_add_f32_dpp v144, v144, v144 row_bcast:31 row_mask:0xc bank_mask:0xf
    s_nop 1
    v_readlane_b32 s40, v144, 63
    v_mov_b32 v146, 0x3acccccd
    s_nop 0
    v_mul_f32 v147, s40, v146
    v_sub_f32 v134, v134, v147
    v_sub_f32 v135, v135, v147
    v_sub_f32 v136, v136, v147
    v_sub_f32 v137, v137, v147
    v_sub_f32 v138, v138, v147
    v_sub_f32 v139, v139, v147
    v_sub_f32 v140, v140, v147
    v_sub_f32 v141, v141, v147
    v_sub_f32 v142, v142, v147
    v_sub_f32 v143, v143, v147
    v_mul_f32 v144, v134, v134
    v_mul_f32 v145, v135, v135
    v_fmac_f32 v144, v136, v136
    v_fmac_f32 v145, v137, v137
    v_fmac_f32 v144, v138, v138
    v_fmac_f32 v145, v139, v139
    v_fmac_f32 v144, v140, v140
    v_fmac_f32 v145, v141, v141
    v_fmac_f32 v144, v142, v142
    v_fmac_f32 v145, v143, v143
    v_add_f32 v144, v144, v145
    s_nop 1
    v_add_f32_dpp v144, v144, v144 row_ror:8 row_mask:0xf bank_mask:0xf
    s_nop 1
    v_add_f32_dpp v144, v144, v144 row_ror:4 row_mask:0xf bank_mask:0xf
    s_nop 1
    v_add_f32_dpp v144, v144, v144 row_ror:2 row_mask:0xf bank_mask:0xf
    s_nop 1
    v_add_f32_dpp v144, v144, v144 row_ror:1 row_mask:0xf bank_mask:0xf
    s_nop 1
    v_add_f32_dpp v144, v144, v144 row_bcast:15 row_mask:0xa bank_mask:0xf
    s_nop 1
    v_add_f32_dpp v144, v144, v144 row_bcast:31 row_mask:0xc bank_mask:0xf
    s_nop 1
    v_readlane_b32 s40, v144, 63
    s_nop 1
    v_mul_f32 v148, s40, v146
    v_cvt_pk_bf16_f32 v148, v148, v148
    v_lshlrev_b32 v148, 16, v148
    v_add_f32 v148, 0x3727c5ac, v148
    v_cvt_pk_bf16_f32 v148, v148, v148
    v_lshlrev_b32 v148, 16, v148
    v_sqrt_f32 v148, v148
    s_nop 0
    v_cvt_pk_bf16_f32 v238, v147, v148
    s_waitcnt vmcnt(6) lgkmcnt(0)
    s_add_u32 s76, s76, 0x9e3779b9
    v_add_u32 v22, s37, v10
    v_add_u32 v24, s49, v15
    v_add_u32 v25, s49, v16
    s_barrier
    ds_read_b128 v[128:131], v22 offset:2048
    ds_read_b128 v[132:135], v22 offset:4096
    ds_read_b128 v[136:139], v22 offset:6144
    ds_read_b128 v[140:143], v22 offset:8192
    ds_read_b64_tr_b16 v[144:145], v24 offset:0
    ds_read_b64_tr_b16 v[146:147], v24 offset:3840
    ds_read_b64_tr_b16 v[148:149], v24 offset:32
    ds_read_b64_tr_b16 v[150:151], v24 offset:3872
    ds_read_b64_tr_b16 v[152:153], v25 offset:0
    ds_read_b64_tr_b16 v[154:155], v25 offset:3840
    s_add_u32 s40, s30, s36
    s_add_u32 m0, s40, 0
    s_nop 0
    buffer_load_dwordx4 v5, s[8:11], s32 offen lds
    s_add_u32 s40, s30, s48
    s_add_u32 m0, s40, 55296
    s_nop 0
    buffer_load_dwordx4 v7, s[12:15], s33 offen lds
    s_add_u32 s40, s40, 62464
    s_add_u32 s41, s36, 8192
    s_add_u32 s42, s34, 0
    s_cmp_eq_u32 s22, 0
    s_cselect_b32 m0, s41, s40
    s_cselect_b32 s41, s42, s33
    buffer_load_dwordx4 v8, s[44:47], s41 offen lds
    s_add_u32 s33, s33, 122880
    s_sub_u32 s48, s48, 15360
    s_cselect_b32 s48, 46080, s48
    s_sub_u32 s49, s49, 15360
    s_cselect_b32 s49, 46080, s49
    v_add_u32 v22, s37, v11
    v_add_u32 v24, s49, v15
    v_add_u32 v25, s49, v16
    s_cmp_eq_u32 s28, 0
    s_cbranch_scc1 G1QE_hz
    s_branch G1QE_ent
G1QE_loop:
    v_mfma_f32_16x16x32_bf16 v[72:75], v[180:183], v[164:167], v[72:75]
    v_mfma_f32_16x16x32_bf16 v[76:79], v[180:183], v[168:171], v[76:79]
G1QE_ent:
    s_waitcnt vmcnt(6) lgkmcnt(0)
    s_barrier
    v_mfma_f32_16x16x32_bf16 v[32:35], v[144:147], v[128:131], v[32:35]
    ds_read_b128 v[156:159], v22 offset:2048
    ds_read_b128 v[160:163], v22 offset:4096
    s_add_u32 s40, s30, s36
    s_add_u32 m0, s40, 9216
    s_nop 0
    buffer_load_dwordx4 v6, s[8:11], s31 offen lds
    v_mfma_f32_16x16x32_bf16 v[36:39], v[144:147], v[132:135], v[36:39]
    ds_read_b128 v[164:167], v22 offset:6144
    ds_read_b128 v[168:171], v22 offset:8192
    s_add_u32 s40, s30, s48
    s_add_u32 m0, s40, 55296
    s_nop 0
    buffer_load_dwordx4 v7, s[12:15], s33 offen lds
    v_mfma_f32_16x16x32_bf16 v[40:43], v[144:147], v[136:139], v[40:43]
    ds_read_b64_tr_b16 v[172:173], v24 offset:0
    ds_read_b64_tr_b16 v[174:175], v24 offset:3840
    s_add_u32 s40, s40, 62464
    s_add_u32 s41, s36, 17408
    v_mfma_f32_16x16x32_bf16 v[44:47], v[144:147], v[140:143], v[44:47]
    ds_read_b64_tr_b16 v[176:177], v24 offset:32
    ds_read_b64_tr_b16 v[178:179], v24 offset:3872
    s_add_u32 s42, s34, 102400
    s_cmp_eq_u32 s22, 0
    s_cselect_b32 m0, s41, s40
    s_cselect_b32 s41, s42, s33
    v_mfma_f32_16x16x32_bf16 v[48:51], v[148:151], v[128:131], v[48:51]
    ds_read_b64_tr_b16 v[180:181], v25 offset:0
    ds_read_b64_tr_b16 v[182:183], v25 offset:3840
    buffer_load_dwordx4 v9, s[44:47], s41 offen lds
    s_add_u32 s33, s33, 122880
    v_mfma_f32_16x16x32_bf16 v[52:55], v[148:151], v[132:135], v[52:55]
    s_add_u32 s37, s37, 18432
    s_cmp_eq_u32 s37, 55296
    s_cselect_b32 s37, 0, s37
    s_sub_u32 s48, s48, 15360
    s_cselect_b32 s48, 46080, s48
    s_add_u32 s32, s32, 128
    v_mfma_f32_16x16x32_bf16 v[56:59], v[148:151], v[136:139], v[56:59]
    s_sub_u32 s49, s49, 15360
    s_cselect_b32 s49, 46080, s49
    v_add_u32 v22, s37, v10
    s_add_u32 s31, s31, 128
    s_add_u32 s34, s34, 128
    v_mfma_f32_16x16x32_bf16 v[60:63], v[148:151], v[140:143], v[60:63]
    v_add_u32 v24, s49, v15
    v_add_u32 v25, s49, v16
    s_add_u32 s36, s36, 18432
    s_cmp_eq_u32 s36, 55296
    s_cselect_b32 s36, 0, s36
    v_mfma_f32_16x16x32_bf16 v[64:67], v[152:155], v[128:131], v[64:67]
    v_mfma_f32_16x16x32_bf16 v[68:71], v[152:155], v[132:135], v[68:71]
    v_mfma_f32_16x16x32_bf16 v[72:75], v[152:155], v[136:139], v[72:75]
    v_mfma_f32_16x16x32_bf16 v[76:79], v[152:155], v[140:143], v[76:79]
    s_waitcnt vmcnt(6) lgkmcnt(0)
    s_barrier
    v_mfma_f32_16x16x32_bf16 v[32:35], v[172:175], v[156:159], v[32:35]
    ds_read_b128 v[128:131], v22 offset:2048
    ds_read_b128 v[132:135], v22 offset:4096
    s_add_u32 s40, s30, s36
    s_add_u32 m0, s40, 0
    s_nop 0
    buffer_load_dwordx4 v5, s[8:11], s32 offen lds
    v_mfma_f32_16x16x32_bf16 v[36:39], v[172:175], v[160:163], v[36:39]
    ds_read_b128 v[136:139], v22 offset:6144
    ds_read_b128 v[140:143], v22 offset:8192
    s_add_u32 s40, s30, s48
    s_add_u32 m0, s40, 55296
    s_nop 0
    buffer_load_dwordx4 v7, s[12:15], s33 offen lds
    v_mfma_f32_16x16x32_bf16 v[40:43], v[172:175], v[164:167], v[40:43]
    ds_read_b64_tr_b16 v[144:145], v24 offset:0
    ds_read_b64_tr_b16 v[146:147], v24 offset:3840
    s_add_u32 s40, s40, 62464
    s_add_u32 s41, s36, 8192
    v_mfma_f32_16x16x32_bf16 v[44:47], v[172:175], v[168:171], v[44:47]
    ds_read_b64_tr_b16 v[148:149], v24 offset:32
    ds_read_b64_tr_b16 v[150:151], v24 offset:3872
    s_add_u32 s42, s34, 0
    s_cmp_eq_u32 s22, 0
    s_cselect_b32 m0, s41, s40
    s_cselect_b32 s41, s42, s33
    v_mfma_f32_16x16x32_bf16 v[48:51], v[176:179], v[156:159], v[48:51]
    ds_read_b64_tr_b16 v[152:153], v25 offset:0
    ds_read_b64_tr_b16 v[154:155], v25 offset:3840
    buffer_load_dwordx4 v8, s[44:47], s41 offen lds
    s_add_u32 s33, s33, 122880
    v_mfma_f32_16x16x32_bf16 v[52:55], v[176:179], v[160:163], v[52:55]
    s_sub_u32 s49, s49, 15360
    s_cselect_b32 s49, 46080, s49
    s_sub_u32 s48, s48, 15360
    s_cselect_b32 s48, 46080, s48
    v_mfma_f32_16x16x32_bf16 v[56:59], v[176:179], v[164:167], v[56:59]
    v_add_u32 v22, s37, v11
    v_mfma_f32_16x16x32_bf16 v[60:63], v[176:179], v[168:171], v[60:63]
    v_add_u32 v24, s49, v15
    v_mfma_f32_16x16x32_bf16 v[64:67], v[180:183], v[156:159], v[64:67]
    v_add_u32 v25, s49, v16
    v_mfma_f32_16x16x32_bf16 v[68:71], v[180:183], v[160:163], v[68:71]
    s_add_u32 s35, s35, 2
    s_bitcmp1_b32 s78, s35
    s_cbranch_scc0 G1QE_loop
    s_cmp_eq_u32 s35, s28
    s_cbranch_scc0 G1QE_h0
    v_mfma_f32_16x16x32_bf16 v[200:203], v[28:31], v[180:183], v[200:203]
G1QE_hz:
    s_waitcnt lgkmcnt(0)
    s_nop 3
    v_mfma_f32_16x16x32_bf16 v[200:203], v[28:31], v[152:155], v[200:203]
    s_and_b32 s40, s28, 6
    s_lshl_b32 s40, s40, 7
    s_and_b32 s41, s28, 8
    s_add_u32 s40, s40, s41
    s_add_u32 s40, s40, s29
    s_mov_b64 exec, 0xffff
    s_nop 6
    v_mov_b32 v201, s76
    v_cvt_pk_bf16_f32 v200, v200, v204
    buffer_store_dwordx2 v[200:201], v4, s[64:67], s40 offen sc1
    s_mov_b64 exec, -1
    s_cmp_eq_u32 s35, 0
    s_cbranch_scc1 G1QE_ent
G1QE_h0:
    s_cmp_eq_u32 s35, 4
    s_cbranch_scc0 G1QE_h2
    v_mov_b32 v239, s76
    v_mov_b32 v233, 0
    s_mov_b64 exec, 1
    buffer_store_dwordx2 v[238:239], v233, s[64:67], s68 offen sc1
    buffer_store_dword v239, v233, s[64:67], s79 offen sc1
    s_mov_b64 exec, -1
    s_branch G1QE_loop
G1QE_h2:
    s_cmp_eq_u32 s35, 14
    s_cbranch_scc1 G1QE_end
    s_cmp_eq_u32 s35, 12
    s_cbranch_scc0 G1QE_loop
    buffer_load_dwordx2 v[238:239], v237, s[64:67], 0 offen sc1
    buffer_load_dword v230, v231, s[64:67], 0 offen sc1
    s_branch G1QE_loop
G1QE_sp:
    s_sleep 2
    buffer_load_dwordx2 v[238:239], v237, s[64:67], 0 offen sc1
    buffer_load_dword v230, v231, s[64:67], 0 offen sc1
    s_waitcnt vmcnt(0)
    s_add_u32 s35, s35, 1
    s_cmp_lt_u32 s35, 0x40000
    s_cbranch_scc1 G1QE_vf
    s_branch G1QE_so
G1QE_cs:
    s_sleep 2
    buffer_load_dwordx4 v[252:255], v4, s[64:67], s29 offen sc1
    s_waitcnt vmcnt(0)
    s_add_u32 s35, s35, 1
    s_cmp_lt_u32 s35, 0x40000
    s_cbranch_scc1 G1QE_cv
    s_branch G1QE_co
G1QE_end:
    v_mfma_f32_16x16x32_bf16 v[72:75], v[180:183], v[164:167], v[72:75]
    v_mfma_f32_16x16x32_bf16 v[76:79], v[180:183], v[168:171], v[76:79]
    s_waitcnt vmcnt(6) lgkmcnt(0)
G1QE_vf:
    v_cmp_ne_u32 vcc, s76, v239
    v_cmp_ne_u32 s[40:41], s76, v230
    s_or_b64 vcc, vcc, s[40:41]
    s_cbranch_scc1 G1QE_sp
G1QE_so:
    s_barrier
    v_mfma_f32_16x16x32_bf16 v[32:35], v[144:147], v[128:131], v[32:35]
    ds_read_b128 v[156:159], v22 offset:2048
    ds_read_b128 v[160:163], v22 offset:4096
    s_add_u32 s40, s30, s36
    v_mfma_f32_16x16x32_bf16 v[36:39], v[144:147], v[132:135], v[36:39]
    ds_read_b128 v[164:167], v22 offset:6144
    ds_read_b128 v[168:171], v22 offset:8192
    s_add_u32 m0, s40, 9216
    s_nop 0
    buffer_load_dwordx4 v6, s[8:11], s31 offen lds
    v_mfma_f32_16x16x32_bf16 v[40:43], v[144:147], v[136:139], v[40:43]
    ds_read_b64_tr_b16 v[172:173], v24 offset:0
    ds_read_b64_tr_b16 v[174:175], v24 offset:3840
    s_add_u32 s40, s30, s48
    v_mfma_f32_16x16x32_bf16 v[44:47], v[144:147], v[140:143], v[44:47]
    ds_read_b64_tr_b16 v[176:177], v24 offset:32
    ds_read_b64_tr_b16 v[178:179], v24 offset:3872
    s_add_u32 m0, s40, 55296
    s_nop 0
    buffer_load_dwordx4 v7, s[12:15], s33 offen lds
    v_mfma_f32_16x16x32_bf16 v[48:51], v[148:151], v[128:131], v[48:51]
    ds_read_b64_tr_b16 v[180:181], v25 offset:0
    ds_read_b64_tr_b16 v[182:183], v25 offset:3840
    s_add_u32 s40, s40, 62464
    s_add_u32 s41, s36, 17408
    s_add_u32 s42, s34, 102400
    s_cmp_eq_u32 s22, 0
    s_cselect_b32 m0, s41, s40
    s_cselect_b32 s41, s42, s33
    v_mfma_f32_16x16x32_bf16 v[52:55], v[148:151], v[132:135], v[52:55]
    s_add_u32 s37, s37, 18432
    s_cmp_eq_u32 s37, 55296
    s_cselect_b32 s37, 0, s37
    buffer_load_dwordx4 v9, s[44:47], s41 offen lds
    v_mfma_f32_16x16x32_bf16 v[56:59], v[148:151], v[136:139], v[56:59]
    s_sub_u32 s49, s49, 15360
    s_cselect_b32 s49, 46080, s49
    v_add_u32 v22, s37, v10
    s_add_u32 s33, s33, 122880
    s_sub_u32 s48, s48, 15360
    s_cselect_b32 s48, 46080, s48
    s_add_u32 s32, s32, 128
    s_add_u32 s31, s31, 128
    s_add_u32 s34, s34, 128
    s_add_u32 s36, s36, 18432
    s_cmp_eq_u32 s36, 55296
    s_cselect_b32 s36, 0, s36
    v_mov_b32 v112, v238
    s_add_u32 s52, s18, 0xa00000
    s_addc_u32 s53, s19, 0
    s_and_b32 s53, s53, 0xffff
    s_mov_b32 s54, 0x2a8000
    s_mov_b32 s55, 0x00020000
    s_lshr_b32 s59, s2, 6
    s_cmp_eq_u32 s59, 3
    s_cselect_b32 s59, 0, s59
    s_lshl_b32 s59, s59, 10
    s_add_u32 s60, s59, 1024
    s_cmp_eq_u32 s60, 3072
    s_cselect_b32 s60, 0, s60
    s_add_u32 s61, s60, 1024
    s_cmp_eq_u32 s61, 3072
    s_cselect_b32 s61, 0, s61
    s_bfe_u32 s74, s2, 0x30003
    s_mul_i32 s74, s74, 68*5120
    s_mul_i32 s73, s22, 6*5120
    s_add_u32 s73, s73, s74
    s_add_u32 s73, s73, 20*5120
    s_mul_i32 s70, s59, 5
    s_add_u32 s70, s70, s73
    s_mul_i32 s71, s60, 5
    s_add_u32 s71, s71, s73
    s_mul_i32 s72, s61, 5
    s_add_u32 s72, s72, s73
    s_and_b32 s73, s22, 3
    s_mul_i32 s73, s73, 5*5120
    s_add_u32 s40, s73, s74
    s_mov_b32 s41, s70
    s_mov_b32 s75, s71
    s_mov_b32 s43, s72
    s_cmp_lt_u32 s22, 4
    s_cselect_b32 s70, s41, s40
    s_cmp_lt_u32 s22, 4
    s_cselect_b32 s71, s41, s40
    s_cselect_b32 s35, 15, 5
    s_lshl_b32 s35, s35, 10
    s_add_u32 s71, s71, s35
    s_cmp_lt_u32 s22, 4
    s_cselect_b32 s72, s75, s40
    s_cselect_b32 s35, 0, 10240
    s_add_u32 s72, s72, s35
    s_cmp_lt_u32 s22, 4
    s_cselect_b32 s73, s75, s41
    s_cselect_b32 s35, 15360, 0
    s_add_u32 s73, s73, s35
    s_cmp_lt_u32 s22, 4
    s_cselect_b32 s74, s43, s41
    s_cselect_b32 s35, 0, 15360
    s_add_u32 s74, s74, s35
    s_cmp_lt_u32 s22, 4
    s_cselect_b32 s80, s43, s75
    s_cselect_b32 s35, 15360, 0
    s_add_u32 s80, s80, s35
    s_cmp_lt_u32 s22, 4
    s_cselect_b32 s81, s40, s75
    s_add_u32 s81, s81, 15360
    s_cmp_lt_u32 s22, 4
    s_cselect_b32 s82, s40, s43
    s_cselect_b32 s35, 20480, 0
    s_add_u32 s82, s82, s35
    s_add_u32 s83, s43, 15360
    v_mfma_f32_16x16x32_bf16 v[60:63], v[148:151], v[140:143], v[60:63]
    v_add_u32 v24, s49, v15
    v_add_u32 v25, s49, v16
    s_add_u32 m0, s30, 155648
    s_add_u32 s40, s73, 4096
    buffer_load_dwordx4 v4, s[52:55], s40 offen lds
    v_mfma_f32_16x16x32_bf16 v[64:67], v[152:155], v[128:131], v[64:67]
    v_mfma_f32_16x16x32_bf16 v[68:71], v[152:155], v[132:135], v[68:71]
    s_add_u32 m0, s30, 147456
    s_add_u32 s40, s73, 3072
    buffer_load_dwordx4 v4, s[52:55], s40 offen lds
    v_mfma_f32_16x16x32_bf16 v[72:75], v[152:155], v[136:139], v[72:75]
    v_mfma_f32_16x16x32_bf16 v[76:79], v[152:155], v[140:143], v[76:79]
    s_waitcnt vmcnt(8) lgkmcnt(0)
    s_barrier
    v_mfma_f32_16x16x32_bf16 v[32:35], v[172:175], v[156:159], v[32:35]
    ds_read_b128 v[128:131], v22 offset:2048
    ds_read_b128 v[132:135], v22 offset:4096
    s_add_u32 s40, s30, s48
    v_mfma_f32_16x16x32_bf16 v[36:39], v[172:175], v[160:163], v[36:39]
    ds_read_b128 v[136:139], v22 offset:6144
    ds_read_b128 v[140:143], v22 offset:8192
    s_add_u32 m0, s40, 55296
    s_nop 0
    buffer_load_dwordx4 v7, s[12:15], s33 offen lds
    v_mfma_f32_16x16x32_bf16 v[40:43], v[172:175], v[164:167], v[40:43]
    ds_read_b64_tr_b16 v[144:145], v24 offset:0
    ds_read_b64_tr_b16 v[146:147], v24 offset:3840
    s_add_u32 s40, s40, 62464
    s_add_u32 s41, s36, 8192
    s_add_u32 s42, s34, 0
    s_cmp_eq_u32 s22, 0
    s_cselect_b32 m0, s41, s40
    s_cselect_b32 s41, s42, s33
    v_mfma_f32_16x16x32_bf16 v[44:47], v[172:175], v[168:171], v[44:47]
    ds_read_b64_tr_b16 v[148:149], v24 offset:32
    ds_read_b64_tr_b16 v[150:151], v24 offset:3872
    buffer_load_dwordx4 v8, s[44:47], s41 offen lds
    v_mfma_f32_16x16x32_bf16 v[48:51], v[176:179], v[156:159], v[48:51]
    ds_read_b64_tr_b16 v[152:153], v25 offset:0
    ds_read_b64_tr_b16 v[154:155], v25 offset:3840
    s_add_u32 m0, s30, 139264
    s_add_u32 s40, s73, 2048
    buffer_load_dwordx4 v4, s[52:55], s40 offen lds
    v_mfma_f32_16x16x32_bf16 v[52:55], v[176:179], v[160:163], v[52:55]
    s_sub_u32 s49, s49, 15360
    s_cselect_b32 s49, 46080, s49
    v_mfma_f32_16x16x32_bf16 v[200:203], v[180:183], v[28:31], 0
    v_add_u32 v22, s37, v11
    s_add_u32 m0, s30, 131072
    s_add_u32 s40, s73, 1024
    buffer_load_dwordx4 v4, s[52:55], s40 offen lds
    v_mfma_f32_16x16x32_bf16 v[56:59], v[176:179], v[164:167], v[56:59]
    v_add_u32 v24, s49, v15
    v_mfma_f32_16x16x32_bf16 v[60:63], v[176:179], v[168:171], v[60:63]
    v_add_u32 v25, s49, v16
    s_add_u32 m0, s30, 122880
    s_add_u32 s40, s73, 0
    buffer_load_dwordx4 v4, s[52:55], s40 offen lds
    v_mfma_f32_16x16x32_bf16 v[64:67], v[180:183], v[156:159], v[64:67]
    v_mfma_f32_16x16x32_bf16 v[68:71], v[180:183], v[160:163], v[68:71]
    s_add_u32 s40, s70, 4096
    buffer_load_dwordx4 v[208:211], v4, s[52:55], s40 offen
    v_mfma_f32_16x16x32_bf16 v[72:75], v[180:183], v[164:167], v[72:75]
    v_mfma_f32_16x16x32_bf16 v[76:79], v[180:183], v[168:171], v[76:79]
    s_waitcnt vmcnt(11) lgkmcnt(0)
    s_barrier
    v_mfma_f32_16x16x32_bf16 v[32:35], v[144:147], v[128:131], v[32:35]
    ds_read_b128 v[156:159], v22 offset:2048
    ds_read_b128 v[160:163], v22 offset:4096
    v_mfma_f32_16x16x32_bf16 v[36:39], v[144:147], v[132:135], v[36:39]
    ds_read_b128 v[164:167], v22 offset:6144
    ds_read_b128 v[168:171], v22 offset:8192
    buffer_load_dwordx4 v[252:255], v4, s[64:67], s29 offen sc1
    v_mfma_f32_16x16x32_bf16 v[40:43], v[144:147], v[136:139], v[40:43]
    ds_read_b64_tr_b16 v[172:173], v24 offset:0
    ds_read_b64_tr_b16 v[174:175], v24 offset:3840
    s_add_u32 s8, s18, 0xd00000
    s_addc_u32 s9, s19, 0
    s_and_b32 s9, s9, 0xffff
    s_mov_b32 s10, 0x880000
    s_mov_b32 s11, 0x00020000
    v_and_b32 v13, 15, v2
    v_lshrrev_b32 v14, 4, v2
    v_lshlrev_b32 v17, 2, v14
    v_sub_u32 v18, v13, v17
    v_mfma_f32_16x16x32_bf16 v[44:47], v[144:147], v[140:143], v[44:47]
    ds_read_b64_tr_b16 v[176:177], v24 offset:32
    ds_read_b64_tr_b16 v[178:179], v24 offset:3872
    s_add_u32 m0, s30, 114688
    s_add_u32 s40, s74, 4096
    buffer_load_dwordx4 v4, s[52:55], s40 offen lds
    v_mfma_f32_16x16x32_bf16 v[48:51], v[148:151], v[128:131], v[48:51]
    ds_read_b64_tr_b16 v[180:181], v25 offset:0
    ds_read_b64_tr_b16 v[182:183], v25 offset:3840
    s_mov_b32 s24, 0xf0000000
    v_mov_b32 v114, v18
    v_add_u32 v118, 8, v18
    v_subrev_u32 v115, 1, v18
    v_add_u32 v119, 7, v18
    v_subrev_u32 v116, 2, v18
    v_add_u32 v120, 6, v18
    v_subrev_u32 v117, 3, v18
    s_add_u32 m0, s30, 106496
    s_add_u32 s40, s74, 3072
    buffer_load_dwordx4 v4, s[52:55], s40 offen lds
    v_mfma_f32_16x16x32_bf16 v[52:55], v[148:151], v[132:135], v[52:55]
    s_add_u32 s37, s37, 18432
    v_add_u32 v121, 5, v18
    v_lshrrev_b32 v114, 3, v114
    v_ashrrev_i32 v118, 31, v118
    v_lshrrev_b32 v115, 3, v115
    v_ashrrev_i32 v119, 31, v119
    v_lshrrev_b32 v116, 3, v116
    v_ashrrev_i32 v120, 31, v120
    v_lshrrev_b32 v117, 3, v117
    v_mfma_f32_16x16x32_bf16 v[200:203], v[152:155], v[28:31], v[200:203]
    s_cmp_eq_u32 s37, 55296
    s_cselect_b32 s37, 0, s37
    buffer_load_dwordx4 v[212:215], v4, s[52:55], s71 offen offset:0
    v_mfma_f32_16x16x32_bf16 v[56:59], v[148:151], v[136:139], v[56:59]
    s_sub_u32 s49, s49, 15360
    s_cselect_b32 s49, 46080, s49
    v_ashrrev_i32 v121, 31, v121
    v_min_u32 v114, 1, v114
    v_bfi_b32 v118, v118, 0, s24
    v_min_u32 v115, 1, v115
    v_bfi_b32 v119, v119, 0, s24
    v_min_u32 v116, 1, v116
    v_bfi_b32 v120, v120, 0, s24
    v_min_u32 v117, 1, v117
    v_mfma_f32_16x16x32_bf16 v[60:63], v[148:151], v[140:143], v[60:63]
    v_add_u32 v22, s37, v10
    buffer_load_dwordx4 v[216:219], v4, s[52:55], s71 offen offset:1024
    v_mfma_f32_16x16x32_bf16 v[64:67], v[152:155], v[128:131], v[64:67]
    v_add_u32 v24, s49, v15
    v_bfi_b32 v121, v121, 0, s24
    v_mul_lo_u32 v114, v114, s24
    v_mul_lo_u32 v115, v115, s24
    v_mul_lo_u32 v116, v116, s24
    v_mul_lo_u32 v117, v117, s24
    s_bfe_u32 s62, s22, 0x10001
    s_or_b32 s63, s62, s21
    s_cselect_b32 s25, 0, s24
    v_or_b32 v122, s25, v118
    v_mfma_f32_16x16x32_bf16 v[68:71], v[152:155], v[132:135], v[68:71]
    v_add_u32 v25, s49, v16
    buffer_load_dwordx4 v[220:223], v4, s[52:55], s71 offen offset:2048
    v_mfma_f32_16x16x32_bf16 v[72:75], v[152:155], v[136:139], v[72:75]
    v_mfma_f32_16x16x32_bf16 v[76:79], v[152:155], v[140:143], v[76:79]
    s_waitcnt vmcnt(14) lgkmcnt(0)
    s_barrier
    v_mfma_f32_16x16x32_bf16 v[32:35], v[172:175], v[156:159], v[32:35]
    ds_read_b128 v[128:131], v22 offset:2048
    ds_read_b128 v[132:135], v22 offset:4096
    v_or_b32 v123, s25, v119
    v_or_b32 v124, s25, v120
    v_or_b32 v125, s25, v121
    v_cvt_pk_bf16_f32 v126, v118, v119
    v_cvt_pk_bf16_f32 v127, v120, v121
    v_pk_ashrrev_i16 v126, 15, v126 op_sel_hi:[0,1]
    v_pk_ashrrev_i16 v127, 15, v127 op_sel_hi:[0,1]
    v_add_u32 v5, 16, v2
    v_mfma_f32_16x16x32_bf16 v[36:39], v[172:175], v[160:163], v[36:39]
    ds_read_b128 v[136:139], v22 offset:6144
    ds_read_b128 v[140:143], v22 offset:8192
    s_add_u32 m0, s30, 98304
    s_add_u32 s40, s74, 2048
    buffer_load_dwordx4 v4, s[52:55], s40 offen lds
    v_mfma_f32_16x16x32_bf16 v[40:43], v[172:175], v[164:167], v[40:43]
    ds_read_b64_tr_b16 v[144:145], v24 offset:0
    ds_read_b64_tr_b16 v[146:147], v24 offset:3840
    v_bfe_i32 v5, v5, 6, 1
    s_and_b32 s78, s22, 1
    s_lshl_b32 s63, s62, 2
    s_add_u32 s63, s63, s78
    s_mul_i32 s63, s63, 7808
    s_lshr_b32 s77, s22, 2
    s_mul_i32 s26, s77, 10240
    s_mul_i32 s77, s77, 80
    s_add_u32 s63, s63, s77
    v_mfma_f32_16x16x32_bf16 v[44:47], v[172:175], v[168:171], v[44:47]
    ds_read_b64_tr_b16 v[148:149], v24 offset:32
    ds_read_b64_tr_b16 v[150:151], v24 offset:3872
    buffer_load_dwordx4 v[224:227], v4, s[52:55], s71 offen offset:3072
    v_mfma_f32_16x16x32_bf16 v[48:51], v[176:179], v[156:159], v[48:51]
    ds_read_b64_tr_b16 v[152:153], v25 offset:0
    ds_read_b64_tr_b16 v[154:155], v25 offset:3840
    s_mul_i32 s77, s78, 3904
    s_sub_u32 s77, 58560, s77
    s_cmp_eq_u32 s62, 0
    s_cselect_b32 s77, s77, 0xffffc300
    v_mul_u32_u24 v6, 488, v13
    v_lshl_add_u32 v6, v14, 3, v6
    v_add_u32 v6, s63, v6
    v_add_u32 v7, s77, v6
    v_lshrrev_b32 v18, 2, v2
    v_mul_u32_u24 v18, 488, v18
    v_mfma_f32_16x16x32_bf16 v[52:55], v[176:179], v[160:163], v[52:55]
    s_sub_u32 s49, s49, 15360
    s_cselect_b32 s49, 46080, s49
    s_add_u32 s40, s71, 4096
    buffer_load_dwordx4 v[228:231], v4, s[52:55], s40 offen
    v_mfma_f32_16x16x32_bf16 v[200:203], v[180:183], v[28:31], v[200:203]
    v_add_u32 v22, s37, v11
    v_add_u32 v26, s63, v18
    v_add_u32 v27, s77, v26
    v_and_b32 v18, 3, v2
    v_lshl_add_u32 v8, v18, 3, v26
    v_mfma_f32_16x16x32_bf16 v[56:59], v[176:179], v[164:167], v[56:59]
    v_add_u32 v24, s49, v15
    v_add_u32 v9, s77, v8
    s_lshl_b32 s63, s21, 3
    s_lshl_b32 s62, s62, 2
    s_add_u32 s63, s63, s62
    s_add_u32 s63, s63, s78
    v_mfma_f32_16x16x32_bf16 v[60:63], v[176:179], v[168:171], v[60:63]
    v_add_u32 v25, s49, v16
    buffer_load_dwordx4 v[232:235], v4, s[52:55], s72 offen offset:0
    v_mfma_f32_16x16x32_bf16 v[64:67], v[180:183], v[156:159], v[64:67]
    s_mul_i32 s63, s63, 69632
    s_add_u32 s26, s26, s63
    s_mul_i32 s63, s3, 1280
    s_add_u32 s26, s26, s63
    s_add_u32 s27, s26, 2*69632
    v_mul_u32_u24 v23, 139264, v14
    v_lshl_add_u32 v23, v13, 4, v23
    s_mov_b32 s24, 0x3ea52b5c
    s_mov_b32 s25, 0x3ea52b5c
    v_mfma_f32_16x16x32_bf16 v[68:71], v[180:183], v[160:163], v[68:71]
    buffer_load_dwordx4 v[236:239], v4, s[52:55], s72 offen offset:1024
    v_mfma_f32_16x16x32_bf16 v[72:75], v[180:183], v[164:167], v[72:75]
    v_mfma_f32_16x16x32_bf16 v[76:79], v[180:183], v[168:171], v[76:79]
    s_waitcnt vmcnt(10) lgkmcnt(0)
    s_barrier
    v_mfma_f32_16x16x32_bf16 v[32:35], v[144:147], v[128:131], v[32:35]
    ds_read_b128 v[156:159], v22 offset:2048
    ds_read_b128 v[160:163], v22 offset:4096
    v_lshrrev_b32 v10, 4, v2
    v_lshlrev_b32 v12, 4, v10
    v_mfma_f32_16x16x32_bf16 v[36:39], v[144:147], v[132:135], v[36:39]
    ds_read_b128 v[164:167], v22 offset:6144
    ds_read_b128 v[168:171], v22 offset:8192
    v_add_u32 v18, 70656, v12
    v_lshl_add_u32 v18, v1, 7, v18
    v_xor_b32 v17, 512, v18
    v_mfma_f32_16x16x32_bf16 v[40:43], v[144:147], v[136:139], v[40:43]
G1QE_cv:
    v_cmp_ne_u32 vcc, s76, v253
    v_cmp_ne_u32 s[40:41], s76, v255
    s_or_b64 vcc, vcc, s[40:41]
    s_cbranch_scc1 G1QE_cs
G1QE_co:
    v_and_b32 v255, s50, v252
    v_lshlrev_b32 v253, 16, v254
    ds_read_b64_tr_b16 v[172:173], v24 offset:0
    ds_read_b64_tr_b16 v[174:175], v24 offset:3840
    buffer_load_dwordx4 v[240:243], v4, s[52:55], s72 offen offset:2048
    v_mfma_f32_16x16x32_bf16 v[44:47], v[144:147], v[140:143], v[44:47]
    v_lshlrev_b32 v252, 16, v252
    v_and_b32 v254, s50, v254
    ds_read_b64_tr_b16 v[176:177], v24 offset:32
    ds_read_b64_tr_b16 v[178:179], v24 offset:3872
    v_and_b32 v11, 15, v2
    v_mfma_f32_16x16x32_bf16 v[48:51], v[148:151], v[128:131], v[48:51]
    ds_read_b64_tr_b16 v[180:181], v25 offset:0
    ds_read_b64_tr_b16 v[182:183], v25 offset:3840
    v_lshlrev_b32 v19, 2, v11
    v_lshrrev_b32 v13, 2, v1
    v_mfma_f32_16x16x32_bf16 v[52:55], v[148:151], v[132:135], v[52:55]
    v_lshl_add_u32 v11, v13, 6, v11
    v_and_b32 v13, 3, v1
    v_mfma_f32_16x16x32_bf16 v[200:203], v[152:155], v[28:31], v[200:203]
    buffer_load_dwordx4 v[244:247], v4, s[52:55], s72 offen offset:3072
    v_mfma_f32_16x16x32_bf16 v[56:59], v[148:151], v[136:139], v[56:59]
    v_mul_u32_u24 v14, 488, v11
    v_lshl_add_u32 v14, v10, 3, v14
    v_mfma_f32_16x16x32_bf16 v[60:63], v[148:151], v[140:143], v[60:63]
    v_lshl_add_u32 v14, v13, 7, v14
    v_add_u32 v20, s56, v14
    v_add_u32 v21, s57, v14
    v_mfma_f32_16x16x32_bf16 v[64:67], v[152:155], v[128:131], v[64:67]
    v_mfma_f32_16x16x16_bf16 v[200:203], v[252:253], v[28:29], v[200:203]
    s_add_u32 s40, s72, 4096
    buffer_load_dwordx4 v[248:251], v4, s[52:55], s40 offen
    v_mfma_f32_16x16x32_bf16 v[68:71], v[152:155], v[132:135], v[68:71]
    v_mfma_f32_16x16x32_bf16 v[72:75], v[152:155], v[136:139], v[72:75]
    v_mfma_f32_16x16x32_bf16 v[76:79], v[152:155], v[140:143], v[76:79]
    s_waitcnt lgkmcnt(0)
    s_setprio 3
    s_barrier
    v_mfma_f32_16x16x32_bf16 v[200:203], v[180:183], v[28:31], v[200:203]
    v_mfma_f32_16x16x32_bf16 v[32:35], v[172:175], v[156:159], v[32:35]
    ds_bpermute_b32 v129, v19, v112 offset:0
    ds_bpermute_b32 v133, v19, v112 offset:64
    v_mfma_f32_16x16x32_bf16 v[36:39], v[172:175], v[160:163], v[36:39]
    ds_bpermute_b32 v137, v19, v112 offset:128
    ds_bpermute_b32 v141, v19, v112 offset:192
    v_mfma_f32_16x16x32_bf16 v[40:43], v[172:175], v[164:167], v[40:43]
    s_add_u32 m0, s30, 90112
    s_add_u32 s40, s74, 1024
    buffer_load_dwordx4 v4, s[52:55], s40 offen lds
    s_add_u32 m0, s30, 81920
    s_add_u32 s40, s74, 0
    buffer_load_dwordx4 v4, s[52:55], s40 offen lds
    v_mfma_f32_16x16x32_bf16 v[44:47], v[172:175], v[168:171], v[44:47]
    s_add_u32 m0, s30, 73728
    s_add_u32 s40, s80, 4096
    buffer_load_dwordx4 v4, s[52:55], s40 offen lds
    s_mov_b32 exec_lo, 0x00010001
    s_mov_b32 exec_hi, 0x00010001
    ds_write_b128 v17, v[200:203] offset:0
    s_mov_b64 exec, -1
    v_mfma_f32_16x16x32_bf16 v[48:51], v[176:179], v[156:159], v[48:51]
    s_waitcnt lgkmcnt(0)
    s_barrier
    v_mfma_f32_16x16x32_bf16 v[52:55], v[176:179], v[160:163], v[52:55]
    ds_read_b128 v[148:151], v18 offset:0
    ds_read_b128 v[152:155], v18 offset:64
    v_mfma_f32_16x16x32_bf16 v[56:59], v[176:179], v[164:167], v[56:59]
    v_lshlrev_b32 v128, 16, v129
    v_and_b32 v130, s50, v129
    v_mfma_f32_16x16x32_bf16 v[60:63], v[176:179], v[168:171], v[60:63]
    v_rcp_f32 v130, v130
    v_lshlrev_b32 v132, 16, v133
    v_mfma_f32_16x16x32_bf16 v[64:67], v[180:183], v[156:159], v[64:67]
    v_and_b32 v134, s50, v133
    v_rcp_f32 v134, v134
    v_mfma_f32_16x16x32_bf16 v[68:71], v[180:183], v[160:163], v[68:71]
    v_lshlrev_b32 v136, 16, v137
    v_and_b32 v138, s50, v137
    v_mfma_f32_16x16x32_bf16 v[72:75], v[180:183], v[164:167], v[72:75]
    v_rcp_f32 v138, v138
    v_lshlrev_b32 v140, 16, v141
    v_mfma_f32_16x16x32_bf16 v[76:79], v[180:183], v[168:171], v[76:79]
    v_and_b32 v142, s50, v141
    v_rcp_f32 v142, v142
    s_waitcnt lgkmcnt(0)
    v_pk_fma_f32 v[32:33], v[148:149], v[128:129], v[32:33] op_sel:[0,0,0] op_sel_hi:[1,0,1] neg_lo:[0,1,0] neg_hi:[0,1,0]
    v_pk_fma_f32 v[34:35], v[150:151], v[128:129], v[34:35] op_sel:[0,0,0] op_sel_hi:[1,0,1] neg_lo:[0,1,0] neg_hi:[0,1,0]
    v_pk_mul_f32 v[32:33], v[32:33], v[130:131] op_sel:[0,0] op_sel_hi:[1,0]
    v_pk_mul_f32 v[34:35], v[34:35], v[130:131] op_sel:[0,0] op_sel_hi:[1,0]
    v_cvt_pk_bf16_f32 v32, v32, v33
    v_cvt_pk_bf16_f32 v33, v34, v35
    ds_write_b64 v20, v[32:33] offset:0
    v_pk_fma_f32 v[36:37], v[148:149], v[132:133], v[36:37] op_sel:[0,0,0] op_sel_hi:[1,0,1] neg_lo:[0,1,0] neg_hi:[0,1,0]
    v_pk_fma_f32 v[38:39], v[150:151], v[132:133], v[38:39] op_sel:[0,0,0] op_sel_hi:[1,0,1] neg_lo:[0,1,0] neg_hi:[0,1,0]
    v_pk_mul_f32 v[36:37], v[36:37], v[134:135] op_sel:[0,0] op_sel_hi:[1,0]
    v_pk_mul_f32 v[38:39], v[38:39], v[134:135] op_sel:[0,0] op_sel_hi:[1,0]
    v_cvt_pk_bf16_f32 v36, v36, v37
    v_cvt_pk_bf16_f32 v37, v38, v39
    ds_write_b64 v20, v[36:37] offset:7808
    v_pk_fma_f32 v[40:41], v[148:149], v[136:137], v[40:41] op_sel:[0,0,0] op_sel_hi:[1,0,1] neg_lo:[0,1,0] neg_hi:[0,1,0]
    v_pk_fma_f32 v[42:43], v[150:151], v[136:137], v[42:43] op_sel:[0,0,0] op_sel_hi:[1,0,1] neg_lo:[0,1,0] neg_hi:[0,1,0]
    v_pk_mul_f32 v[40:41], v[40:41], v[138:139] op_sel:[0,0] op_sel_hi:[1,0]
    v_pk_mul_f32 v[42:43], v[42:43], v[138:139] op_sel:[0,0] op_sel_hi:[1,0]
    v_cvt_pk_bf16_f32 v40, v40, v41
    v_cvt_pk_bf16_f32 v41, v42, v43
    ds_write_b64 v20, v[40:41] offset:15616
    v_pk_fma_f32 v[44:45], v[148:149], v[140:141], v[44:45] op_sel:[0,0,0] op_sel_hi:[1,0,1] neg_lo:[0,1,0] neg_hi:[0,1,0]
    v_pk_fma_f32 v[46:47], v[150:151], v[140:141], v[46:47] op_sel:[0,0,0] op_sel_hi:[1,0,1] neg_lo:[0,1,0] neg_hi:[0,1,0]
    v_pk_mul_f32 v[44:45], v[44:45], v[142:143] op_sel:[0,0] op_sel_hi:[1,0]
    v_pk_mul_f32 v[46:47], v[46:47], v[142:143] op_sel:[0,0] op_sel_hi:[1,0]
    v_cvt_pk_bf16_f32 v44, v44, v45
    v_cvt_pk_bf16_f32 v45, v46, v47
    ds_write_b64 v20, v[44:45] offset:23424
    buffer_load_dwordx4 v[192:195], v4, s[52:55], s70 offen offset:0
    v_pk_fma_f32 v[48:49], v[152:153], v[128:129], v[48:49] op_sel:[0,0,0] op_sel_hi:[1,0,1] neg_lo:[0,1,0] neg_hi:[0,1,0]
    v_pk_fma_f32 v[50:51], v[154:155], v[128:129], v[50:51] op_sel:[0,0,0] op_sel_hi:[1,0,1] neg_lo:[0,1,0] neg_hi:[0,1,0]
    v_pk_mul_f32 v[48:49], v[48:49], v[130:131] op_sel:[0,0] op_sel_hi:[1,0]
    v_pk_mul_f32 v[50:51], v[50:51], v[130:131] op_sel:[0,0] op_sel_hi:[1,0]
    v_cvt_pk_bf16_f32 v48, v48, v49
    v_cvt_pk_bf16_f32 v49, v50, v51
    ds_write_b64 v20, v[48:49] offset:32
    v_pk_fma_f32 v[52:53], v[152:153], v[132:133], v[52:53] op_sel:[0,0,0] op_sel_hi:[1,0,1] neg_lo:[0,1,0] neg_hi:[0,1,0]
    v_pk_fma_f32 v[54:55], v[154:155], v[132:133], v[54:55] op_sel:[0,0,0] op_sel_hi:[1,0,1] neg_lo:[0,1,0] neg_hi:[0,1,0]
    v_pk_mul_f32 v[52:53], v[52:53], v[134:135] op_sel:[0,0] op_sel_hi:[1,0]
    v_pk_mul_f32 v[54:55], v[54:55], v[134:135] op_sel:[0,0] op_sel_hi:[1,0]
    v_cvt_pk_bf16_f32 v52, v52, v53
    v_cvt_pk_bf16_f32 v53, v54, v55
    ds_write_b64 v20, v[52:53] offset:7840
    v_pk_fma_f32 v[56:57], v[152:153], v[136:137], v[56:57] op_sel:[0,0,0] op_sel_hi:[1,0,1] neg_lo:[0,1,0] neg_hi:[0,1,0]
    v_pk_fma_f32 v[58:59], v[154:155], v[136:137], v[58:59] op_sel:[0,0,0] op_sel_hi:[1,0,1] neg_lo:[0,1,0] neg_hi:[0,1,0]
    v_pk_mul_f32 v[56:57], v[56:57], v[138:139] op_sel:[0,0] op_sel_hi:[1,0]
    v_pk_mul_f32 v[58:59], v[58:59], v[138:139] op_sel:[0,0] op_sel_hi:[1,0]
    v_cvt_pk_bf16_f32 v56, v56, v57
    v_cvt_pk_bf16_f32 v57, v58, v59
    ds_write_b64 v20, v[56:57] offset:15648
    v_pk_fma_f32 v[60:61], v[152:153], v[140:141], v[60:61] op_sel:[0,0,0] op_sel_hi:[1,0,1] neg_lo:[0,1,0] neg_hi:[0,1,0]
    v_pk_fma_f32 v[62:63], v[154:155], v[140:141], v[62:63] op_sel:[0,0,0] op_sel_hi:[1,0,1] neg_lo:[0,1,0] neg_hi:[0,1,0]
    v_pk_mul_f32 v[60:61], v[60:61], v[142:143] op_sel:[0,0] op_sel_hi:[1,0]
    v_pk_mul_f32 v[62:63], v[62:63], v[142:143] op_sel:[0,0] op_sel_hi:[1,0]
    v_cvt_pk_bf16_f32 v60, v60, v61
    v_cvt_pk_bf16_f32 v61, v62, v63
    ds_write_b64 v20, v[60:61] offset:23456
    buffer_load_dwordx4 v[196:199], v4, s[52:55], s70 offen offset:1024
    v_pk_fma_f32 v[64:65], v[200:201], v[128:129], v[64:65] op_sel:[0,0,0] op_sel_hi:[1,0,1] neg_lo:[0,1,0] neg_hi:[0,1,0]
    v_pk_fma_f32 v[66:67], v[202:203], v[128:129], v[66:67] op_sel:[0,0,0] op_sel_hi:[1,0,1] neg_lo:[0,1,0] neg_hi:[0,1,0]
    v_pk_mul_f32 v[64:65], v[64:65], v[130:131] op_sel:[0,0] op_sel_hi:[1,0]
    v_pk_mul_f32 v[66:67], v[66:67], v[130:131] op_sel:[0,0] op_sel_hi:[1,0]
    v_cvt_pk_bf16_f32 v64, v64, v65
    v_cvt_pk_bf16_f32 v65, v66, v67
    ds_write_b64 v21, v[64:65] offset:0
    v_pk_fma_f32 v[68:69], v[200:201], v[132:133], v[68:69] op_sel:[0,0,0] op_sel_hi:[1,0,1] neg_lo:[0,1,0] neg_hi:[0,1,0]
    v_pk_fma_f32 v[70:71], v[202:203], v[132:133], v[70:71] op_sel:[0,0,0] op_sel_hi:[1,0,1] neg_lo:[0,1,0] neg_hi:[0,1,0]
    v_pk_mul_f32 v[68:69], v[68:69], v[134:135] op_sel:[0,0] op_sel_hi:[1,0]
    v_pk_mul_f32 v[70:71], v[70:71], v[134:135] op_sel:[0,0] op_sel_hi:[1,0]
    v_cvt_pk_bf16_f32 v68, v68, v69
    v_cvt_pk_bf16_f32 v69, v70, v71
    ds_write_b64 v21, v[68:69] offset:7808
    v_pk_fma_f32 v[72:73], v[200:201], v[136:137], v[72:73] op_sel:[0,0,0] op_sel_hi:[1,0,1] neg_lo:[0,1,0] neg_hi:[0,1,0]
    v_pk_fma_f32 v[74:75], v[202:203], v[136:137], v[74:75] op_sel:[0,0,0] op_sel_hi:[1,0,1] neg_lo:[0,1,0] neg_hi:[0,1,0]
    v_pk_mul_f32 v[72:73], v[72:73], v[138:139] op_sel:[0,0] op_sel_hi:[1,0]
    v_pk_mul_f32 v[74:75], v[74:75], v[138:139] op_sel:[0,0] op_sel_hi:[1,0]
    v_cvt_pk_bf16_f32 v72, v72, v73
    v_cvt_pk_bf16_f32 v73, v74, v75
    ds_write_b64 v21, v[72:73] offset:15616
    v_pk_fma_f32 v[76:77], v[200:201], v[140:141], v[76:77] op_sel:[0,0,0] op_sel_hi:[1,0,1] neg_lo:[0,1,0] neg_hi:[0,1,0]
    v_pk_fma_f32 v[78:79], v[202:203], v[140:141], v[78:79] op_sel:[0,0,0] op_sel_hi:[1,0,1] neg_lo:[0,1,0] neg_hi:[0,1,0]
    v_pk_mul_f32 v[76:77], v[76:77], v[142:143] op_sel:[0,0] op_sel_hi:[1,0]
    v_pk_mul_f32 v[78:79], v[78:79], v[142:143] op_sel:[0,0] op_sel_hi:[1,0]
    v_cvt_pk_bf16_f32 v76, v76, v77
    v_cvt_pk_bf16_f32 v77, v78, v79
    ds_write_b64 v21, v[76:77] offset:23424
    s_branch G1_att
G1_att:
    buffer_load_dwordx4 v[200:203], v4, s[52:55], s70 offen offset:2048
    buffer_load_dwordx4 v[204:207], v4, s[52:55], s70 offen offset:3072
    s_waitcnt lgkmcnt(0)
    s_barrier
    ds_read_b64 v[48:49], v6 offset:0
    ds_read_b64 v[50:51], v6 offset:8
    ds_read_b64 v[64:65], v7 offset:160
    ds_read_b64 v[66:67], v7 offset:168
    ds_read_b64 v[68:69], v6 offset:160
    ds_read_b64 v[70:71], v6 offset:168
    ds_read_b64 v[52:53], v6 offset:15616
    ds_read_b64 v[54:55], v6 offset:15624
    ds_read_b64 v[72:73], v6 offset:15776
    ds_read_b64 v[74:75], v6 offset:15784
    ds_read_b64 v[56:57], v6 offset:40
    ds_read_b64 v[58:59], v6 offset:48
    ds_read_b64 v[76:77], v7 offset:200
    ds_read_b64 v[78:79], v7 offset:208
    ds_read_b64 v[80:81], v6 offset:200
    ds_read_b64 v[82:83], v6 offset:208
    ds_read_b64 v[60:61], v6 offset:15656
    ds_read_b64 v[62:63], v6 offset:15664
    ds_read_b64 v[84:85], v6 offset:15816
    ds_read_b64 v[86:87], v6 offset:15824
    s_and_b32 s43, s2, 7
    s_lshl_b32 s43, s43, 2
    s_lshr_b32 s41, s2, 6
    s_add_u32 s43, s43, s41
    s_mul_i32 s40, s43, 4*69632
    s_and_b32 s42, s22, 1
    s_waitcnt lgkmcnt(14)
    v_and_b32 v50, v5, v50
    v_and_b32 v51, v5, v51
    s_mul_i32 s42, s42, 2*69632
    s_add_u32 s12, s40, s42
    v_mfma_f32_16x16x32_bf16 v[128:131], v[64:67], v[48:51], v[122:125]
    v_mfma_f32_16x16x32_bf16 v[144:147], v[68:71], v[48:51], v[114:117]
    s_waitcnt lgkmcnt(10)
    v_and_b32 v54, v5, v54
    v_and_b32 v55, v5, v55
    ds_read_b64_tr_b16 v[88:89], v9 offset:320
    ds_read_b64_tr_b16 v[90:91], v8 offset:320
    ds_read_b64_tr_b16 v[92:93], v8 offset:15936
    ds_read_b64_tr_b16 v[94:95], v27 offset:352
    v_mfma_f32_16x16x32_bf16 v[132:135], v[68:71], v[52:55], v[118:121]
    v_mfma_f32_16x16x32_bf16 v[148:151], v[72:75], v[52:55], v[114:117]
    s_waitcnt lgkmcnt(8)
    v_and_b32 v58, v5, v58
    v_and_b32 v59, v5, v59
    ds_read_b64_tr_b16 v[96:97], v26 offset:352
    ds_read_b64_tr_b16 v[98:99], v26 offset:15968
    ds_read_b64_tr_b16 v[100:101], v9 offset:360
    ds_read_b64_tr_b16 v[102:103], v8 offset:360
    v_mfma_f32_16x16x32_bf16 v[136:139], v[76:79], v[56:59], v[122:125]
    v_mfma_f32_16x16x32_bf16 v[152:155], v[80:83], v[56:59], v[114:117]
    s_waitcnt lgkmcnt(8)
    v_and_b32 v62, v5, v62
    v_and_b32 v63, v5, v63
    ds_read_b64_tr_b16 v[104:105], v8 offset:15976
    ds_read_b64_tr_b16 v[106:107], v27 offset:392
    ds_read_b64_tr_b16 v[108:109], v26 offset:392
    ds_read_b64_tr_b16 v[110:111], v26 offset:16008
    v_mfma_f32_16x16x32_bf16 v[140:143], v[80:83], v[60:63], v[118:121]
    v_mfma_f32_16x16x32_bf16 v[156:159], v[84:87], v[60:63], v[114:117]
    s_add_u32 s13, s12, 69632
    s_sub_u32 s14, s40, s42
    s_add_u32 s14, s14, 2*69632
    s_add_u32 s15, s14, 69632
    v_max_f32 v144, v128, v144
    v_max_f32 v145, v129, v145
    v_max_f32 v146, v130, v146
    v_max_f32 v147, v131, v147
    v_max3_f32 v160, v144, v145, v146
    v_max_f32 v160, v160, v147
    v_max_f32 v148, v132, v148
    v_max_f32 v149, v133, v149
    v_max_f32 v150, v134, v150
    v_max_f32 v151, v135, v151
    v_max3_f32 v162, v148, v149, v150
    v_max_f32 v162, v162, v151
    v_max_f32 v152, v136, v152
    v_max_f32 v153, v137, v153
    v_max_f32 v154, v138, v154
    v_max_f32 v155, v139, v155
    v_max3_f32 v164, v152, v153, v154
    v_max_f32 v164, v164, v155
    s_mul_i32 s40, s22, 6144
    s_add_u32 s40, s40, 20480
    v_max_f32 v156, v140, v156
    v_max_f32 v157, v141, v157
    v_max_f32 v158, v142, v158
    v_max_f32 v159, v143, v159
    v_max3_f32 v166, v156, v157, v158
    v_max_f32 v166, v166, v159
    s_add_u32 s44, s12, s40
    v_permlane16_swap_b32 v160, v162
    v_permlane16_swap_b32 v164, v166
    v_max_f32 v160, v160, v162
    v_max_f32 v164, v164, v166
    s_add_u32 s45, s13, s40
    s_add_u32 s46, s14, s40
    v_permlane32_swap_b32 v160, v164
    v_max_f32 v160, v160, v164
    v_mul_f32 v160, s24, v160
    v_mov_b32 v164, v160
    s_add_u32 s47, s15, s40
    s_mul_i32 s40, s22, 5120
    v_permlane32_swap_b32 v160, v164
    v_mov_b32 v162, v160
    v_mov_b32 v166, v164
    s_and_b32 s42, s22, 4
    s_mul_i32 s41, s42, 5888
    v_permlane16_swap_b32 v160, v162
    v_permlane16_swap_b32 v164, v166
    s_sub_u32 s40, s40, s41
    s_add_u32 s40, s40, 3072
    s_add_u32 s12, s12, s40
    s_add_u32 s13, s13, s40
    s_add_u32 s14, s14, s40
    s_add_u32 s15, s15, s40
    s_lshl_b32 s43, s43, 3
    s_add_u32 s43, s43, s22
    s_lshl_b32 s43, s43, 8
    v_and_b32 v15, 15, v2
    s_lshl_b32 s42, s42, 8
    v_lshrrev_b32 v13, 2, v15
    v_min_u32 v13, 1, v13
    v_mul_u32_u24 v13, s42, v13
    v_lshl_add_u32 v15, v15, 2, s43
    v_sub_u32 v15, v15, v13
    s_waitcnt lgkmcnt(0)
    s_barrier
    v_pk_fma_f32 v[144:145], v[144:145], s[24:25], v[160:161] op_sel_hi:[1,1,0] neg_lo:[0,0,1] neg_hi:[0,0,1]
    v_pk_fma_f32 v[146:147], v[146:147], s[24:25], v[160:161] op_sel_hi:[1,1,0] neg_lo:[0,0,1] neg_hi:[0,0,1]
    v_exp_f32 v144, v144
    v_exp_f32 v145, v145
    v_exp_f32 v146, v146
    v_exp_f32 v147, v147
    s_add_u32 m0, s30, 65536
    s_add_u32 s40, s80, 3072
    buffer_load_dwordx4 v4, s[52:55], s40 offen lds
    v_cvt_pk_bf16_f32 v144, v144, v145
    v_cvt_pk_bf16_f32 v145, v146, v147
    v_bfi_b32 v48, v126, 0, v144
    v_bfi_b32 v49, v127, 0, v145
    v_and_b32 v50, v126, v144
    v_and_b32 v51, v127, v145
    s_add_u32 m0, s30, 57344
    s_add_u32 s40, s80, 2048
    buffer_load_dwordx4 v4, s[52:55], s40 offen lds
    v_pk_fma_f32 v[148:149], v[148:149], s[24:25], v[162:163] op_sel_hi:[1,1,0] neg_lo:[0,0,1] neg_hi:[0,0,1]
    v_pk_fma_f32 v[150:151], v[150:151], s[24:25], v[162:163] op_sel_hi:[1,1,0] neg_lo:[0,0,1] neg_hi:[0,0,1]
    v_exp_f32 v148, v148
    v_exp_f32 v149, v149
    v_exp_f32 v150, v150
    v_exp_f32 v151, v151
    v_cvt_pk_bf16_f32 v148, v148, v149
    v_cvt_pk_bf16_f32 v149, v150, v151
    v_bfi_b32 v52, v126, 0, v148
    v_bfi_b32 v53, v127, 0, v149
    v_and_b32 v54, v126, v148
    v_and_b32 v55, v127, v149
    v_pk_fma_f32 v[152:153], v[152:153], s[24:25], v[164:165] op_sel_hi:[1,1,0] neg_lo:[0,0,1] neg_hi:[0,0,1]
    v_pk_fma_f32 v[154:155], v[154:155], s[24:25], v[164:165] op_sel_hi:[1,1,0] neg_lo:[0,0,1] neg_hi:[0,0,1]
    v_exp_f32 v152, v152
    v_exp_f32 v153, v153
    v_exp_f32 v154, v154
    v_exp_f32 v155, v155
    v_cvt_pk_bf16_f32 v152, v152, v153
    v_cvt_pk_bf16_f32 v153, v154, v155
    v_bfi_b32 v56, v126, 0, v152
    v_bfi_b32 v57, v127, 0, v153
    v_and_b32 v58, v126, v152
    v_and_b32 v59, v127, v153
    v_pk_fma_f32 v[156:157], v[156:157], s[24:25], v[166:167] op_sel_hi:[1,1,0] neg_lo:[0,0,1] neg_hi:[0,0,1]
    v_pk_fma_f32 v[158:159], v[158:159], s[24:25], v[166:167] op_sel_hi:[1,1,0] neg_lo:[0,0,1] neg_hi:[0,0,1]
    v_exp_f32 v156, v156
    v_exp_f32 v157, v157
    v_exp_f32 v158, v158
    v_exp_f32 v159, v159
    v_cvt_pk_bf16_f32 v156, v156, v157
    v_cvt_pk_bf16_f32 v157, v158, v159
    v_bfi_b32 v60, v126, 0, v156
    v_bfi_b32 v61, v127, 0, v157
    v_and_b32 v62, v126, v156
    v_and_b32 v63, v127, v157
    v_mfma_f32_16x16x32_bf16 v[72:75], v[28:31], v[48:51], 0
    v_mfma_f32_16x16x32_bf16 v[64:67], v[88:91], v[48:51], 0
    v_mfma_f32_16x16x32_bf16 v[68:71], v[94:97], v[48:51], 0
    v_mfma_f32_16x16x32_bf16 v[84:87], v[28:31], v[52:55], 0
    v_mfma_f32_16x16x32_bf16 v[76:79], v[90:93], v[52:55], 0
    v_mfma_f32_16x16x32_bf16 v[80:83], v[96:99], v[52:55], 0
    v_mfma_f32_16x16x32_bf16 v[136:139], v[28:31], v[56:59], 0
    v_mfma_f32_16x16x32_bf16 v[128:131], v[100:103], v[56:59], 0
    v_mfma_f32_16x16x32_bf16 v[132:135], v[106:109], v[56:59], 0
    v_mfma_f32_16x16x32_bf16 v[152:155], v[28:31], v[60:63], 0
    v_mfma_f32_16x16x32_bf16 v[144:147], v[102:105], v[60:63], 0
    v_mfma_f32_16x16x32_bf16 v[148:151], v[108:111], v[60:63], 0
    v_rcp_f32 v72, v72
    s_nop 3
    v_pk_mul_f32 v[64:65], v[64:65], v[72:73] op_sel_hi:[1,0]
    v_pk_mul_f32 v[66:67], v[66:67], v[72:73] op_sel_hi:[1,0]
    v_pk_mul_f32 v[68:69], v[68:69], v[72:73] op_sel_hi:[1,0]
    v_pk_mul_f32 v[70:71], v[70:71], v[72:73] op_sel_hi:[1,0]
    v_cvt_pk_bf16_f32 v48, v64, v65
    v_cvt_pk_bf16_f32 v49, v66, v67
    v_cvt_pk_bf16_f32 v56, v68, v69
    v_cvt_pk_bf16_f32 v57, v70, v71
    v_rcp_f32 v136, v136
    s_nop 0
    v_pk_mul_f32 v[128:129], v[128:129], v[136:137] op_sel_hi:[1,0]
    v_pk_mul_f32 v[130:131], v[130:131], v[136:137] op_sel_hi:[1,0]
    v_pk_mul_f32 v[132:133], v[132:133], v[136:137] op_sel_hi:[1,0]
    v_pk_mul_f32 v[134:135], v[134:135], v[136:137] op_sel_hi:[1,0]
    v_cvt_pk_bf16_f32 v50, v128, v129
    v_cvt_pk_bf16_f32 v51, v130, v131
    v_cvt_pk_bf16_f32 v58, v132, v133
    v_cvt_pk_bf16_f32 v59, v134, v135
    buffer_store_dwordx4 v[48:51], v4, s[8:11], s26 offen sc1
    v_rcp_f32 v84, v84
    s_nop 0
    v_pk_mul_f32 v[76:77], v[76:77], v[84:85] op_sel_hi:[1,0]
    v_pk_mul_f32 v[78:79], v[78:79], v[84:85] op_sel_hi:[1,0]
    v_pk_mul_f32 v[80:81], v[80:81], v[84:85] op_sel_hi:[1,0]
    v_pk_mul_f32 v[82:83], v[82:83], v[84:85] op_sel_hi:[1,0]
    v_cvt_pk_bf16_f32 v52, v76, v77
    v_cvt_pk_bf16_f32 v53, v78, v79
    v_rcp_f32 v152, v152
    s_nop 0
    v_pk_mul_f32 v[144:145], v[144:145], v[152:153] op_sel_hi:[1,0]
    v_pk_mul_f32 v[146:147], v[146:147], v[152:153] op_sel_hi:[1,0]
    v_pk_mul_f32 v[148:149], v[148:149], v[152:153] op_sel_hi:[1,0]
    v_pk_mul_f32 v[150:151], v[150:151], v[152:153] op_sel_hi:[1,0]
    v_cvt_pk_bf16_f32 v54, v144, v145
    v_cvt_pk_bf16_f32 v55, v146, v147
    buffer_store_dwordx4 v[52:55], v4, s[8:11], s27 offen sc1
    s_mov_b32 exec_lo, 0xffff0000
    s_mov_b32 exec_hi, 0
    v_cvt_pk_bf16_f32 v56, v80, v81
    v_cvt_pk_bf16_f32 v57, v82, v83
    v_cvt_pk_bf16_f32 v58, v148, v149
    v_cvt_pk_bf16_f32 v59, v150, v151
    s_mov_b32 exec_lo, -1
    buffer_store_dwordx4 v[56:59], v23, s[8:11], s26 offen offset:1024 sc1
    s_mov_b64 exec, -1
    s_waitcnt vmcnt(0)
    s_add_u32 s75, s76, 2
    v_mov_b32 v5, s75
    v_mov_b32 v7, 0
    s_mov_b64 exec, 1
    buffer_store_dword v5, v7, s[64:67], s69 offen sc1
    s_mov_b64 exec, -1
    s_setprio 0
    buffer_load_dword v14, v15, s[64:67], 0 offen sc1
    s_add_u32 m0, s30, 49152
    s_add_u32 s40, s80, 1024
    buffer_load_dwordx4 v4, s[52:55], s40 offen lds
    s_add_u32 m0, s30, 40960
    s_add_u32 s40, s80, 0
    buffer_load_dwordx4 v4, s[52:55], s40 offen lds
    s_add_u32 m0, s30, 32768
    s_add_u32 s40, s81, 4096
    buffer_load_dwordx4 v4, s[52:55], s40 offen lds
    s_add_u32 m0, s30, 24576
    s_add_u32 s40, s81, 3072
    buffer_load_dwordx4 v4, s[52:55], s40 offen lds
    s_add_u32 m0, s30, 16384
    s_add_u32 s40, s81, 2048
    buffer_load_dwordx4 v4, s[52:55], s40 offen lds
    s_add_u32 m0, s30, 8192
    s_add_u32 s40, s81, 1024
    buffer_load_dwordx4 v4, s[52:55], s40 offen lds
    s_add_u32 m0, s30, 0
    s_add_u32 s40, s81, 0
    buffer_load_dwordx4 v4, s[52:55], s40 offen lds
    buffer_load_dwordx4 v[172:175], v4, s[52:55], s82 offen offset:0
    buffer_load_dwordx4 v[176:179], v4, s[52:55], s82 offen offset:1024
    buffer_load_dwordx4 v[180:183], v4, s[52:55], s82 offen offset:2048
    buffer_load_dwordx4 v[184:187], v4, s[52:55], s82 offen offset:3072
    s_add_u32 s40, s82, 4096
    buffer_load_dwordx4 v[188:191], v4, s[52:55], s40 offen
    s_cmp_lt_u32 s22, 4
    s_cbranch_scc1 1f
    buffer_load_dwordx4 v[32:35], v4, s[52:55], s83 offen offset:0
    buffer_load_dwordx4 v[36:39], v4, s[52:55], s83 offen offset:1024
    buffer_load_dwordx4 v[40:43], v4, s[52:55], s83 offen offset:2048
    buffer_load_dwordx4 v[44:47], v4, s[52:55], s83 offen offset:3072
    s_add_u32 s40, s83, 4096
    buffer_load_dwordx4 v[168:171], v4, s[52:55], s40 offen
1:
    v_add_u32 v8, s30, v4
    v_add_u32 v9, 65536, v8
    v_add_u32 v10, 0x20000, v8
    s_and_b32 s24, s22, 1
    s_mov_b32 s80, s16
    s_mov_b32 s81, s17
    s_and_b32 s81, s81, 0xffff
    s_mov_b32 s82, 0x280000
    s_mov_b32 s83, 0x00020000
    v_and_b32 v11, 15, v2
    v_lshrrev_b32 v13, 4, v2
    s_and_b32 s40, s2, 7
    s_lshl_b32 s40, s40, 2
    s_lshr_b32 s41, s2, 6
    s_add_u32 s40, s40, s41
    s_lshl_b32 s40, s40, 6
    s_bfe_u32 s41, s2, 0x30003
    s_and_b32 s42, s41, 1
    s_mul_i32 s41, s41, 160
    s_lshl_b32 s43, s22, 3
    s_add_u32 s43, s43, s40
    s_mul_i32 s43, s43, 1280
    s_add_u32 s43, s43, s41
    s_lshl_b32 s42, s42, 1
    v_lshrrev_b32 v11, 3, v2
    v_and_b32 v13, 7, v2
    v_add_u32 v13, s42, v13
    v_lshrrev_b32 v6, 1, v13
    v_lshlrev_b32 v6, 13, v6
    v_and_b32 v3, 1, v13
    v_lshl_add_u32 v6, v3, 9, v6
    v_and_b32 v3, 7, v13
    v_lshrrev_b32 v12, 4, v2
    v_xor_b32 v3, v3, v12
    s_and_b32 s48, s22, 3
    s_lshl_b32 s48, s48, 2
    v_xor_b32 v3, s48, v3
    v_and_b32 v12, 1, v11
    v_mul_u32_u24 v12, 24, v12
    v_xor_b32 v3, v3, v12
    v_lshl_add_u32 v6, v3, 4, v6
    s_lshr_b32 s48, s22, 2
    s_mul_i32 s48, s48, 40960
    v_add_u32 v6, s48, v6
    v_mul_u32_u24 v11, 1280, v11
    v_lshl_add_u32 v11, v13, 4, v11
    v_add_u32 v11, s43, v11
    v_bfe_u32 v12, v2, 3, 2
    v_bfe_u32 v13, v2, 1, 2
    v_lshl_or_b32 v12, v13, 2, v12
    v_bfe_u32 v13, v2, 5, 1
    v_lshl_or_b32 v12, v13, 4, v12
    v_and_b32 v13, 1, v2
    s_lshl_b32 s43, s24, 5
    s_add_u32 s43, s43, s40
    s_mul_i32 s43, s43, 1280
    s_add_u32 s43, s43, s41
    s_sub_u32 s42, 2, s42
    s_lshl_b32 s48, s42, 6
    s_add_u32 s43, s43, s48
    v_mul_u32_u24 v3, 1280, v12
    v_lshl_add_u32 v3, v13, 4, v3
    v_add_u32 v3, s43, v3
    v_mul_u32_u24 v13, 33, v13
    v_and_b32 v2, 1, v12
    v_mul_u32_u24 v2, 24, v2
    v_xor_b32 v13, v13, v2
    v_lshrrev_b32 v12, 1, v12
    v_xor_b32 v2, v12, v13
    s_lshl_b32 s42, s42, 14
    s_mul_i32 s48, s24, 40960
    s_add_u32 s42, s42, s48
    v_lshl_add_u32 v2, v2, 4, s42
    s_lshl_b32 s48, s2, 3
    s_add_u32 s48, s48, s22
    s_waitcnt vmcnt(12)
    s_branch G2_p
G2:
    buffer_load_dword v14, v15, s[64:67], 0 offen sc1
    s_waitcnt vmcnt(1)
    s_add_u32 s75, s76, 2
    v_mov_b32 v5, s75
    v_mov_b32 v7, 0
    s_mov_b64 exec, 1
    buffer_store_dword v5, v7, s[64:67], s69 offen sc1
    s_mov_b64 exec, -1
    s_setprio 0
    s_add_u32 m0, s30, 40960
    s_add_u32 s40, s80, 0
    buffer_load_dwordx4 v4, s[52:55], s40 offen lds
    s_add_u32 m0, s30, 49152
    s_add_u32 s40, s80, 1024
    buffer_load_dwordx4 v4, s[52:55], s40 offen lds
    s_add_u32 m0, s30, 57344
    s_add_u32 s40, s80, 2048
    buffer_load_dwordx4 v4, s[52:55], s40 offen lds
    s_add_u32 m0, s30, 65536
    s_add_u32 s40, s80, 3072
    buffer_load_dwordx4 v4, s[52:55], s40 offen lds
    s_add_u32 m0, s30, 73728
    s_add_u32 s40, s80, 4096
    buffer_load_dwordx4 v4, s[52:55], s40 offen lds
    s_add_u32 m0, s30, 0
    s_add_u32 s40, s81, 0
    buffer_load_dwordx4 v4, s[52:55], s40 offen lds
    s_add_u32 m0, s30, 8192
    s_add_u32 s40, s81, 1024
    buffer_load_dwordx4 v4, s[52:55], s40 offen lds
    s_add_u32 m0, s30, 16384
    s_add_u32 s40, s81, 2048
    buffer_load_dwordx4 v4, s[52:55], s40 offen lds
    s_add_u32 m0, s30, 24576
    s_add_u32 s40, s81, 3072
    buffer_load_dwordx4 v4, s[52:55], s40 offen lds
    s_add_u32 m0, s30, 32768
    s_add_u32 s40, s81, 4096
    buffer_load_dwordx4 v4, s[52:55], s40 offen lds
    buffer_load_dwordx4 v[172:175], v4, s[52:55], s82 offen offset:0
    buffer_load_dwordx4 v[176:179], v4, s[52:55], s82 offen offset:1024
    buffer_load_dwordx4 v[180:183], v4, s[52:55], s82 offen offset:2048
    buffer_load_dwordx4 v[184:187], v4, s[52:55], s82 offen offset:3072
    s_add_u32 s40, s82, 4096
    buffer_load_dwordx4 v[188:191], v4, s[52:55], s40 offen
    s_cmp_lt_u32 s22, 4
    s_cbranch_scc1 1f
    buffer_load_dwordx4 v[32:35], v4, s[52:55], s83 offen offset:0
    buffer_load_dwordx4 v[36:39], v4, s[52:55], s83 offen offset:1024
    buffer_load_dwordx4 v[40:43], v4, s[52:55], s83 offen offset:2048
    buffer_load_dwordx4 v[44:47], v4, s[52:55], s83 offen offset:3072
    s_add_u32 s40, s83, 4096
    buffer_load_dwordx4 v[168:171], v4, s[52:55], s40 offen
1:
    v_add_u32 v8, s30, v4
    v_add_u32 v9, 65536, v8
    v_add_u32 v10, 0x20000, v8
    s_and_b32 s24, s22, 1
    s_mov_b32 s80, s16
    s_mov_b32 s81, s17
    s_and_b32 s81, s81, 0xffff
    s_mov_b32 s82, 0x280000
    s_mov_b32 s83, 0x00020000
    v_and_b32 v11, 15, v2
    v_lshrrev_b32 v13, 4, v2
    s_and_b32 s40, s2, 7
    s_lshl_b32 s40, s40, 2
    s_lshr_b32 s41, s2, 6
    s_add_u32 s40, s40, s41
    s_lshl_b32 s40, s40, 6
    s_bfe_u32 s41, s2, 0x30003
    s_and_b32 s42, s41, 1
    s_mul_i32 s41, s41, 160
    s_lshl_b32 s43, s22, 3
    s_add_u32 s43, s43, s40
    s_mul_i32 s43, s43, 1280
    s_add_u32 s43, s43, s41
    s_lshl_b32 s42, s42, 1
    v_lshrrev_b32 v11, 3, v2
    v_and_b32 v13, 7, v2
    v_add_u32 v13, s42, v13
    v_lshrrev_b32 v6, 1, v13
    v_lshlrev_b32 v6, 13, v6
    v_and_b32 v3, 1, v13
    v_lshl_add_u32 v6, v3, 9, v6
    v_and_b32 v3, 7, v13
    v_lshrrev_b32 v12, 4, v2
    v_xor_b32 v3, v3, v12
    s_and_b32 s48, s22, 3
    s_lshl_b32 s48, s48, 2
    v_xor_b32 v3, s48, v3
    v_and_b32 v12, 1, v11
    v_mul_u32_u24 v12, 24, v12
    v_xor_b32 v3, v3, v12
    v_lshl_add_u32 v6, v3, 4, v6
    s_lshr_b32 s48, s22, 2
    s_mul_i32 s48, s48, 40960
    v_add_u32 v6, s48, v6
    v_mul_u32_u24 v11, 1280, v11
    v_lshl_add_u32 v11, v13, 4, v11
    v_add_u32 v11, s43, v11
    v_bfe_u32 v12, v2, 3, 2
    v_bfe_u32 v13, v2, 1, 2
    v_lshl_or_b32 v12, v13, 2, v12
    v_bfe_u32 v13, v2, 5, 1
    v_lshl_or_b32 v12, v13, 4, v12
    v_and_b32 v13, 1, v2
    s_lshl_b32 s43, s24, 5
    s_add_u32 s43, s43, s40
    s_mul_i32 s43, s43, 1280
    s_add_u32 s43, s43, s41
    s_sub_u32 s42, 2, s42
    s_lshl_b32 s48, s42, 6
    s_add_u32 s43, s43, s48
    v_mul_u32_u24 v3, 1280, v12
    v_lshl_add_u32 v3, v13, 4, v3
    v_add_u32 v3, s43, v3
    v_mul_u32_u24 v13, 33, v13
    v_and_b32 v2, 1, v12
    v_mul_u32_u24 v2, 24, v2
    v_xor_b32 v13, v13, v2
    v_lshrrev_b32 v12, 1, v12
    v_xor_b32 v2, v12, v13
    s_lshl_b32 s42, s42, 14
    s_mul_i32 s48, s24, 40960
    s_add_u32 s42, s42, s48
    v_lshl_add_u32 v2, v2, 4, s42
    s_lshl_b32 s48, s2, 3
    s_add_u32 s48, s48, s22
    s_waitcnt vmcnt(16)
G2_p:
    s_cmp_lt_u32 s22, 4
    s_cbranch_scc1 G2_lo
    s_setprio 2
    v_cmp_ne_u32 vcc, s75, v14
    s_and_b32 s40, vcc_lo, 0xff0
    s_cbranch_scc0 G2h_n_go
    s_mov_b32 s49, 0
    buffer_load_dword v14, v15, s[64:67], 0 offen sc1
    s_sleep 8
G2h_n:
    buffer_load_dword v5, v15, s[64:67], 0 offen sc1
    s_waitcnt vmcnt(1)
    v_cmp_ne_u32 vcc, s75, v14
    s_and_b32 s40, vcc_lo, 0xff0
    s_cbranch_scc0 G2h_n_go
    buffer_load_dword v14, v15, s[64:67], 0 offen sc1
    s_waitcnt vmcnt(1)
    v_cmp_ne_u32 vcc, s75, v5
    s_and_b32 s40, vcc_lo, 0xff0
    s_cbranch_scc0 G2h_n_go
    s_add_u32 s49, s49, 1
    s_cmp_lt_u32 s49, 0x40000
    s_cbranch_scc1 G2h_n
G2h_n_go:
    s_and_b32 s51, vcc_lo, 0xf
    buffer_load_dwordx4 v[128:131], v4, s[8:11], s12 offen offset:0
    buffer_load_dwordx4 v[132:135], v4, s[8:11], s13 offen offset:0
    buffer_load_dwordx4 v[136:139], v4, s[8:11], s14 offen offset:0
    buffer_load_dwordx4 v[140:143], v4, s[8:11], s15 offen offset:0
    buffer_load_dwordx4 v[144:147], v4, s[8:11], s12 offen offset:1024
    buffer_load_dwordx4 v[148:151], v4, s[8:11], s13 offen offset:1024
    buffer_load_dwordx4 v[152:155], v4, s[8:11], s14 offen offset:1024
    buffer_load_dwordx4 v[156:159], v4, s[8:11], s15 offen offset:1024
    buffer_load_dwordx4 v[16:19], v4, s[8:11], s12 offen offset:2048
    buffer_load_dwordx4 v[20:23], v4, s[8:11], s13 offen offset:2048
    buffer_load_dwordx4 v[24:27], v4, s[8:11], s14 offen offset:2048
    buffer_load_dwordx4 v[28:31], v4, s[8:11], s15 offen offset:2048
    s_cmp_lg_u32 s51, 0
    s_cbranch_scc1 G2h_b
    s_waitcnt vmcnt(8) lgkmcnt(0)
    v_mfma_f32_16x16x32_bf16 v[48:51], v[192:195], v[128:131], 0
    s_cmp_lg_u32 s48, 7
    s_cbranch_scc1 1f
    v_lshlrev_b32 v7, 2, v4
    s_mov_b32 s70, 69636
    s_mov_b32 s71, 73732
    s_mov_b32 s72, 77828
    s_mov_b32 s73, 81924
    buffer_load_dword v160, v7, s[64:67], s70 offen sc1
    buffer_load_dword v161, v7, s[64:67], s71 offen sc1
    buffer_load_dword v162, v7, s[64:67], s72 offen sc1
    buffer_load_dword v163, v7, s[64:67], s73 offen sc1
1:
    v_mfma_f32_16x16x32_bf16 v[52:55], v[192:195], v[132:135], 0
    v_mfma_f32_16x16x32_bf16 v[56:59], v[192:195], v[136:139], 0
    v_mfma_f32_16x16x32_bf16 v[60:63], v[192:195], v[140:143], 0
    v_mfma_f32_16x16x32_bf16 v[64:67], v[196:199], v[128:131], 0
    v_mfma_f32_16x16x32_bf16 v[68:71], v[196:199], v[132:135], 0
    v_mfma_f32_16x16x32_bf16 v[72:75], v[196:199], v[136:139], 0
    v_mfma_f32_16x16x32_bf16 v[76:79], v[196:199], v[140:143], 0
    v_mfma_f32_16x16x32_bf16 v[80:83], v[200:203], v[128:131], 0
    v_mfma_f32_16x16x32_bf16 v[84:87], v[200:203], v[132:135], 0
    v_mfma_f32_16x16x32_bf16 v[88:91], v[200:203], v[136:139], 0
    v_mfma_f32_16x16x32_bf16 v[92:95], v[200:203], v[140:143], 0
    v_mfma_f32_16x16x32_bf16 v[96:99], v[204:207], v[128:131], 0
    v_mfma_f32_16x16x32_bf16 v[100:103], v[204:207], v[132:135], 0
    v_mfma_f32_16x16x32_bf16 v[104:107], v[204:207], v[136:139], 0
    v_mfma_f32_16x16x32_bf16 v[108:111], v[204:207], v[140:143], 0
    v_mfma_f32_16x16x32_bf16 v[112:115], v[208:211], v[128:131], 0
    v_mfma_f32_16x16x32_bf16 v[116:119], v[208:211], v[132:135], 0
    v_mfma_f32_16x16x32_bf16 v[120:123], v[208:211], v[136:139], 0
    v_mfma_f32_16x16x32_bf16 v[124:127], v[208:211], v[140:143], 0
    s_waitcnt vmcnt(4) lgkmcnt(0)
    v_mfma_f32_16x16x32_bf16 v[48:51], v[212:215], v[144:147], v[48:51]
    ds_read_b128 v[192:195], v9 offset:57344
    v_mfma_f32_16x16x32_bf16 v[52:55], v[212:215], v[148:151], v[52:55]
    s_add_u32 s77, s44, s59
    buffer_load_dwordx4 v[128:131], v4, s[8:11], s77 offen offset:0
    v_mfma_f32_16x16x32_bf16 v[56:59], v[212:215], v[152:155], v[56:59]
    ds_read_b128 v[196:199], v10 offset:0
    v_mfma_f32_16x16x32_bf16 v[60:63], v[212:215], v[156:159], v[60:63]
    s_add_u32 s78, s45, s59
    buffer_load_dwordx4 v[132:135], v4, s[8:11], s78 offen offset:0
    v_mfma_f32_16x16x32_bf16 v[64:67], v[216:219], v[144:147], v[64:67]
    ds_read_b128 v[200:203], v10 offset:8192
    v_mfma_f32_16x16x32_bf16 v[68:71], v[216:219], v[148:151], v[68:71]
    s_add_u32 s79, s46, s59
    buffer_load_dwordx4 v[136:139], v4, s[8:11], s79 offen offset:0
    v_mfma_f32_16x16x32_bf16 v[72:75], v[216:219], v[152:155], v[72:75]
    ds_read_b128 v[204:207], v10 offset:16384
    v_mfma_f32_16x16x32_bf16 v[76:79], v[216:219], v[156:159], v[76:79]
    s_add_u32 s3, s47, s59
    buffer_load_dwordx4 v[140:143], v4, s[8:11], s3 offen offset:0
    v_mfma_f32_16x16x32_bf16 v[80:83], v[220:223], v[144:147], v[80:83]
    ds_read_b128 v[208:211], v10 offset:24576
    v_mfma_f32_16x16x32_bf16 v[84:87], v[220:223], v[148:151], v[84:87]
    buffer_load_dwordx4 v[252:255], v11, s[80:83], 0 offen
    v_mfma_f32_16x16x32_bf16 v[88:91], v[220:223], v[152:155], v[88:91]
    v_mfma_f32_16x16x32_bf16 v[92:95], v[220:223], v[156:159], v[92:95]
    v_mfma_f32_16x16x32_bf16 v[96:99], v[224:227], v[144:147], v[96:99]
    v_mfma_f32_16x16x32_bf16 v[100:103], v[224:227], v[148:151], v[100:103]
    v_mfma_f32_16x16x32_bf16 v[104:107], v[224:227], v[152:155], v[104:107]
    v_mfma_f32_16x16x32_bf16 v[108:111], v[224:227], v[156:159], v[108:111]
    v_mfma_f32_16x16x32_bf16 v[112:115], v[228:231], v[144:147], v[112:115]
    v_mfma_f32_16x16x32_bf16 v[116:119], v[228:231], v[148:151], v[116:119]
    v_mfma_f32_16x16x32_bf16 v[120:123], v[228:231], v[152:155], v[120:123]
    v_mfma_f32_16x16x32_bf16 v[124:127], v[228:231], v[156:159], v[124:127]
    s_waitcnt vmcnt(5) lgkmcnt(0)
    v_mfma_f32_16x16x32_bf16 v[48:51], v[232:235], v[16:19], v[48:51]
    ds_read_b128 v[212:215], v9 offset:16384
    v_mfma_f32_16x16x32_bf16 v[52:55], v[232:235], v[20:23], v[52:55]
    buffer_load_dwordx4 v[144:147], v4, s[8:11], s77 offen offset:3072
    v_mfma_f32_16x16x32_bf16 v[56:59], v[232:235], v[24:27], v[56:59]
    ds_read_b128 v[216:219], v9 offset:24576
    v_mfma_f32_16x16x32_bf16 v[60:63], v[232:235], v[28:31], v[60:63]
    buffer_load_dwordx4 v[148:151], v4, s[8:11], s78 offen offset:3072
    v_mfma_f32_16x16x32_bf16 v[64:67], v[236:239], v[16:19], v[64:67]
    ds_read_b128 v[220:223], v9 offset:32768
    v_mfma_f32_16x16x32_bf16 v[68:71], v[236:239], v[20:23], v[68:71]
    buffer_load_dwordx4 v[152:155], v4, s[8:11], s79 offen offset:3072
    v_mfma_f32_16x16x32_bf16 v[72:75], v[236:239], v[24:27], v[72:75]
    ds_read_b128 v[224:227], v9 offset:40960
    v_mfma_f32_16x16x32_bf16 v[76:79], v[236:239], v[28:31], v[76:79]
    buffer_load_dwordx4 v[156:159], v4, s[8:11], s3 offen offset:3072
    v_mfma_f32_16x16x32_bf16 v[80:83], v[240:243], v[16:19], v[80:83]
    ds_read_b128 v[228:231], v9 offset:49152
    v_mfma_f32_16x16x32_bf16 v[84:87], v[240:243], v[20:23], v[84:87]
    v_mfma_f32_16x16x32_bf16 v[88:91], v[240:243], v[24:27], v[88:91]
    v_mfma_f32_16x16x32_bf16 v[92:95], v[240:243], v[28:31], v[92:95]
    v_mfma_f32_16x16x32_bf16 v[96:99], v[244:247], v[16:19], v[96:99]
    v_mfma_f32_16x16x32_bf16 v[100:103], v[244:247], v[20:23], v[100:103]
    v_mfma_f32_16x16x32_bf16 v[104:107], v[244:247], v[24:27], v[104:107]
    v_mfma_f32_16x16x32_bf16 v[108:111], v[244:247], v[28:31], v[108:111]
    v_mfma_f32_16x16x32_bf16 v[112:115], v[248:251], v[16:19], v[112:115]
    v_mfma_f32_16x16x32_bf16 v[116:119], v[248:251], v[20:23], v[116:119]
    v_mfma_f32_16x16x32_bf16 v[120:123], v[248:251], v[24:27], v[120:123]
    v_mfma_f32_16x16x32_bf16 v[124:127], v[248:251], v[28:31], v[124:127]
    s_add_u32 s77, s44, s60
    buffer_load_dwordx4 v[16:19], v4, s[8:11], s77 offen offset:0
    s_add_u32 s78, s45, s60
    buffer_load_dwordx4 v[20:23], v4, s[8:11], s78 offen offset:0
    s_add_u32 s79, s46, s60
    buffer_load_dwordx4 v[24:27], v4, s[8:11], s79 offen offset:0
    s_add_u32 s3, s47, s60
    buffer_load_dwordx4 v[28:31], v4, s[8:11], s3 offen offset:0
    s_branch G2h_m
G2h_b:
    s_waitcnt vmcnt(8) lgkmcnt(0)
    v_mfma_f32_16x16x32_bf16 v[48:51], v[192:195], v[128:131], 0
    buffer_load_dword v14, v15, s[64:67], 0 offen sc1
    v_mfma_f32_16x16x32_bf16 v[52:55], v[192:195], v[132:135], 0
    s_cmp_lg_u32 s48, 7
    s_cbranch_scc1 1f
    v_lshlrev_b32 v7, 2, v4
    s_mov_b32 s70, 69636
    s_mov_b32 s71, 73732
    s_mov_b32 s72, 77828
    s_mov_b32 s73, 81924
    buffer_load_dword v160, v7, s[64:67], s70 offen sc1
    buffer_load_dword v161, v7, s[64:67], s71 offen sc1
    buffer_load_dword v162, v7, s[64:67], s72 offen sc1
    buffer_load_dword v163, v7, s[64:67], s73 offen sc1
1:
    v_mfma_f32_16x16x32_bf16 v[56:59], v[192:195], v[136:139], 0
    v_mfma_f32_16x16x32_bf16 v[60:63], v[192:195], v[140:143], 0
    v_mfma_f32_16x16x32_bf16 v[64:67], v[196:199], v[128:131], 0
    v_mfma_f32_16x16x32_bf16 v[68:71], v[196:199], v[132:135], 0
    v_mfma_f32_16x16x32_bf16 v[72:75], v[196:199], v[136:139], 0
    v_mfma_f32_16x16x32_bf16 v[76:79], v[196:199], v[140:143], 0
    v_mfma_f32_16x16x32_bf16 v[80:83], v[200:203], v[128:131], 0
    v_mfma_f32_16x16x32_bf16 v[84:87], v[200:203], v[132:135], 0
    v_mfma_f32_16x16x32_bf16 v[88:91], v[200:203], v[136:139], 0
    v_mfma_f32_16x16x32_bf16 v[92:95], v[200:203], v[140:143], 0
    v_mfma_f32_16x16x32_bf16 v[96:99], v[204:207], v[128:131], 0
    v_mfma_f32_16x16x32_bf16 v[100:103], v[204:207], v[132:135], 0
    v_mfma_f32_16x16x32_bf16 v[104:107], v[204:207], v[136:139], 0
    v_mfma_f32_16x16x32_bf16 v[108:111], v[204:207], v[140:143], 0
    v_mfma_f32_16x16x32_bf16 v[112:115], v[208:211], v[128:131], 0
    v_mfma_f32_16x16x32_bf16 v[116:119], v[208:211], v[132:135], 0
    v_mfma_f32_16x16x32_bf16 v[120:123], v[208:211], v[136:139], 0
    v_mfma_f32_16x16x32_bf16 v[124:127], v[208:211], v[140:143], 0
    s_waitcnt vmcnt(5) lgkmcnt(0)
    v_mfma_f32_16x16x32_bf16 v[48:51], v[212:215], v[144:147], v[48:51]
    ds_read_b128 v[192:195], v9 offset:57344
    v_mfma_f32_16x16x32_bf16 v[52:55], v[212:215], v[148:151], v[52:55]
    buffer_load_dwordx4 v[252:255], v11, s[80:83], 0 offen
    v_mfma_f32_16x16x32_bf16 v[56:59], v[212:215], v[152:155], v[56:59]
    ds_read_b128 v[196:199], v10 offset:0
    v_mfma_f32_16x16x32_bf16 v[60:63], v[212:215], v[156:159], v[60:63]
    ds_read_b128 v[200:203], v10 offset:8192
    v_mfma_f32_16x16x32_bf16 v[64:67], v[216:219], v[144:147], v[64:67]
    ds_read_b128 v[204:207], v10 offset:16384
    v_mfma_f32_16x16x32_bf16 v[68:71], v[216:219], v[148:151], v[68:71]
    ds_read_b128 v[208:211], v10 offset:24576
    v_mfma_f32_16x16x32_bf16 v[72:75], v[216:219], v[152:155], v[72:75]
    v_mfma_f32_16x16x32_bf16 v[76:79], v[216:219], v[156:159], v[76:79]
    v_mfma_f32_16x16x32_bf16 v[80:83], v[220:223], v[144:147], v[80:83]
    v_mfma_f32_16x16x32_bf16 v[84:87], v[220:223], v[148:151], v[84:87]
    v_mfma_f32_16x16x32_bf16 v[88:91], v[220:223], v[152:155], v[88:91]
    v_mfma_f32_16x16x32_bf16 v[92:95], v[220:223], v[156:159], v[92:95]
    v_mfma_f32_16x16x32_bf16 v[96:99], v[224:227], v[144:147], v[96:99]
    v_mfma_f32_16x16x32_bf16 v[100:103], v[224:227], v[148:151], v[100:103]
    v_mfma_f32_16x16x32_bf16 v[104:107], v[224:227], v[152:155], v[104:107]
    v_mfma_f32_16x16x32_bf16 v[108:111], v[224:227], v[156:159], v[108:111]
    v_mfma_f32_16x16x32_bf16 v[112:115], v[228:231], v[144:147], v[112:115]
    v_mfma_f32_16x16x32_bf16 v[116:119], v[228:231], v[148:151], v[116:119]
    v_mfma_f32_16x16x32_bf16 v[120:123], v[228:231], v[152:155], v[120:123]
    v_mfma_f32_16x16x32_bf16 v[124:127], v[228:231], v[156:159], v[124:127]
    s_waitcnt vmcnt(1) lgkmcnt(0)
    v_cmp_ne_u32 vcc, s75, v14
    s_and_b32 s40, vcc_lo, 0xf
    s_cbranch_scc0 G2h_r2
    v_mfma_f32_16x16x32_bf16 v[48:51], v[232:235], v[16:19], v[48:51]
    ds_read_b128 v[212:215], v9 offset:16384
    v_mfma_f32_16x16x32_bf16 v[52:55], v[232:235], v[20:23], v[52:55]
    buffer_load_dword v14, v15, s[64:67], 0 offen sc1
    v_mfma_f32_16x16x32_bf16 v[56:59], v[232:235], v[24:27], v[56:59]
    ds_read_b128 v[216:219], v9 offset:24576
    v_mfma_f32_16x16x32_bf16 v[60:63], v[232:235], v[28:31], v[60:63]
    ds_read_b128 v[220:223], v9 offset:32768
    v_mfma_f32_16x16x32_bf16 v[64:67], v[236:239], v[16:19], v[64:67]
    ds_read_b128 v[224:227], v9 offset:40960
    v_mfma_f32_16x16x32_bf16 v[68:71], v[236:239], v[20:23], v[68:71]
    ds_read_b128 v[228:231], v9 offset:49152
    v_mfma_f32_16x16x32_bf16 v[72:75], v[236:239], v[24:27], v[72:75]
    v_mfma_f32_16x16x32_bf16 v[76:79], v[236:239], v[28:31], v[76:79]
    v_mfma_f32_16x16x32_bf16 v[80:83], v[240:243], v[16:19], v[80:83]
    v_mfma_f32_16x16x32_bf16 v[84:87], v[240:243], v[20:23], v[84:87]
    v_mfma_f32_16x16x32_bf16 v[88:91], v[240:243], v[24:27], v[88:91]
    v_mfma_f32_16x16x32_bf16 v[92:95], v[240:243], v[28:31], v[92:95]
    v_mfma_f32_16x16x32_bf16 v[96:99], v[244:247], v[16:19], v[96:99]
    v_mfma_f32_16x16x32_bf16 v[100:103], v[244:247], v[20:23], v[100:103]
    v_mfma_f32_16x16x32_bf16 v[104:107], v[244:247], v[24:27], v[104:107]
    v_mfma_f32_16x16x32_bf16 v[108:111], v[244:247], v[28:31], v[108:111]
    v_mfma_f32_16x16x32_bf16 v[112:115], v[248:251], v[16:19], v[112:115]
    v_mfma_f32_16x16x32_bf16 v[116:119], v[248:251], v[20:23], v[116:119]
    v_mfma_f32_16x16x32_bf16 v[120:123], v[248:251], v[24:27], v[120:123]
    v_mfma_f32_16x16x32_bf16 v[124:127], v[248:251], v[28:31], v[124:127]
    s_waitcnt vmcnt(0)
    v_cmp_ne_u32 vcc, s75, v14
    s_and_b32 s40, vcc_lo, 0xf
    s_cbranch_scc0 G2h_nq_go
    s_mov_b32 s49, 0
    buffer_load_dword v14, v15, s[64:67], 0 offen sc1
    s_sleep 8
G2h_nq:
    buffer_load_dword v5, v15, s[64:67], 0 offen sc1
    s_waitcnt vmcnt(1)
    v_cmp_ne_u32 vcc, s75, v14
    s_and_b32 s40, vcc_lo, 0xf
    s_cbranch_scc0 G2h_nq_go
    buffer_load_dword v14, v15, s[64:67], 0 offen sc1
    s_waitcnt vmcnt(1)
    v_cmp_ne_u32 vcc, s75, v5
    s_and_b32 s40, vcc_lo, 0xf
    s_cbranch_scc0 G2h_nq_go
    s_add_u32 s49, s49, 1
    s_cmp_lt_u32 s49, 0x40000
    s_cbranch_scc1 G2h_nq
G2h_nq_go:
    s_add_u32 s77, s44, s59
    buffer_load_dwordx4 v[128:131], v4, s[8:11], s77 offen offset:0
    s_add_u32 s78, s45, s59
    buffer_load_dwordx4 v[132:135], v4, s[8:11], s78 offen offset:0
    s_add_u32 s79, s46, s59
    buffer_load_dwordx4 v[136:139], v4, s[8:11], s79 offen offset:0
    s_add_u32 s3, s47, s59
    buffer_load_dwordx4 v[140:143], v4, s[8:11], s3 offen offset:0
    buffer_load_dwordx4 v[144:147], v4, s[8:11], s77 offen offset:3072
    buffer_load_dwordx4 v[148:151], v4, s[8:11], s78 offen offset:3072
    buffer_load_dwordx4 v[152:155], v4, s[8:11], s79 offen offset:3072
    buffer_load_dwordx4 v[156:159], v4, s[8:11], s3 offen offset:3072
    s_add_u32 s77, s44, s60
    buffer_load_dwordx4 v[16:19], v4, s[8:11], s77 offen offset:0
    s_add_u32 s78, s45, s60
    buffer_load_dwordx4 v[20:23], v4, s[8:11], s78 offen offset:0
    s_add_u32 s79, s46, s60
    buffer_load_dwordx4 v[24:27], v4, s[8:11], s79 offen offset:0
    s_add_u32 s3, s47, s60
    buffer_load_dwordx4 v[28:31], v4, s[8:11], s3 offen offset:0
    s_branch G2h_m
G2h_r2:
    v_mfma_f32_16x16x32_bf16 v[48:51], v[232:235], v[16:19], v[48:51]
    ds_read_b128 v[212:215], v9 offset:16384
    v_mfma_f32_16x16x32_bf16 v[52:55], v[232:235], v[20:23], v[52:55]
    s_add_u32 s77, s44, s59
    buffer_load_dwordx4 v[128:131], v4, s[8:11], s77 offen offset:0
    v_mfma_f32_16x16x32_bf16 v[56:59], v[232:235], v[24:27], v[56:59]
    ds_read_b128 v[216:219], v9 offset:24576
    v_mfma_f32_16x16x32_bf16 v[60:63], v[232:235], v[28:31], v[60:63]
    s_add_u32 s78, s45, s59
    buffer_load_dwordx4 v[132:135], v4, s[8:11], s78 offen offset:0
    v_mfma_f32_16x16x32_bf16 v[64:67], v[236:239], v[16:19], v[64:67]
    ds_read_b128 v[220:223], v9 offset:32768
    v_mfma_f32_16x16x32_bf16 v[68:71], v[236:239], v[20:23], v[68:71]
    s_add_u32 s79, s46, s59
    buffer_load_dwordx4 v[136:139], v4, s[8:11], s79 offen offset:0
    v_mfma_f32_16x16x32_bf16 v[72:75], v[236:239], v[24:27], v[72:75]
    ds_read_b128 v[224:227], v9 offset:40960
    v_mfma_f32_16x16x32_bf16 v[76:79], v[236:239], v[28:31], v[76:79]
    s_add_u32 s3, s47, s59
    buffer_load_dwordx4 v[140:143], v4, s[8:11], s3 offen offset:0
    v_mfma_f32_16x16x32_bf16 v[80:83], v[240:243], v[16:19], v[80:83]
    ds_read_b128 v[228:231], v9 offset:49152
    v_mfma_f32_16x16x32_bf16 v[84:87], v[240:243], v[20:23], v[84:87]
    buffer_load_dwordx4 v[144:147], v4, s[8:11], s77 offen offset:3072
    v_mfma_f32_16x16x32_bf16 v[88:91], v[240:243], v[24:27], v[88:91]
    buffer_load_dwordx4 v[148:151], v4, s[8:11], s78 offen offset:3072
    v_mfma_f32_16x16x32_bf16 v[92:95], v[240:243], v[28:31], v[92:95]
    buffer_load_dwordx4 v[152:155], v4, s[8:11], s79 offen offset:3072
    v_mfma_f32_16x16x32_bf16 v[96:99], v[244:247], v[16:19], v[96:99]
    buffer_load_dwordx4 v[156:159], v4, s[8:11], s3 offen offset:3072
    v_mfma_f32_16x16x32_bf16 v[100:103], v[244:247], v[20:23], v[100:103]
    v_mfma_f32_16x16x32_bf16 v[104:107], v[244:247], v[24:27], v[104:107]
    v_mfma_f32_16x16x32_bf16 v[108:111], v[244:247], v[28:31], v[108:111]
    v_mfma_f32_16x16x32_bf16 v[112:115], v[248:251], v[16:19], v[112:115]
    v_mfma_f32_16x16x32_bf16 v[116:119], v[248:251], v[20:23], v[116:119]
    v_mfma_f32_16x16x32_bf16 v[120:123], v[248:251], v[24:27], v[120:123]
    v_mfma_f32_16x16x32_bf16 v[124:127], v[248:251], v[28:31], v[124:127]
    s_add_u32 s77, s44, s60
    buffer_load_dwordx4 v[16:19], v4, s[8:11], s77 offen offset:0
    s_add_u32 s78, s45, s60
    buffer_load_dwordx4 v[20:23], v4, s[8:11], s78 offen offset:0
    s_add_u32 s79, s46, s60
    buffer_load_dwordx4 v[24:27], v4, s[8:11], s79 offen offset:0
    s_add_u32 s3, s47, s60
    buffer_load_dwordx4 v[28:31], v4, s[8:11], s3 offen offset:0
G2h_m:
    s_waitcnt vmcnt(8) lgkmcnt(0)
    v_mfma_f32_16x16x32_bf16 v[48:51], v[192:195], v[128:131], v[48:51]
    v_mfma_f32_16x16x32_bf16 v[52:55], v[192:195], v[132:135], v[52:55]
    v_mfma_f32_16x16x32_bf16 v[56:59], v[192:195], v[136:139], v[56:59]
    v_mfma_f32_16x16x32_bf16 v[60:63], v[192:195], v[140:143], v[60:63]
    v_mfma_f32_16x16x32_bf16 v[64:67], v[196:199], v[128:131], v[64:67]
    v_mfma_f32_16x16x32_bf16 v[68:71], v[196:199], v[132:135], v[68:71]
    v_mfma_f32_16x16x32_bf16 v[72:75], v[196:199], v[136:139], v[72:75]
    v_mfma_f32_16x16x32_bf16 v[76:79], v[196:199], v[140:143], v[76:79]
    v_mfma_f32_16x16x32_bf16 v[80:83], v[200:203], v[128:131], v[80:83]
    v_mfma_f32_16x16x32_bf16 v[84:87], v[200:203], v[132:135], v[84:87]
    v_mfma_f32_16x16x32_bf16 v[88:91], v[200:203], v[136:139], v[88:91]
    v_mfma_f32_16x16x32_bf16 v[92:95], v[200:203], v[140:143], v[92:95]
    v_mfma_f32_16x16x32_bf16 v[96:99], v[204:207], v[128:131], v[96:99]
    v_mfma_f32_16x16x32_bf16 v[100:103], v[204:207], v[132:135], v[100:103]
    v_mfma_f32_16x16x32_bf16 v[104:107], v[204:207], v[136:139], v[104:107]
    v_mfma_f32_16x16x32_bf16 v[108:111], v[204:207], v[140:143], v[108:111]
    v_mfma_f32_16x16x32_bf16 v[112:115], v[208:211], v[128:131], v[112:115]
    v_mfma_f32_16x16x32_bf16 v[116:119], v[208:211], v[132:135], v[116:119]
    v_mfma_f32_16x16x32_bf16 v[120:123], v[208:211], v[136:139], v[120:123]
    v_mfma_f32_16x16x32_bf16 v[124:127], v[208:211], v[140:143], v[124:127]
    s_waitcnt vmcnt(4) lgkmcnt(0)
    v_mfma_f32_16x16x32_bf16 v[48:51], v[212:215], v[144:147], v[48:51]
    ds_read_b128 v[192:195], v8 offset:40960
    v_mfma_f32_16x16x32_bf16 v[52:55], v[212:215], v[148:151], v[52:55]
    buffer_load_dwordx4 v[232:235], v4, s[8:11], s77 offen offset:3072
    v_mfma_f32_16x16x32_bf16 v[56:59], v[212:215], v[152:155], v[56:59]
    ds_read_b128 v[196:199], v8 offset:49152
    v_mfma_f32_16x16x32_bf16 v[60:63], v[212:215], v[156:159], v[60:63]
    buffer_load_dwordx4 v[236:239], v4, s[8:11], s78 offen offset:3072
    v_mfma_f32_16x16x32_bf16 v[64:67], v[216:219], v[144:147], v[64:67]
    ds_read_b128 v[200:203], v8 offset:57344
    v_mfma_f32_16x16x32_bf16 v[68:71], v[216:219], v[148:151], v[68:71]
    buffer_load_dwordx4 v[240:243], v4, s[8:11], s79 offen offset:3072
    v_mfma_f32_16x16x32_bf16 v[72:75], v[216:219], v[152:155], v[72:75]
    ds_read_b128 v[204:207], v9 offset:0
    v_mfma_f32_16x16x32_bf16 v[76:79], v[216:219], v[156:159], v[76:79]
    buffer_load_dwordx4 v[244:247], v4, s[8:11], s3 offen offset:3072
    v_mfma_f32_16x16x32_bf16 v[80:83], v[220:223], v[144:147], v[80:83]
    ds_read_b128 v[208:211], v9 offset:8192
    v_mfma_f32_16x16x32_bf16 v[84:87], v[220:223], v[148:151], v[84:87]
    v_mfma_f32_16x16x32_bf16 v[88:91], v[220:223], v[152:155], v[88:91]
    v_mfma_f32_16x16x32_bf16 v[92:95], v[220:223], v[156:159], v[92:95]
    v_mfma_f32_16x16x32_bf16 v[96:99], v[224:227], v[144:147], v[96:99]
    v_mfma_f32_16x16x32_bf16 v[100:103], v[224:227], v[148:151], v[100:103]
    v_mfma_f32_16x16x32_bf16 v[104:107], v[224:227], v[152:155], v[104:107]
    v_mfma_f32_16x16x32_bf16 v[108:111], v[224:227], v[156:159], v[108:111]
    v_mfma_f32_16x16x32_bf16 v[112:115], v[228:231], v[144:147], v[112:115]
    v_mfma_f32_16x16x32_bf16 v[116:119], v[228:231], v[148:151], v[116:119]
    v_mfma_f32_16x16x32_bf16 v[120:123], v[228:231], v[152:155], v[120:123]
    v_mfma_f32_16x16x32_bf16 v[124:127], v[228:231], v[156:159], v[124:127]
    s_waitcnt vmcnt(4) lgkmcnt(0)
    v_mfma_f32_16x16x32_bf16 v[48:51], v[192:195], v[16:19], v[48:51]
    ds_read_b128 v[212:215], v8 offset:0
    v_mfma_f32_16x16x32_bf16 v[52:55], v[192:195], v[20:23], v[52:55]
    s_add_u32 s77, s44, s61
    buffer_load_dwordx4 v[128:131], v4, s[8:11], s77 offen offset:0
    v_mfma_f32_16x16x32_bf16 v[56:59], v[192:195], v[24:27], v[56:59]
    ds_read_b128 v[216:219], v8 offset:8192
    v_mfma_f32_16x16x32_bf16 v[60:63], v[192:195], v[28:31], v[60:63]
    s_add_u32 s78, s45, s61
    buffer_load_dwordx4 v[132:135], v4, s[8:11], s78 offen offset:0
    v_mfma_f32_16x16x32_bf16 v[64:67], v[196:199], v[16:19], v[64:67]
    ds_read_b128 v[220:223], v8 offset:16384
    v_mfma_f32_16x16x32_bf16 v[68:71], v[196:199], v[20:23], v[68:71]
    s_add_u32 s79, s46, s61
    buffer_load_dwordx4 v[136:139], v4, s[8:11], s79 offen offset:0
    v_mfma_f32_16x16x32_bf16 v[72:75], v[196:199], v[24:27], v[72:75]
    ds_read_b128 v[224:227], v8 offset:24576
    v_mfma_f32_16x16x32_bf16 v[76:79], v[196:199], v[28:31], v[76:79]
    s_add_u32 s3, s47, s61
    buffer_load_dwordx4 v[140:143], v4, s[8:11], s3 offen offset:0
    v_mfma_f32_16x16x32_bf16 v[80:83], v[200:203], v[16:19], v[80:83]
    ds_read_b128 v[228:231], v8 offset:32768
    v_mfma_f32_16x16x32_bf16 v[84:87], v[200:203], v[20:23], v[84:87]
    buffer_load_dwordx4 v[144:147], v4, s[8:11], s77 offen offset:3072
    v_mfma_f32_16x16x32_bf16 v[88:91], v[200:203], v[24:27], v[88:91]
    buffer_load_dwordx4 v[148:151], v4, s[8:11], s78 offen offset:3072
    v_mfma_f32_16x16x32_bf16 v[92:95], v[200:203], v[28:31], v[92:95]
    buffer_load_dwordx4 v[152:155], v4, s[8:11], s79 offen offset:3072
    v_mfma_f32_16x16x32_bf16 v[96:99], v[204:207], v[16:19], v[96:99]
    buffer_load_dwordx4 v[156:159], v4, s[8:11], s3 offen offset:3072
    v_mfma_f32_16x16x32_bf16 v[100:103], v[204:207], v[20:23], v[100:103]
    v_mfma_f32_16x16x32_bf16 v[104:107], v[204:207], v[24:27], v[104:107]
    v_mfma_f32_16x16x32_bf16 v[108:111], v[204:207], v[28:31], v[108:111]
    v_mfma_f32_16x16x32_bf16 v[112:115], v[208:211], v[16:19], v[112:115]
    v_mfma_f32_16x16x32_bf16 v[116:119], v[208:211], v[20:23], v[116:119]
    v_mfma_f32_16x16x32_bf16 v[120:123], v[208:211], v[24:27], v[120:123]
    v_mfma_f32_16x16x32_bf16 v[124:127], v[208:211], v[28:31], v[124:127]
    s_waitcnt vmcnt(8) lgkmcnt(0)
    s_mul_i32 s40, s24, 40960
    s_sub_u32 s41, 40960, s40
    v_mfma_f32_16x16x32_bf16 v[48:51], v[212:215], v[232:235], v[48:51]
    v_mfma_f32_16x16x32_bf16 v[52:55], v[212:215], v[236:239], v[52:55]
    v_mfma_f32_16x16x32_bf16 v[56:59], v[212:215], v[240:243], v[56:59]
    v_mfma_f32_16x16x32_bf16 v[60:63], v[212:215], v[244:247], v[60:63]
    s_waitcnt vmcnt(4) lgkmcnt(0)
    v_mfma_f32_16x16x32_bf16 v[48:51], v[172:175], v[128:131], v[48:51]
    v_mfma_f32_16x16x32_bf16 v[52:55], v[172:175], v[132:135], v[52:55]
    v_mfma_f32_16x16x32_bf16 v[56:59], v[172:175], v[136:139], v[56:59]
    v_mfma_f32_16x16x32_bf16 v[60:63], v[172:175], v[140:143], v[60:63]
    s_waitcnt vmcnt(0) lgkmcnt(0)
    v_mfma_f32_16x16x32_bf16 v[48:51], v[32:35], v[144:147], v[48:51]
    v_lshrrev_b32 v13, 5, v4
    v_and_b32 v13, 16, v13
    v_xor_b32 v12, v13, v8
    v_lshrrev_b32 v13, 1, v4
    v_and_b32 v13, 128, v13
    v_mfma_f32_16x16x32_bf16 v[52:55], v[32:35], v[148:151], v[52:55]
    v_xor_b32 v13, v13, v12
    v_add_u32 v12, s40, v13
    v_add_u32 v14, s41, v13
    v_mfma_f32_16x16x32_bf16 v[56:59], v[32:35], v[152:155], v[56:59]
    v_mfma_f32_16x16x32_bf16 v[60:63], v[32:35], v[156:159], v[60:63]
    v_mfma_f32_16x16x32_bf16 v[64:67], v[216:219], v[232:235], v[64:67]
    v_cvt_pk_f16_f32 v48, v48, v49
    v_cvt_pk_f16_f32 v49, v50, v51
    v_mfma_f32_16x16x32_bf16 v[68:71], v[216:219], v[236:239], v[68:71]
    v_cvt_pk_f16_f32 v50, v52, v53
    v_cvt_pk_f16_f32 v51, v54, v55
    s_nop 0
    v_mfma_f32_16x16x32_bf16 v[64:67], v[176:179], v[128:131], v[64:67]
    v_permlane16_swap_b32 v48, v50
    v_permlane16_swap_b32 v49, v51
    v_mfma_f32_16x16x32_bf16 v[68:71], v[176:179], v[132:135], v[68:71]
    ds_write_b128 v12, v[48:51] offset:0
    v_xor_b32 v12, 32, v12
    v_mfma_f32_16x16x32_bf16 v[64:67], v[36:39], v[144:147], v[64:67]
    v_cvt_pk_f16_f32 v56, v56, v57
    v_cvt_pk_f16_f32 v57, v58, v59
    v_mfma_f32_16x16x32_bf16 v[68:71], v[36:39], v[148:151], v[68:71]
    v_cvt_pk_f16_f32 v58, v60, v61
    v_cvt_pk_f16_f32 v59, v62, v63
    s_nop 0
    v_mfma_f32_16x16x32_bf16 v[72:75], v[216:219], v[240:243], v[72:75]
    v_permlane16_swap_b32 v56, v58
    v_permlane16_swap_b32 v57, v59
    v_mfma_f32_16x16x32_bf16 v[76:79], v[216:219], v[244:247], v[76:79]
    ds_write_b128 v14, v[56:59] offset:0
    v_xor_b32 v14, 32, v14
    v_mfma_f32_16x16x32_bf16 v[72:75], v[176:179], v[136:139], v[72:75]
    v_cvt_pk_f16_f32 v64, v64, v65
    v_cvt_pk_f16_f32 v65, v66, v67
    v_mfma_f32_16x16x32_bf16 v[76:79], v[176:179], v[140:143], v[76:79]
    v_cvt_pk_f16_f32 v66, v68, v69
    v_cvt_pk_f16_f32 v67, v70, v71
    s_nop 0
    v_mfma_f32_16x16x32_bf16 v[72:75], v[36:39], v[152:155], v[72:75]
    v_permlane16_swap_b32 v64, v66
    v_permlane16_swap_b32 v65, v67
    v_mfma_f32_16x16x32_bf16 v[76:79], v[36:39], v[156:159], v[76:79]
    ds_write_b128 v12, v[64:67] offset:8192
    v_xor_b32 v12, 96, v12
    v_mfma_f32_16x16x32_bf16 v[80:83], v[220:223], v[232:235], v[80:83]
    v_mfma_f32_16x16x32_bf16 v[84:87], v[220:223], v[236:239], v[84:87]
    v_mfma_f32_16x16x32_bf16 v[80:83], v[180:183], v[128:131], v[80:83]
    v_cvt_pk_f16_f32 v72, v72, v73
    v_cvt_pk_f16_f32 v73, v74, v75
    v_mfma_f32_16x16x32_bf16 v[84:87], v[180:183], v[132:135], v[84:87]
    v_cvt_pk_f16_f32 v74, v76, v77
    v_cvt_pk_f16_f32 v75, v78, v79
    s_nop 0
    v_mfma_f32_16x16x32_bf16 v[80:83], v[40:43], v[144:147], v[80:83]
    v_permlane16_swap_b32 v72, v74
    v_permlane16_swap_b32 v73, v75
    v_mfma_f32_16x16x32_bf16 v[84:87], v[40:43], v[148:151], v[84:87]
    ds_write_b128 v14, v[72:75] offset:8192
    v_xor_b32 v14, 96, v14
    v_mfma_f32_16x16x32_bf16 v[88:91], v[220:223], v[240:243], v[88:91]
    v_mfma_f32_16x16x32_bf16 v[92:95], v[220:223], v[244:247], v[92:95]
    v_mfma_f32_16x16x32_bf16 v[88:91], v[180:183], v[136:139], v[88:91]
    v_cvt_pk_f16_f32 v80, v80, v81
    v_cvt_pk_f16_f32 v81, v82, v83
    v_mfma_f32_16x16x32_bf16 v[92:95], v[180:183], v[140:143], v[92:95]
    v_cvt_pk_f16_f32 v82, v84, v85
    v_cvt_pk_f16_f32 v83, v86, v87
    s_nop 0
    v_mfma_f32_16x16x32_bf16 v[88:91], v[40:43], v[152:155], v[88:91]
    v_permlane16_swap_b32 v80, v82
    v_permlane16_swap_b32 v81, v83
    v_mfma_f32_16x16x32_bf16 v[92:95], v[40:43], v[156:159], v[92:95]
    ds_write_b128 v12, v[80:83] offset:16384
    v_xor_b32 v12, 32, v12
    v_mfma_f32_16x16x32_bf16 v[96:99], v[224:227], v[232:235], v[96:99]
    v_lshlrev_b32 v52, 16, v252
    v_and_b32 v53, 0xffff0000, v252
    v_mfma_f32_16x16x32_bf16 v[100:103], v[224:227], v[236:239], v[100:103]
    v_lshlrev_b32 v54, 16, v253
    v_and_b32 v55, 0xffff0000, v253
    v_mfma_f32_16x16x32_bf16 v[96:99], v[184:187], v[128:131], v[96:99]
    v_cvt_pk_f16_f32 v88, v88, v89
    v_cvt_pk_f16_f32 v89, v90, v91
    v_mfma_f32_16x16x32_bf16 v[100:103], v[184:187], v[132:135], v[100:103]
    v_cvt_pk_f16_f32 v90, v92, v93
    v_cvt_pk_f16_f32 v91, v94, v95
    s_nop 0
    v_mfma_f32_16x16x32_bf16 v[96:99], v[44:47], v[144:147], v[96:99]
    v_permlane16_swap_b32 v88, v90
    v_permlane16_swap_b32 v89, v91
    v_mfma_f32_16x16x32_bf16 v[100:103], v[44:47], v[148:151], v[100:103]
    ds_write_b128 v14, v[88:91] offset:16384
    v_xor_b32 v14, 32, v14
    v_mfma_f32_16x16x32_bf16 v[104:107], v[224:227], v[240:243], v[104:107]
    v_lshlrev_b32 v60, 16, v254
    v_and_b32 v61, 0xffff0000, v254
    v_mfma_f32_16x16x32_bf16 v[108:111], v[224:227], v[244:247], v[108:111]
    v_lshlrev_b32 v62, 16, v255
    v_and_b32 v63, 0xffff0000, v255
    v_mfma_f32_16x16x32_bf16 v[104:107], v[184:187], v[136:139], v[104:107]
    v_cvt_pk_f16_f32 v96, v96, v97
    v_cvt_pk_f16_f32 v97, v98, v99
    v_mfma_f32_16x16x32_bf16 v[108:111], v[184:187], v[140:143], v[108:111]
    v_cvt_pk_f16_f32 v98, v100, v101
    v_cvt_pk_f16_f32 v99, v102, v103
    s_nop 0
    v_mfma_f32_16x16x32_bf16 v[104:107], v[44:47], v[152:155], v[104:107]
    v_permlane16_swap_b32 v96, v98
    v_permlane16_swap_b32 v97, v99
    v_mfma_f32_16x16x32_bf16 v[108:111], v[44:47], v[156:159], v[108:111]
    ds_write_b128 v12, v[96:99] offset:24576
    v_xor_b32 v12, 96, v12
    v_mfma_f32_16x16x32_bf16 v[112:115], v[228:231], v[232:235], v[112:115]
    v_mfma_f32_16x16x32_bf16 v[116:119], v[228:231], v[236:239], v[116:119]
    v_mfma_f32_16x16x32_bf16 v[112:115], v[188:191], v[128:131], v[112:115]
    v_cvt_pk_f16_f32 v104, v104, v105
    v_cvt_pk_f16_f32 v105, v106, v107
    v_mfma_f32_16x16x32_bf16 v[116:119], v[188:191], v[132:135], v[116:119]
    v_cvt_pk_f16_f32 v106, v108, v109
    v_cvt_pk_f16_f32 v107, v110, v111
    s_nop 0
    v_mfma_f32_16x16x32_bf16 v[112:115], v[168:171], v[144:147], v[112:115]
    v_permlane16_swap_b32 v104, v106
    v_permlane16_swap_b32 v105, v107
    v_mfma_f32_16x16x32_bf16 v[116:119], v[168:171], v[148:151], v[116:119]
    ds_write_b128 v14, v[104:107] offset:24576
    v_xor_b32 v14, 96, v14
    v_mfma_f32_16x16x32_bf16 v[120:123], v[228:231], v[240:243], v[120:123]
    v_mfma_f32_16x16x32_bf16 v[124:127], v[228:231], v[244:247], v[124:127]
    v_mfma_f32_16x16x32_bf16 v[120:123], v[188:191], v[136:139], v[120:123]
    v_cvt_pk_f16_f32 v112, v112, v113
    v_cvt_pk_f16_f32 v113, v114, v115
    v_mfma_f32_16x16x32_bf16 v[124:127], v[188:191], v[140:143], v[124:127]
    v_cvt_pk_f16_f32 v114, v116, v117
    v_cvt_pk_f16_f32 v115, v118, v119
    s_nop 0
    v_mfma_f32_16x16x32_bf16 v[120:123], v[168:171], v[152:155], v[120:123]
    v_permlane16_swap_b32 v112, v114
    v_permlane16_swap_b32 v113, v115
    v_mfma_f32_16x16x32_bf16 v[124:127], v[168:171], v[156:159], v[124:127]
    ds_write_b128 v12, v[112:115] offset:32768
    s_branch G2_fin
G2_lo:
    v_cmp_ne_u32 vcc, s75, v14
    s_and_b32 s40, vcc_lo, 0xf
    s_cbranch_scc0 G2l_n_go
    s_mov_b32 s49, 0
    buffer_load_dword v14, v15, s[64:67], 0 offen sc1
    s_sleep 8
G2l_n:
    buffer_load_dword v5, v15, s[64:67], 0 offen sc1
    s_waitcnt vmcnt(1)
    v_cmp_ne_u32 vcc, s75, v14
    s_and_b32 s40, vcc_lo, 0xf
    s_cbranch_scc0 G2l_n_go
    buffer_load_dword v14, v15, s[64:67], 0 offen sc1
    s_waitcnt vmcnt(1)
    v_cmp_ne_u32 vcc, s75, v5
    s_and_b32 s40, vcc_lo, 0xf
    s_cbranch_scc0 G2l_n_go
    s_add_u32 s49, s49, 1
    s_cmp_lt_u32 s49, 0x40000
    s_cbranch_scc1 G2l_n
G2l_n_go:
    s_and_b32 s51, vcc_lo, 0xff0
    s_add_u32 s77, s44, s59
    buffer_load_dwordx4 v[128:131], v4, s[8:11], s77 offen offset:0
    s_add_u32 s78, s45, s59
    buffer_load_dwordx4 v[132:135], v4, s[8:11], s78 offen offset:0
    s_add_u32 s79, s46, s59
    buffer_load_dwordx4 v[136:139], v4, s[8:11], s79 offen offset:0
    s_add_u32 s3, s47, s59
    buffer_load_dwordx4 v[140:143], v4, s[8:11], s3 offen offset:0
    buffer_load_dwordx4 v[144:147], v4, s[8:11], s77 offen offset:3072
    buffer_load_dwordx4 v[148:151], v4, s[8:11], s78 offen offset:3072
    buffer_load_dwordx4 v[152:155], v4, s[8:11], s79 offen offset:3072
    buffer_load_dwordx4 v[156:159], v4, s[8:11], s3 offen offset:3072
    s_add_u32 s77, s44, s60
    buffer_load_dwordx4 v[16:19], v4, s[8:11], s77 offen offset:0
    s_add_u32 s78, s45, s60
    buffer_load_dwordx4 v[20:23], v4, s[8:11], s78 offen offset:0
    s_add_u32 s79, s46, s60
    buffer_load_dwordx4 v[24:27], v4, s[8:11], s79 offen offset:0
    s_add_u32 s3, s47, s60
    buffer_load_dwordx4 v[28:31], v4, s[8:11], s3 offen offset:0
    s_cmp_lg_u32 s51, 0
    s_cbranch_scc1 G2l_b
    s_waitcnt vmcnt(8) lgkmcnt(0)
    v_mfma_f32_16x16x32_bf16 v[48:51], v[192:195], v[128:131], 0
    v_mfma_f32_16x16x32_bf16 v[52:55], v[192:195], v[132:135], 0
    v_mfma_f32_16x16x32_bf16 v[56:59], v[192:195], v[136:139], 0
    v_mfma_f32_16x16x32_bf16 v[60:63], v[192:195], v[140:143], 0
    v_mfma_f32_16x16x32_bf16 v[64:67], v[196:199], v[128:131], 0
    v_mfma_f32_16x16x32_bf16 v[68:71], v[196:199], v[132:135], 0
    v_mfma_f32_16x16x32_bf16 v[72:75], v[196:199], v[136:139], 0
    v_mfma_f32_16x16x32_bf16 v[76:79], v[196:199], v[140:143], 0
    v_mfma_f32_16x16x32_bf16 v[80:83], v[200:203], v[128:131], 0
    v_mfma_f32_16x16x32_bf16 v[84:87], v[200:203], v[132:135], 0
    v_mfma_f32_16x16x32_bf16 v[88:91], v[200:203], v[136:139], 0
    v_mfma_f32_16x16x32_bf16 v[92:95], v[200:203], v[140:143], 0
    v_mfma_f32_16x16x32_bf16 v[96:99], v[204:207], v[128:131], 0
    v_mfma_f32_16x16x32_bf16 v[100:103], v[204:207], v[132:135], 0
    v_mfma_f32_16x16x32_bf16 v[104:107], v[204:207], v[136:139], 0
    v_mfma_f32_16x16x32_bf16 v[108:111], v[204:207], v[140:143], 0
    v_mfma_f32_16x16x32_bf16 v[112:115], v[208:211], v[128:131], 0
    v_mfma_f32_16x16x32_bf16 v[116:119], v[208:211], v[132:135], 0
    v_mfma_f32_16x16x32_bf16 v[120:123], v[208:211], v[136:139], 0
    v_mfma_f32_16x16x32_bf16 v[124:127], v[208:211], v[140:143], 0
    s_waitcnt vmcnt(4) lgkmcnt(0)
    v_mfma_f32_16x16x32_bf16 v[48:51], v[212:215], v[144:147], v[48:51]
    ds_read_b128 v[192:195], v9 offset:57344
    v_mfma_f32_16x16x32_bf16 v[52:55], v[212:215], v[148:151], v[52:55]
    buffer_load_dwordx4 v[32:35], v4, s[8:11], s77 offen offset:3072
    v_mfma_f32_16x16x32_bf16 v[56:59], v[212:215], v[152:155], v[56:59]
    ds_read_b128 v[196:199], v10 offset:0
    v_mfma_f32_16x16x32_bf16 v[60:63], v[212:215], v[156:159], v[60:63]
    buffer_load_dwordx4 v[36:39], v4, s[8:11], s78 offen offset:3072
    v_mfma_f32_16x16x32_bf16 v[64:67], v[216:219], v[144:147], v[64:67]
    ds_read_b128 v[200:203], v10 offset:8192
    v_mfma_f32_16x16x32_bf16 v[68:71], v[216:219], v[148:151], v[68:71]
    buffer_load_dwordx4 v[40:43], v4, s[8:11], s79 offen offset:3072
    v_mfma_f32_16x16x32_bf16 v[72:75], v[216:219], v[152:155], v[72:75]
    ds_read_b128 v[204:207], v10 offset:16384
    v_mfma_f32_16x16x32_bf16 v[76:79], v[216:219], v[156:159], v[76:79]
    buffer_load_dwordx4 v[44:47], v4, s[8:11], s3 offen offset:3072
    v_mfma_f32_16x16x32_bf16 v[80:83], v[220:223], v[144:147], v[80:83]
    ds_read_b128 v[208:211], v10 offset:24576
    v_mfma_f32_16x16x32_bf16 v[84:87], v[220:223], v[148:151], v[84:87]
    v_mfma_f32_16x16x32_bf16 v[88:91], v[220:223], v[152:155], v[88:91]
    v_mfma_f32_16x16x32_bf16 v[92:95], v[220:223], v[156:159], v[92:95]
    v_mfma_f32_16x16x32_bf16 v[96:99], v[224:227], v[144:147], v[96:99]
    v_mfma_f32_16x16x32_bf16 v[100:103], v[224:227], v[148:151], v[100:103]
    v_mfma_f32_16x16x32_bf16 v[104:107], v[224:227], v[152:155], v[104:107]
    v_mfma_f32_16x16x32_bf16 v[108:111], v[224:227], v[156:159], v[108:111]
    v_mfma_f32_16x16x32_bf16 v[112:115], v[228:231], v[144:147], v[112:115]
    v_mfma_f32_16x16x32_bf16 v[116:119], v[228:231], v[148:151], v[116:119]
    v_mfma_f32_16x16x32_bf16 v[120:123], v[228:231], v[152:155], v[120:123]
    v_mfma_f32_16x16x32_bf16 v[124:127], v[228:231], v[156:159], v[124:127]
    s_waitcnt vmcnt(4) lgkmcnt(0)
    v_mfma_f32_16x16x32_bf16 v[48:51], v[232:235], v[16:19], v[48:51]
    ds_read_b128 v[212:215], v9 offset:16384
    v_mfma_f32_16x16x32_bf16 v[52:55], v[232:235], v[20:23], v[52:55]
    s_add_u32 s77, s44, s61
    buffer_load_dwordx4 v[128:131], v4, s[8:11], s77 offen offset:0
    v_mfma_f32_16x16x32_bf16 v[56:59], v[232:235], v[24:27], v[56:59]
    ds_read_b128 v[216:219], v9 offset:24576
    v_mfma_f32_16x16x32_bf16 v[60:63], v[232:235], v[28:31], v[60:63]
    s_add_u32 s78, s45, s61
    buffer_load_dwordx4 v[132:135], v4, s[8:11], s78 offen offset:0
    v_mfma_f32_16x16x32_bf16 v[64:67], v[236:239], v[16:19], v[64:67]
    ds_read_b128 v[220:223], v9 offset:32768
    v_mfma_f32_16x16x32_bf16 v[68:71], v[236:239], v[20:23], v[68:71]
    s_add_u32 s79, s46, s61
    buffer_load_dwordx4 v[136:139], v4, s[8:11], s79 offen offset:0
    v_mfma_f32_16x16x32_bf16 v[72:75], v[236:239], v[24:27], v[72:75]
    ds_read_b128 v[224:227], v9 offset:40960
    v_mfma_f32_16x16x32_bf16 v[76:79], v[236:239], v[28:31], v[76:79]
    s_add_u32 s3, s47, s61
    buffer_load_dwordx4 v[140:143], v4, s[8:11], s3 offen offset:0
    v_mfma_f32_16x16x32_bf16 v[80:83], v[240:243], v[16:19], v[80:83]
    ds_read_b128 v[228:231], v9 offset:49152
    v_mfma_f32_16x16x32_bf16 v[84:87], v[240:243], v[20:23], v[84:87]
    v_mfma_f32_16x16x32_bf16 v[88:91], v[240:243], v[24:27], v[88:91]
    v_mfma_f32_16x16x32_bf16 v[92:95], v[240:243], v[28:31], v[92:95]
    v_mfma_f32_16x16x32_bf16 v[96:99], v[244:247], v[16:19], v[96:99]
    v_mfma_f32_16x16x32_bf16 v[100:103], v[244:247], v[20:23], v[100:103]
    v_mfma_f32_16x16x32_bf16 v[104:107], v[244:247], v[24:27], v[104:107]
    v_mfma_f32_16x16x32_bf16 v[108:111], v[244:247], v[28:31], v[108:111]
    v_mfma_f32_16x16x32_bf16 v[112:115], v[248:251], v[16:19], v[112:115]
    v_mfma_f32_16x16x32_bf16 v[116:119], v[248:251], v[20:23], v[116:119]
    v_mfma_f32_16x16x32_bf16 v[120:123], v[248:251], v[24:27], v[120:123]
    v_mfma_f32_16x16x32_bf16 v[124:127], v[248:251], v[28:31], v[124:127]
    s_waitcnt vmcnt(4) lgkmcnt(0)
    v_mfma_f32_16x16x32_bf16 v[48:51], v[192:195], v[32:35], v[48:51]
    ds_read_b128 v[232:235], v8 offset:40960
    v_mfma_f32_16x16x32_bf16 v[52:55], v[192:195], v[36:39], v[52:55]
    buffer_load_dwordx4 v[144:147], v4, s[8:11], s77 offen offset:3072
    v_mfma_f32_16x16x32_bf16 v[56:59], v[192:195], v[40:43], v[56:59]
    ds_read_b128 v[236:239], v8 offset:49152
    v_mfma_f32_16x16x32_bf16 v[60:63], v[192:195], v[44:47], v[60:63]
    buffer_load_dwordx4 v[148:151], v4, s[8:11], s78 offen offset:3072
    v_mfma_f32_16x16x32_bf16 v[64:67], v[196:199], v[32:35], v[64:67]
    ds_read_b128 v[240:243], v8 offset:57344
    v_mfma_f32_16x16x32_bf16 v[68:71], v[196:199], v[36:39], v[68:71]
    buffer_load_dwordx4 v[152:155], v4, s[8:11], s79 offen offset:3072
    v_mfma_f32_16x16x32_bf16 v[72:75], v[196:199], v[40:43], v[72:75]
    ds_read_b128 v[244:247], v9 offset:0
    v_mfma_f32_16x16x32_bf16 v[76:79], v[196:199], v[44:47], v[76:79]
    buffer_load_dwordx4 v[156:159], v4, s[8:11], s3 offen offset:3072
    v_mfma_f32_16x16x32_bf16 v[80:83], v[200:203], v[32:35], v[80:83]
    ds_read_b128 v[248:251], v9 offset:8192
    v_mfma_f32_16x16x32_bf16 v[84:87], v[200:203], v[36:39], v[84:87]
    buffer_load_dwordx4 v[252:255], v11, s[80:83], 0 offen
    v_mfma_f32_16x16x32_bf16 v[88:91], v[200:203], v[40:43], v[88:91]
    buffer_load_dwordx4 v[164:167], v3, s[80:83], 0 offen
    v_mfma_f32_16x16x32_bf16 v[92:95], v[200:203], v[44:47], v[92:95]
    v_mfma_f32_16x16x32_bf16 v[96:99], v[204:207], v[32:35], v[96:99]
    v_mfma_f32_16x16x32_bf16 v[100:103], v[204:207], v[36:39], v[100:103]
    v_mfma_f32_16x16x32_bf16 v[104:107], v[204:207], v[40:43], v[104:107]
    v_mfma_f32_16x16x32_bf16 v[108:111], v[204:207], v[44:47], v[108:111]
    v_mfma_f32_16x16x32_bf16 v[112:115], v[208:211], v[32:35], v[112:115]
    v_mfma_f32_16x16x32_bf16 v[116:119], v[208:211], v[36:39], v[116:119]
    v_mfma_f32_16x16x32_bf16 v[120:123], v[208:211], v[40:43], v[120:123]
    v_mfma_f32_16x16x32_bf16 v[124:127], v[208:211], v[44:47], v[124:127]
    s_waitcnt vmcnt(6) lgkmcnt(0)
    v_mfma_f32_16x16x32_bf16 v[48:51], v[212:215], v[128:131], v[48:51]
    ds_read_b128 v[192:195], v8 offset:0
    v_mfma_f32_16x16x32_bf16 v[52:55], v[212:215], v[132:135], v[52:55]
    buffer_load_dwordx4 v[16:19], v4, s[8:11], s12 offen offset:0
    v_mfma_f32_16x16x32_bf16 v[56:59], v[212:215], v[136:139], v[56:59]
    ds_read_b128 v[196:199], v8 offset:8192
    v_mfma_f32_16x16x32_bf16 v[60:63], v[212:215], v[140:143], v[60:63]
    buffer_load_dwordx4 v[20:23], v4, s[8:11], s13 offen offset:0
    v_mfma_f32_16x16x32_bf16 v[64:67], v[216:219], v[128:131], v[64:67]
    ds_read_b128 v[200:203], v8 offset:16384
    v_mfma_f32_16x16x32_bf16 v[68:71], v[216:219], v[132:135], v[68:71]
    buffer_load_dwordx4 v[24:27], v4, s[8:11], s14 offen offset:0
    v_mfma_f32_16x16x32_bf16 v[72:75], v[216:219], v[136:139], v[72:75]
    ds_read_b128 v[204:207], v8 offset:24576
    v_mfma_f32_16x16x32_bf16 v[76:79], v[216:219], v[140:143], v[76:79]
    buffer_load_dwordx4 v[28:31], v4, s[8:11], s15 offen offset:0
    v_mfma_f32_16x16x32_bf16 v[80:83], v[220:223], v[128:131], v[80:83]
    ds_read_b128 v[208:211], v8 offset:32768
    v_mfma_f32_16x16x32_bf16 v[84:87], v[220:223], v[132:135], v[84:87]
    buffer_load_dwordx4 v[32:35], v4, s[8:11], s12 offen offset:1024
    v_mfma_f32_16x16x32_bf16 v[88:91], v[220:223], v[136:139], v[88:91]
    buffer_load_dwordx4 v[36:39], v4, s[8:11], s13 offen offset:1024
    v_mfma_f32_16x16x32_bf16 v[92:95], v[220:223], v[140:143], v[92:95]
    buffer_load_dwordx4 v[40:43], v4, s[8:11], s14 offen offset:1024
    v_mfma_f32_16x16x32_bf16 v[96:99], v[224:227], v[128:131], v[96:99]
    buffer_load_dwordx4 v[44:47], v4, s[8:11], s15 offen offset:1024
    v_mfma_f32_16x16x32_bf16 v[100:103], v[224:227], v[132:135], v[100:103]
    v_mfma_f32_16x16x32_bf16 v[104:107], v[224:227], v[136:139], v[104:107]
    v_mfma_f32_16x16x32_bf16 v[108:111], v[224:227], v[140:143], v[108:111]
    v_mfma_f32_16x16x32_bf16 v[112:115], v[228:231], v[128:131], v[112:115]
    v_mfma_f32_16x16x32_bf16 v[116:119], v[228:231], v[132:135], v[116:119]
    v_mfma_f32_16x16x32_bf16 v[120:123], v[228:231], v[136:139], v[120:123]
    v_mfma_f32_16x16x32_bf16 v[124:127], v[228:231], v[140:143], v[124:127]
    s_branch G2l_m
G2l_b:
    s_waitcnt vmcnt(8) lgkmcnt(0)
    v_mfma_f32_16x16x32_bf16 v[48:51], v[192:195], v[128:131], 0
    v_mfma_f32_16x16x32_bf16 v[52:55], v[192:195], v[132:135], 0
    v_mfma_f32_16x16x32_bf16 v[56:59], v[192:195], v[136:139], 0
    v_mfma_f32_16x16x32_bf16 v[60:63], v[192:195], v[140:143], 0
    v_mfma_f32_16x16x32_bf16 v[64:67], v[196:199], v[128:131], 0
    v_mfma_f32_16x16x32_bf16 v[68:71], v[196:199], v[132:135], 0
    v_mfma_f32_16x16x32_bf16 v[72:75], v[196:199], v[136:139], 0
    v_mfma_f32_16x16x32_bf16 v[76:79], v[196:199], v[140:143], 0
    v_mfma_f32_16x16x32_bf16 v[80:83], v[200:203], v[128:131], 0
    v_mfma_f32_16x16x32_bf16 v[84:87], v[200:203], v[132:135], 0
    v_mfma_f32_16x16x32_bf16 v[88:91], v[200:203], v[136:139], 0
    v_mfma_f32_16x16x32_bf16 v[92:95], v[200:203], v[140:143], 0
    v_mfma_f32_16x16x32_bf16 v[96:99], v[204:207], v[128:131], 0
    v_mfma_f32_16x16x32_bf16 v[100:103], v[204:207], v[132:135], 0
    v_mfma_f32_16x16x32_bf16 v[104:107], v[204:207], v[136:139], 0
    v_mfma_f32_16x16x32_bf16 v[108:111], v[204:207], v[140:143], 0
    v_mfma_f32_16x16x32_bf16 v[112:115], v[208:211], v[128:131], 0
    v_mfma_f32_16x16x32_bf16 v[116:119], v[208:211], v[132:135], 0
    v_mfma_f32_16x16x32_bf16 v[120:123], v[208:211], v[136:139], 0
    v_mfma_f32_16x16x32_bf16 v[124:127], v[208:211], v[140:143], 0
    s_waitcnt vmcnt(4) lgkmcnt(0)
    v_mfma_f32_16x16x32_bf16 v[48:51], v[212:215], v[144:147], v[48:51]
    ds_read_b128 v[192:195], v9 offset:57344
    v_mfma_f32_16x16x32_bf16 v[52:55], v[212:215], v[148:151], v[52:55]
    buffer_load_dword v14, v15, s[64:67], 0 offen sc1
    v_mfma_f32_16x16x32_bf16 v[56:59], v[212:215], v[152:155], v[56:59]
    ds_read_b128 v[196:199], v10 offset:0
    v_mfma_f32_16x16x32_bf16 v[60:63], v[212:215], v[156:159], v[60:63]
    buffer_load_dwordx4 v[32:35], v4, s[8:11], s77 offen offset:3072
    v_mfma_f32_16x16x32_bf16 v[64:67], v[216:219], v[144:147], v[64:67]
    ds_read_b128 v[200:203], v10 offset:8192
    v_mfma_f32_16x16x32_bf16 v[68:71], v[216:219], v[148:151], v[68:71]
    buffer_load_dwordx4 v[36:39], v4, s[8:11], s78 offen offset:3072
    v_mfma_f32_16x16x32_bf16 v[72:75], v[216:219], v[152:155], v[72:75]
    ds_read_b128 v[204:207], v10 offset:16384
    v_mfma_f32_16x16x32_bf16 v[76:79], v[216:219], v[156:159], v[76:79]
    buffer_load_dwordx4 v[40:43], v4, s[8:11], s79 offen offset:3072
    v_mfma_f32_16x16x32_bf16 v[80:83], v[220:223], v[144:147], v[80:83]
    ds_read_b128 v[208:211], v10 offset:24576
    v_mfma_f32_16x16x32_bf16 v[84:87], v[220:223], v[148:151], v[84:87]
    buffer_load_dwordx4 v[44:47], v4, s[8:11], s3 offen offset:3072
    v_mfma_f32_16x16x32_bf16 v[88:91], v[220:223], v[152:155], v[88:91]
    v_mfma_f32_16x16x32_bf16 v[92:95], v[220:223], v[156:159], v[92:95]
    v_mfma_f32_16x16x32_bf16 v[96:99], v[224:227], v[144:147], v[96:99]
    v_mfma_f32_16x16x32_bf16 v[100:103], v[224:227], v[148:151], v[100:103]
    v_mfma_f32_16x16x32_bf16 v[104:107], v[224:227], v[152:155], v[104:107]
    v_mfma_f32_16x16x32_bf16 v[108:111], v[224:227], v[156:159], v[108:111]
    v_mfma_f32_16x16x32_bf16 v[112:115], v[228:231], v[144:147], v[112:115]
    v_mfma_f32_16x16x32_bf16 v[116:119], v[228:231], v[148:151], v[116:119]
    v_mfma_f32_16x16x32_bf16 v[120:123], v[228:231], v[152:155], v[120:123]
    v_mfma_f32_16x16x32_bf16 v[124:127], v[228:231], v[156:159], v[124:127]
    s_waitcnt vmcnt(5) lgkmcnt(0)
    v_mfma_f32_16x16x32_bf16 v[48:51], v[232:235], v[16:19], v[48:51]
    ds_read_b128 v[212:215], v9 offset:16384
    v_mfma_f32_16x16x32_bf16 v[52:55], v[232:235], v[20:23], v[52:55]
    s_add_u32 s77, s44, s61
    buffer_load_dwordx4 v[128:131], v4, s[8:11], s77 offen offset:0
    v_mfma_f32_16x16x32_bf16 v[56:59], v[232:235], v[24:27], v[56:59]
    ds_read_b128 v[216:219], v9 offset:24576
    v_mfma_f32_16x16x32_bf16 v[60:63], v[232:235], v[28:31], v[60:63]
    s_add_u32 s78, s45, s61
    buffer_load_dwordx4 v[132:135], v4, s[8:11], s78 offen offset:0
    v_mfma_f32_16x16x32_bf16 v[64:67], v[236:239], v[16:19], v[64:67]
    ds_read_b128 v[220:223], v9 offset:32768
    v_mfma_f32_16x16x32_bf16 v[68:71], v[236:239], v[20:23], v[68:71]
    s_add_u32 s79, s46, s61
    buffer_load_dwordx4 v[136:139], v4, s[8:11], s79 offen offset:0
    v_mfma_f32_16x16x32_bf16 v[72:75], v[236:239], v[24:27], v[72:75]
    ds_read_b128 v[224:227], v9 offset:40960
    v_mfma_f32_16x16x32_bf16 v[76:79], v[236:239], v[28:31], v[76:79]
    s_add_u32 s3, s47, s61
    buffer_load_dwordx4 v[140:143], v4, s[8:11], s3 offen offset:0
    v_mfma_f32_16x16x32_bf16 v[80:83], v[240:243], v[16:19], v[80:83]
    ds_read_b128 v[228:231], v9 offset:49152
    v_mfma_f32_16x16x32_bf16 v[84:87], v[240:243], v[20:23], v[84:87]
    v_mfma_f32_16x16x32_bf16 v[88:91], v[240:243], v[24:27], v[88:91]
    v_mfma_f32_16x16x32_bf16 v[92:95], v[240:243], v[28:31], v[92:95]
    v_mfma_f32_16x16x32_bf16 v[96:99], v[244:247], v[16:19], v[96:99]
    v_mfma_f32_16x16x32_bf16 v[100:103], v[244:247], v[20:23], v[100:103]
    v_mfma_f32_16x16x32_bf16 v[104:107], v[244:247], v[24:27], v[104:107]
    v_mfma_f32_16x16x32_bf16 v[108:111], v[244:247], v[28:31], v[108:111]
    v_mfma_f32_16x16x32_bf16 v[112:115], v[248:251], v[16:19], v[112:115]
    v_mfma_f32_16x16x32_bf16 v[116:119], v[248:251], v[20:23], v[116:119]
    v_mfma_f32_16x16x32_bf16 v[120:123], v[248:251], v[24:27], v[120:123]
    v_mfma_f32_16x16x32_bf16 v[124:127], v[248:251], v[28:31], v[124:127]
    s_waitcnt vmcnt(4) lgkmcnt(0)
    v_cmp_ne_u32 vcc, s75, v14
    s_and_b32 s40, vcc_lo, 0xff0
    s_cbranch_scc0 G2l_r3
    v_mfma_f32_16x16x32_bf16 v[48:51], v[192:195], v[32:35], v[48:51]
    ds_read_b128 v[232:235], v8 offset:40960
    v_mfma_f32_16x16x32_bf16 v[52:55], v[192:195], v[36:39], v[52:55]
    buffer_load_dword v14, v15, s[64:67], 0 offen sc1
    v_mfma_f32_16x16x32_bf16 v[56:59], v[192:195], v[40:43], v[56:59]
    ds_read_b128 v[236:239], v8 offset:49152
    v_mfma_f32_16x16x32_bf16 v[60:63], v[192:195], v[44:47], v[60:63]
    buffer_load_dwordx4 v[144:147], v4, s[8:11], s77 offen offset:3072
    v_mfma_f32_16x16x32_bf16 v[64:67], v[196:199], v[32:35], v[64:67]
    ds_read_b128 v[240:243], v8 offset:57344
    v_mfma_f32_16x16x32_bf16 v[68:71], v[196:199], v[36:39], v[68:71]
    buffer_load_dwordx4 v[148:151], v4, s[8:11], s78 offen offset:3072
    v_mfma_f32_16x16x32_bf16 v[72:75], v[196:199], v[40:43], v[72:75]
    ds_read_b128 v[244:247], v9 offset:0
    v_mfma_f32_16x16x32_bf16 v[76:79], v[196:199], v[44:47], v[76:79]
    buffer_load_dwordx4 v[152:155], v4, s[8:11], s79 offen offset:3072
    v_mfma_f32_16x16x32_bf16 v[80:83], v[200:203], v[32:35], v[80:83]
    ds_read_b128 v[248:251], v9 offset:8192
    v_mfma_f32_16x16x32_bf16 v[84:87], v[200:203], v[36:39], v[84:87]
    buffer_load_dwordx4 v[156:159], v4, s[8:11], s3 offen offset:3072
    v_mfma_f32_16x16x32_bf16 v[88:91], v[200:203], v[40:43], v[88:91]
    buffer_load_dwordx4 v[252:255], v11, s[80:83], 0 offen
    v_mfma_f32_16x16x32_bf16 v[92:95], v[200:203], v[44:47], v[92:95]
    buffer_load_dwordx4 v[164:167], v3, s[80:83], 0 offen
    v_mfma_f32_16x16x32_bf16 v[96:99], v[204:207], v[32:35], v[96:99]
    v_mfma_f32_16x16x32_bf16 v[100:103], v[204:207], v[36:39], v[100:103]
    v_mfma_f32_16x16x32_bf16 v[104:107], v[204:207], v[40:43], v[104:107]
    v_mfma_f32_16x16x32_bf16 v[108:111], v[204:207], v[44:47], v[108:111]
    v_mfma_f32_16x16x32_bf16 v[112:115], v[208:211], v[32:35], v[112:115]
    v_mfma_f32_16x16x32_bf16 v[116:119], v[208:211], v[36:39], v[116:119]
    v_mfma_f32_16x16x32_bf16 v[120:123], v[208:211], v[40:43], v[120:123]
    v_mfma_f32_16x16x32_bf16 v[124:127], v[208:211], v[44:47], v[124:127]
    s_waitcnt vmcnt(7) lgkmcnt(0)
    v_mfma_f32_16x16x32_bf16 v[48:51], v[212:215], v[128:131], v[48:51]
    ds_read_b128 v[192:195], v8 offset:0
    v_mfma_f32_16x16x32_bf16 v[52:55], v[212:215], v[132:135], v[52:55]
    ds_read_b128 v[196:199], v8 offset:8192
    v_mfma_f32_16x16x32_bf16 v[56:59], v[212:215], v[136:139], v[56:59]
    ds_read_b128 v[200:203], v8 offset:16384
    v_mfma_f32_16x16x32_bf16 v[60:63], v[212:215], v[140:143], v[60:63]
    ds_read_b128 v[204:207], v8 offset:24576
    v_mfma_f32_16x16x32_bf16 v[64:67], v[216:219], v[128:131], v[64:67]
    ds_read_b128 v[208:211], v8 offset:32768
    v_mfma_f32_16x16x32_bf16 v[68:71], v[216:219], v[132:135], v[68:71]
    v_mfma_f32_16x16x32_bf16 v[72:75], v[216:219], v[136:139], v[72:75]
    v_mfma_f32_16x16x32_bf16 v[76:79], v[216:219], v[140:143], v[76:79]
    v_mfma_f32_16x16x32_bf16 v[80:83], v[220:223], v[128:131], v[80:83]
    v_mfma_f32_16x16x32_bf16 v[84:87], v[220:223], v[132:135], v[84:87]
    v_mfma_f32_16x16x32_bf16 v[88:91], v[220:223], v[136:139], v[88:91]
    v_mfma_f32_16x16x32_bf16 v[92:95], v[220:223], v[140:143], v[92:95]
    v_mfma_f32_16x16x32_bf16 v[96:99], v[224:227], v[128:131], v[96:99]
    v_mfma_f32_16x16x32_bf16 v[100:103], v[224:227], v[132:135], v[100:103]
    v_mfma_f32_16x16x32_bf16 v[104:107], v[224:227], v[136:139], v[104:107]
    v_mfma_f32_16x16x32_bf16 v[108:111], v[224:227], v[140:143], v[108:111]
    v_mfma_f32_16x16x32_bf16 v[112:115], v[228:231], v[128:131], v[112:115]
    v_mfma_f32_16x16x32_bf16 v[116:119], v[228:231], v[132:135], v[116:119]
    v_mfma_f32_16x16x32_bf16 v[120:123], v[228:231], v[136:139], v[120:123]
    v_mfma_f32_16x16x32_bf16 v[124:127], v[228:231], v[140:143], v[124:127]
    s_waitcnt vmcnt(6)
    v_cmp_ne_u32 vcc, s75, v14
    s_and_b32 s40, vcc_lo, 0xff0
    s_cbranch_scc0 G2l_nq_go
    s_mov_b32 s49, 0
    buffer_load_dword v14, v15, s[64:67], 0 offen sc1
    s_sleep 8
G2l_nq:
    buffer_load_dword v5, v15, s[64:67], 0 offen sc1
    s_waitcnt vmcnt(1)
    v_cmp_ne_u32 vcc, s75, v14
    s_and_b32 s40, vcc_lo, 0xff0
    s_cbranch_scc0 G2l_nq_go
    buffer_load_dword v14, v15, s[64:67], 0 offen sc1
    s_waitcnt vmcnt(1)
    v_cmp_ne_u32 vcc, s75, v5
    s_and_b32 s40, vcc_lo, 0xff0
    s_cbranch_scc0 G2l_nq_go
    s_add_u32 s49, s49, 1
    s_cmp_lt_u32 s49, 0x40000
    s_cbranch_scc1 G2l_nq
G2l_nq_go:
    buffer_load_dwordx4 v[16:19], v4, s[8:11], s12 offen offset:0
    buffer_load_dwordx4 v[20:23], v4, s[8:11], s13 offen offset:0
    buffer_load_dwordx4 v[24:27], v4, s[8:11], s14 offen offset:0
    buffer_load_dwordx4 v[28:31], v4, s[8:11], s15 offen offset:0
    buffer_load_dwordx4 v[32:35], v4, s[8:11], s12 offen offset:1024
    buffer_load_dwordx4 v[36:39], v4, s[8:11], s13 offen offset:1024
    buffer_load_dwordx4 v[40:43], v4, s[8:11], s14 offen offset:1024
    buffer_load_dwordx4 v[44:47], v4, s[8:11], s15 offen offset:1024
    s_branch G2l_m
G2l_r3:
    v_mfma_f32_16x16x32_bf16 v[48:51], v[192:195], v[32:35], v[48:51]
    ds_read_b128 v[232:235], v8 offset:40960
    v_mfma_f32_16x16x32_bf16 v[52:55], v[192:195], v[36:39], v[52:55]
    buffer_load_dwordx4 v[144:147], v4, s[8:11], s77 offen offset:3072
    v_mfma_f32_16x16x32_bf16 v[56:59], v[192:195], v[40:43], v[56:59]
    ds_read_b128 v[236:239], v8 offset:49152
    v_mfma_f32_16x16x32_bf16 v[60:63], v[192:195], v[44:47], v[60:63]
    buffer_load_dwordx4 v[148:151], v4, s[8:11], s78 offen offset:3072
    v_mfma_f32_16x16x32_bf16 v[64:67], v[196:199], v[32:35], v[64:67]
    ds_read_b128 v[240:243], v8 offset:57344
    v_mfma_f32_16x16x32_bf16 v[68:71], v[196:199], v[36:39], v[68:71]
    buffer_load_dwordx4 v[152:155], v4, s[8:11], s79 offen offset:3072
    v_mfma_f32_16x16x32_bf16 v[72:75], v[196:199], v[40:43], v[72:75]
    ds_read_b128 v[244:247], v9 offset:0
    v_mfma_f32_16x16x32_bf16 v[76:79], v[196:199], v[44:47], v[76:79]
    buffer_load_dwordx4 v[156:159], v4, s[8:11], s3 offen offset:3072
    v_mfma_f32_16x16x32_bf16 v[80:83], v[200:203], v[32:35], v[80:83]
    ds_read_b128 v[248:251], v9 offset:8192
    v_mfma_f32_16x16x32_bf16 v[84:87], v[200:203], v[36:39], v[84:87]
    buffer_load_dwordx4 v[252:255], v11, s[80:83], 0 offen
    v_mfma_f32_16x16x32_bf16 v[88:91], v[200:203], v[40:43], v[88:91]
    buffer_load_dwordx4 v[164:167], v3, s[80:83], 0 offen
    v_mfma_f32_16x16x32_bf16 v[92:95], v[200:203], v[44:47], v[92:95]
    v_mfma_f32_16x16x32_bf16 v[96:99], v[204:207], v[32:35], v[96:99]
    v_mfma_f32_16x16x32_bf16 v[100:103], v[204:207], v[36:39], v[100:103]
    v_mfma_f32_16x16x32_bf16 v[104:107], v[204:207], v[40:43], v[104:107]
    v_mfma_f32_16x16x32_bf16 v[108:111], v[204:207], v[44:47], v[108:111]
    v_mfma_f32_16x16x32_bf16 v[112:115], v[208:211], v[32:35], v[112:115]
    v_mfma_f32_16x16x32_bf16 v[116:119], v[208:211], v[36:39], v[116:119]
    v_mfma_f32_16x16x32_bf16 v[120:123], v[208:211], v[40:43], v[120:123]
    v_mfma_f32_16x16x32_bf16 v[124:127], v[208:211], v[44:47], v[124:127]
    s_waitcnt vmcnt(6) lgkmcnt(0)
    v_mfma_f32_16x16x32_bf16 v[48:51], v[212:215], v[128:131], v[48:51]
    ds_read_b128 v[192:195], v8 offset:0
    v_mfma_f32_16x16x32_bf16 v[52:55], v[212:215], v[132:135], v[52:55]
    buffer_load_dwordx4 v[16:19], v4, s[8:11], s12 offen offset:0
    v_mfma_f32_16x16x32_bf16 v[56:59], v[212:215], v[136:139], v[56:59]
    ds_read_b128 v[196:199], v8 offset:8192
    v_mfma_f32_16x16x32_bf16 v[60:63], v[212:215], v[140:143], v[60:63]
    buffer_load_dwordx4 v[20:23], v4, s[8:11], s13 offen offset:0
    v_mfma_f32_16x16x32_bf16 v[64:67], v[216:219], v[128:131], v[64:67]
    ds_read_b128 v[200:203], v8 offset:16384
    v_mfma_f32_16x16x32_bf16 v[68:71], v[216:219], v[132:135], v[68:71]
    buffer_load_dwordx4 v[24:27], v4, s[8:11], s14 offen offset:0
    v_mfma_f32_16x16x32_bf16 v[72:75], v[216:219], v[136:139], v[72:75]
    ds_read_b128 v[204:207], v8 offset:24576
    v_mfma_f32_16x16x32_bf16 v[76:79], v[216:219], v[140:143], v[76:79]
    buffer_load_dwordx4 v[28:31], v4, s[8:11], s15 offen offset:0
    v_mfma_f32_16x16x32_bf16 v[80:83], v[220:223], v[128:131], v[80:83]
    ds_read_b128 v[208:211], v8 offset:32768
    v_mfma_f32_16x16x32_bf16 v[84:87], v[220:223], v[132:135], v[84:87]
    buffer_load_dwordx4 v[32:35], v4, s[8:11], s12 offen offset:1024
    v_mfma_f32_16x16x32_bf16 v[88:91], v[220:223], v[136:139], v[88:91]
    buffer_load_dwordx4 v[36:39], v4, s[8:11], s13 offen offset:1024
    v_mfma_f32_16x16x32_bf16 v[92:95], v[220:223], v[140:143], v[92:95]
    buffer_load_dwordx4 v[40:43], v4, s[8:11], s14 offen offset:1024
    v_mfma_f32_16x16x32_bf16 v[96:99], v[224:227], v[128:131], v[96:99]
    buffer_load_dwordx4 v[44:47], v4, s[8:11], s15 offen offset:1024
    v_mfma_f32_16x16x32_bf16 v[100:103], v[224:227], v[132:135], v[100:103]
    v_mfma_f32_16x16x32_bf16 v[104:107], v[224:227], v[136:139], v[104:107]
    v_mfma_f32_16x16x32_bf16 v[108:111], v[224:227], v[140:143], v[108:111]
    v_mfma_f32_16x16x32_bf16 v[112:115], v[228:231], v[128:131], v[112:115]
    v_mfma_f32_16x16x32_bf16 v[116:119], v[228:231], v[132:135], v[116:119]
    v_mfma_f32_16x16x32_bf16 v[120:123], v[228:231], v[136:139], v[120:123]
    v_mfma_f32_16x16x32_bf16 v[124:127], v[228:231], v[140:143], v[124:127]
G2l_m:
    s_waitcnt vmcnt(10) lgkmcnt(0)
    s_mul_i32 s40, s24, 40960
    s_sub_u32 s41, 40960, s40
    v_mfma_f32_16x16x32_bf16 v[48:51], v[232:235], v[144:147], v[48:51]
    v_mfma_f32_16x16x32_bf16 v[52:55], v[232:235], v[148:151], v[52:55]
    v_mfma_f32_16x16x32_bf16 v[56:59], v[232:235], v[152:155], v[56:59]
    v_mfma_f32_16x16x32_bf16 v[60:63], v[232:235], v[156:159], v[60:63]
    s_waitcnt vmcnt(4) lgkmcnt(0)
    v_mfma_f32_16x16x32_bf16 v[48:51], v[192:195], v[16:19], v[48:51]
    v_mfma_f32_16x16x32_bf16 v[52:55], v[192:195], v[20:23], v[52:55]
    v_mfma_f32_16x16x32_bf16 v[56:59], v[192:195], v[24:27], v[56:59]
    v_mfma_f32_16x16x32_bf16 v[60:63], v[192:195], v[28:31], v[60:63]
    s_waitcnt vmcnt(0) lgkmcnt(0)
    v_mfma_f32_16x16x32_bf16 v[48:51], v[172:175], v[32:35], v[48:51]
    v_lshrrev_b32 v13, 5, v4
    v_and_b32 v13, 16, v13
    v_xor_b32 v12, v13, v8
    v_lshrrev_b32 v13, 1, v4
    v_and_b32 v13, 128, v13
    v_mfma_f32_16x16x32_bf16 v[52:55], v[172:175], v[36:39], v[52:55]
    v_xor_b32 v13, v13, v12
    v_add_u32 v12, s40, v13
    v_add_u32 v14, s41, v13
    v_mfma_f32_16x16x32_bf16 v[56:59], v[172:175], v[40:43], v[56:59]
    v_mfma_f32_16x16x32_bf16 v[60:63], v[172:175], v[44:47], v[60:63]
    v_mfma_f32_16x16x32_bf16 v[64:67], v[236:239], v[144:147], v[64:67]
    v_cvt_pk_f16_f32 v48, v48, v49
    v_cvt_pk_f16_f32 v49, v50, v51
    v_mfma_f32_16x16x32_bf16 v[68:71], v[236:239], v[148:151], v[68:71]
    v_cvt_pk_f16_f32 v50, v52, v53
    v_cvt_pk_f16_f32 v51, v54, v55
    s_nop 0
    v_mfma_f32_16x16x32_bf16 v[64:67], v[196:199], v[16:19], v[64:67]
    v_permlane16_swap_b32 v48, v50
    v_permlane16_swap_b32 v49, v51
    v_mfma_f32_16x16x32_bf16 v[68:71], v[196:199], v[20:23], v[68:71]
    ds_write_b128 v12, v[48:51] offset:0
    v_xor_b32 v12, 32, v12
    v_mfma_f32_16x16x32_bf16 v[64:67], v[176:179], v[32:35], v[64:67]
    v_cvt_pk_f16_f32 v56, v56, v57
    v_cvt_pk_f16_f32 v57, v58, v59
    v_mfma_f32_16x16x32_bf16 v[68:71], v[176:179], v[36:39], v[68:71]
    v_cvt_pk_f16_f32 v58, v60, v61
    v_cvt_pk_f16_f32 v59, v62, v63
    s_nop 0
    v_mfma_f32_16x16x32_bf16 v[72:75], v[236:239], v[152:155], v[72:75]
    v_permlane16_swap_b32 v56, v58
    v_permlane16_swap_b32 v57, v59
    v_mfma_f32_16x16x32_bf16 v[76:79], v[236:239], v[156:159], v[76:79]
    ds_write_b128 v14, v[56:59] offset:0
    v_xor_b32 v14, 32, v14
    v_mfma_f32_16x16x32_bf16 v[72:75], v[196:199], v[24:27], v[72:75]
    v_cvt_pk_f16_f32 v64, v64, v65
    v_cvt_pk_f16_f32 v65, v66, v67
    v_mfma_f32_16x16x32_bf16 v[76:79], v[196:199], v[28:31], v[76:79]
    v_cvt_pk_f16_f32 v66, v68, v69
    v_cvt_pk_f16_f32 v67, v70, v71
    s_nop 0
    v_mfma_f32_16x16x32_bf16 v[72:75], v[176:179], v[40:43], v[72:75]
    v_permlane16_swap_b32 v64, v66
    v_permlane16_swap_b32 v65, v67
    v_mfma_f32_16x16x32_bf16 v[76:79], v[176:179], v[44:47], v[76:79]
    ds_write_b128 v12, v[64:67] offset:8192
    v_xor_b32 v12, 96, v12
    v_mfma_f32_16x16x32_bf16 v[80:83], v[240:243], v[144:147], v[80:83]
    v_mfma_f32_16x16x32_bf16 v[84:87], v[240:243], v[148:151], v[84:87]
    v_mfma_f32_16x16x32_bf16 v[80:83], v[200:203], v[16:19], v[80:83]
    v_cvt_pk_f16_f32 v72, v72, v73
    v_cvt_pk_f16_f32 v73, v74, v75
    v_mfma_f32_16x16x32_bf16 v[84:87], v[200:203], v[20:23], v[84:87]
    v_cvt_pk_f16_f32 v74, v76, v77
    v_cvt_pk_f16_f32 v75, v78, v79
    s_nop 0
    v_mfma_f32_16x16x32_bf16 v[80:83], v[180:183], v[32:35], v[80:83]
    v_permlane16_swap_b32 v72, v74
    v_permlane16_swap_b32 v73, v75
    v_mfma_f32_16x16x32_bf16 v[84:87], v[180:183], v[36:39], v[84:87]
    ds_write_b128 v14, v[72:75] offset:8192
    v_xor_b32 v14, 96, v14
    v_mfma_f32_16x16x32_bf16 v[88:91], v[240:243], v[152:155], v[88:91]
    v_mfma_f32_16x16x32_bf16 v[92:95], v[240:243], v[156:159], v[92:95]
    v_mfma_f32_16x16x32_bf16 v[88:91], v[200:203], v[24:27], v[88:91]
    v_cvt_pk_f16_f32 v80, v80, v81
    v_cvt_pk_f16_f32 v81, v82, v83
    v_mfma_f32_16x16x32_bf16 v[92:95], v[200:203], v[28:31], v[92:95]
    v_cvt_pk_f16_f32 v82, v84, v85
    v_cvt_pk_f16_f32 v83, v86, v87
    s_nop 0
    v_mfma_f32_16x16x32_bf16 v[88:91], v[180:183], v[40:43], v[88:91]
    v_permlane16_swap_b32 v80, v82
    v_permlane16_swap_b32 v81, v83
    v_mfma_f32_16x16x32_bf16 v[92:95], v[180:183], v[44:47], v[92:95]
    ds_write_b128 v12, v[80:83] offset:16384
    v_xor_b32 v12, 32, v12
    v_mfma_f32_16x16x32_bf16 v[96:99], v[244:247], v[144:147], v[96:99]
    v_lshlrev_b32 v52, 16, v252
    v_and_b32 v53, 0xffff0000, v252
    v_mfma_f32_16x16x32_bf16 v[100:103], v[244:247], v[148:151], v[100:103]
    v_lshlrev_b32 v54, 16, v253
    v_and_b32 v55, 0xffff0000, v253
    v_mfma_f32_16x16x32_bf16 v[96:99], v[204:207], v[16:19], v[96:99]
    v_cvt_pk_f16_f32 v88, v88, v89
    v_cvt_pk_f16_f32 v89, v90, v91
    v_mfma_f32_16x16x32_bf16 v[100:103], v[204:207], v[20:23], v[100:103]
    v_cvt_pk_f16_f32 v90, v92, v93
    v_cvt_pk_f16_f32 v91, v94, v95
    s_nop 0
    v_mfma_f32_16x16x32_bf16 v[96:99], v[184:187], v[32:35], v[96:99]
    v_permlane16_swap_b32 v88, v90
    v_permlane16_swap_b32 v89, v91
    v_mfma_f32_16x16x32_bf16 v[100:103], v[184:187], v[36:39], v[100:103]
    ds_write_b128 v14, v[88:91] offset:16384
    v_xor_b32 v14, 32, v14
    v_mfma_f32_16x16x32_bf16 v[104:107], v[244:247], v[152:155], v[104:107]
    v_lshlrev_b32 v60, 16, v254
    v_and_b32 v61, 0xffff0000, v254
    v_mfma_f32_16x16x32_bf16 v[108:111], v[244:247], v[156:159], v[108:111]
    v_lshlrev_b32 v62, 16, v255
    v_and_b32 v63, 0xffff0000, v255
    v_mfma_f32_16x16x32_bf16 v[104:107], v[204:207], v[24:27], v[104:107]
    v_cvt_pk_f16_f32 v96, v96, v97
    v_cvt_pk_f16_f32 v97, v98, v99
    v_mfma_f32_16x16x32_bf16 v[108:111], v[204:207], v[28:31], v[108:111]
    v_cvt_pk_f16_f32 v98, v100, v101
    v_cvt_pk_f16_f32 v99, v102, v103
    s_nop 0
    v_mfma_f32_16x16x32_bf16 v[104:107], v[184:187], v[40:43], v[104:107]
    v_permlane16_swap_b32 v96, v98
    v_permlane16_swap_b32 v97, v99
    v_mfma_f32_16x16x32_bf16 v[108:111], v[184:187], v[44:47], v[108:111]
    ds_write_b128 v12, v[96:99] offset:24576
    v_xor_b32 v12, 96, v12
    v_mfma_f32_16x16x32_bf16 v[112:115], v[248:251], v[144:147], v[112:115]
    v_lshlrev_b32 v68, 16, v164
    v_and_b32 v69, 0xffff0000, v164
    v_mfma_f32_16x16x32_bf16 v[116:119], v[248:251], v[148:151], v[116:119]
    v_lshlrev_b32 v70, 16, v165
    v_and_b32 v71, 0xffff0000, v165
    v_mfma_f32_16x16x32_bf16 v[112:115], v[208:211], v[16:19], v[112:115]
    v_cvt_pk_f16_f32 v104, v104, v105
    v_cvt_pk_f16_f32 v105, v106, v107
    v_mfma_f32_16x16x32_bf16 v[116:119], v[208:211], v[20:23], v[116:119]
    v_cvt_pk_f16_f32 v106, v108, v109
    v_cvt_pk_f16_f32 v107, v110, v111
    s_nop 0
    v_mfma_f32_16x16x32_bf16 v[112:115], v[188:191], v[32:35], v[112:115]
    v_permlane16_swap_b32 v104, v106
    v_permlane16_swap_b32 v105, v107
    v_mfma_f32_16x16x32_bf16 v[116:119], v[188:191], v[36:39], v[116:119]
    ds_write_b128 v14, v[104:107] offset:24576
    v_xor_b32 v14, 96, v14
    v_mfma_f32_16x16x32_bf16 v[120:123], v[248:251], v[152:155], v[120:123]
    v_lshlrev_b32 v76, 16, v166
    v_and_b32 v77, 0xffff0000, v166
    v_mfma_f32_16x16x32_bf16 v[124:127], v[248:251], v[156:159], v[124:127]
    v_lshlrev_b32 v78, 16, v167
    v_and_b32 v79, 0xffff0000, v167
    v_mfma_f32_16x16x32_bf16 v[120:123], v[208:211], v[24:27], v[120:123]
    v_cvt_pk_f16_f32 v112, v112, v113
    v_cvt_pk_f16_f32 v113, v114, v115
    v_mfma_f32_16x16x32_bf16 v[124:127], v[208:211], v[28:31], v[124:127]
    v_cvt_pk_f16_f32 v114, v116, v117
    v_cvt_pk_f16_f32 v115, v118, v119
    s_nop 0
    v_mfma_f32_16x16x32_bf16 v[120:123], v[188:191], v[40:43], v[120:123]
    v_permlane16_swap_b32 v112, v114
    v_permlane16_swap_b32 v113, v115
    v_mfma_f32_16x16x32_bf16 v[124:127], v[188:191], v[44:47], v[124:127]
    ds_write_b128 v12, v[112:115] offset:32768
G2_fin:
    s_mov_b32 s12, s6
    s_mov_b32 s13, s7
    s_and_b32 s13, s13, 0xffff
    s_mov_b32 s14, 0x280000
    s_mov_b32 s15, 0x00020000
    s_nop 0
    v_cvt_pk_f16_f32 v120, v120, v121
    v_cvt_pk_f16_f32 v121, v122, v123
    v_cvt_pk_f16_f32 v122, v124, v125
    v_cvt_pk_f16_f32 v123, v126, v127
    s_nop 1
    v_permlane16_swap_b32 v120, v122
    v_permlane16_swap_b32 v121, v123
    ds_write_b128 v14, v[120:123] offset:32768
    s_setprio 0
    s_waitcnt vmcnt(0) lgkmcnt(0)
    s_barrier
    ds_read_b128 v[16:19], v6 offset:0
    ds_read_b128 v[20:23], v6 offset:1024
    ds_read_b128 v[24:27], v6 offset:2048
    ds_read_b128 v[28:31], v6 offset:3072
    ds_read_b128 v[32:35], v6 offset:4096
    ds_read_b128 v[36:39], v6 offset:5120
    ds_read_b128 v[40:43], v6 offset:6144
    ds_read_b128 v[44:47], v6 offset:7168
    s_cmp_ge_u32 s22, 2
    s_cbranch_scc1 G2_two
    ds_read_b128 v[192:195], v2 offset:0
    ds_read_b128 v[196:199], v2 offset:1024
    ds_read_b128 v[200:203], v2 offset:2048
    ds_read_b128 v[204:207], v2 offset:3072
    ds_read_b128 v[208:211], v2 offset:4096
    ds_read_b128 v[212:215], v2 offset:5120
    ds_read_b128 v[216:219], v2 offset:6144
    ds_read_b128 v[220:223], v2 offset:7168
    s_waitcnt lgkmcnt(14)
    v_pk_add_f16 v16, v16, v20
    v_pk_add_f16 v17, v17, v21
    v_pk_add_f16 v18, v18, v22
    v_pk_add_f16 v19, v19, v23
    s_waitcnt lgkmcnt(12)
    v_pk_add_f16 v24, v24, v28
    v_pk_add_f16 v25, v25, v29
    v_pk_add_f16 v26, v26, v30
    v_pk_add_f16 v27, v27, v31
    v_pk_add_f16 v16, v16, v24
    v_pk_add_f16 v17, v17, v25
    v_pk_add_f16 v18, v18, v26
    v_pk_add_f16 v19, v19, v27
    v_fma_mix_f32 v52, v16, 1.0, v52 op_sel:[0,0,0] op_sel_hi:[1,0,0]
    v_fma_mix_f32 v53, v16, 1.0, v53 op_sel:[1,0,0] op_sel_hi:[1,0,0]
    v_fma_mix_f32 v54, v17, 1.0, v54 op_sel:[0,0,0] op_sel_hi:[1,0,0]
    v_fma_mix_f32 v55, v17, 1.0, v55 op_sel:[1,0,0] op_sel_hi:[1,0,0]
    v_fma_mix_f32 v60, v18, 1.0, v60 op_sel:[0,0,0] op_sel_hi:[1,0,0]
    v_fma_mix_f32 v61, v18, 1.0, v61 op_sel:[1,0,0] op_sel_hi:[1,0,0]
    v_fma_mix_f32 v62, v19, 1.0, v62 op_sel:[0,0,0] op_sel_hi:[1,0,0]
    v_fma_mix_f32 v63, v19, 1.0, v63 op_sel:[1,0,0] op_sel_hi:[1,0,0]
    s_waitcnt lgkmcnt(10)
    v_pk_add_f16 v32, v32, v36
    v_pk_add_f16 v33, v33, v37
    v_pk_add_f16 v34, v34, v38
    v_pk_add_f16 v35, v35, v39
    s_waitcnt lgkmcnt(8)
    v_pk_add_f16 v40, v40, v44
    v_pk_add_f16 v41, v41, v45
    v_pk_add_f16 v42, v42, v46
    v_pk_add_f16 v43, v43, v47
    v_pk_add_f16 v32, v32, v40
    v_pk_add_f16 v33, v33, v41
    v_pk_add_f16 v34, v34, v42
    v_pk_add_f16 v35, v35, v43
    v_fma_mix_f32 v52, v32, 1.0, v52 op_sel:[0,0,0] op_sel_hi:[1,0,0]
    v_fma_mix_f32 v53, v32, 1.0, v53 op_sel:[1,0,0] op_sel_hi:[1,0,0]
    v_fma_mix_f32 v54, v33, 1.0, v54 op_sel:[0,0,0] op_sel_hi:[1,0,0]
    v_fma_mix_f32 v55, v33, 1.0, v55 op_sel:[1,0,0] op_sel_hi:[1,0,0]
    v_fma_mix_f32 v60, v34, 1.0, v60 op_sel:[0,0,0] op_sel_hi:[1,0,0]
    v_fma_mix_f32 v61, v34, 1.0, v61 op_sel:[1,0,0] op_sel_hi:[1,0,0]
    v_fma_mix_f32 v62, v35, 1.0, v62 op_sel:[0,0,0] op_sel_hi:[1,0,0]
    v_fma_mix_f32 v63, v35, 1.0, v63 op_sel:[1,0,0] op_sel_hi:[1,0,0]
    v_cvt_pk_bf16_f32 v24, v52, v53
    v_cvt_pk_bf16_f32 v25, v54, v55
    v_cvt_pk_bf16_f32 v26, v60, v61
    v_cvt_pk_bf16_f32 v27, v62, v63
    buffer_store_dwordx4 v[24:27], v11, s[12:15], 0 offen
    s_waitcnt lgkmcnt(6)
    v_pk_add_f16 v192, v192, v196
    v_pk_add_f16 v193, v193, v197
    v_pk_add_f16 v194, v194, v198
    v_pk_add_f16 v195, v195, v199
    s_waitcnt lgkmcnt(4)
    v_pk_add_f16 v200, v200, v204
    v_pk_add_f16 v201, v201, v205
    v_pk_add_f16 v202, v202, v206
    v_pk_add_f16 v203, v203, v207
    v_pk_add_f16 v192, v192, v200
    v_pk_add_f16 v193, v193, v201
    v_pk_add_f16 v194, v194, v202
    v_pk_add_f16 v195, v195, v203
    v_fma_mix_f32 v68, v192, 1.0, v68 op_sel:[0,0,0] op_sel_hi:[1,0,0]
    v_fma_mix_f32 v69, v192, 1.0, v69 op_sel:[1,0,0] op_sel_hi:[1,0,0]
    v_fma_mix_f32 v70, v193, 1.0, v70 op_sel:[0,0,0] op_sel_hi:[1,0,0]
    v_fma_mix_f32 v71, v193, 1.0, v71 op_sel:[1,0,0] op_sel_hi:[1,0,0]
    v_fma_mix_f32 v76, v194, 1.0, v76 op_sel:[0,0,0] op_sel_hi:[1,0,0]
    v_fma_mix_f32 v77, v194, 1.0, v77 op_sel:[1,0,0] op_sel_hi:[1,0,0]
    v_fma_mix_f32 v78, v195, 1.0, v78 op_sel:[0,0,0] op_sel_hi:[1,0,0]
    v_fma_mix_f32 v79, v195, 1.0, v79 op_sel:[1,0,0] op_sel_hi:[1,0,0]
    s_waitcnt lgkmcnt(2)
    v_pk_add_f16 v208, v208, v212
    v_pk_add_f16 v209, v209, v213
    v_pk_add_f16 v210, v210, v214
    v_pk_add_f16 v211, v211, v215
    s_waitcnt lgkmcnt(0)
    v_pk_add_f16 v216, v216, v220
    v_pk_add_f16 v217, v217, v221
    v_pk_add_f16 v218, v218, v222
    v_pk_add_f16 v219, v219, v223
    v_pk_add_f16 v208, v208, v216
    v_pk_add_f16 v209, v209, v217
    v_pk_add_f16 v210, v210, v218
    v_pk_add_f16 v211, v211, v219
    v_fma_mix_f32 v68, v208, 1.0, v68 op_sel:[0,0,0] op_sel_hi:[1,0,0]
    v_fma_mix_f32 v69, v208, 1.0, v69 op_sel:[1,0,0] op_sel_hi:[1,0,0]
    v_fma_mix_f32 v70, v209, 1.0, v70 op_sel:[0,0,0] op_sel_hi:[1,0,0]
    v_fma_mix_f32 v71, v209, 1.0, v71 op_sel:[1,0,0] op_sel_hi:[1,0,0]
    v_fma_mix_f32 v76, v210, 1.0, v76 op_sel:[0,0,0] op_sel_hi:[1,0,0]
    v_fma_mix_f32 v77, v210, 1.0, v77 op_sel:[1,0,0] op_sel_hi:[1,0,0]
    v_fma_mix_f32 v78, v211, 1.0, v78 op_sel:[0,0,0] op_sel_hi:[1,0,0]
    v_fma_mix_f32 v79, v211, 1.0, v79 op_sel:[1,0,0] op_sel_hi:[1,0,0]
    v_cvt_pk_bf16_f32 v200, v68, v69
    v_cvt_pk_bf16_f32 v201, v70, v71
    v_cvt_pk_bf16_f32 v202, v76, v77
    v_cvt_pk_bf16_f32 v203, v78, v79
    buffer_store_dwordx4 v[200:203], v3, s[12:15], 0 offen
    s_branch G2_end
G2_two:
    s_waitcnt lgkmcnt(6)
    v_pk_add_f16 v16, v16, v20
    v_pk_add_f16 v17, v17, v21
    v_pk_add_f16 v18, v18, v22
    v_pk_add_f16 v19, v19, v23
    s_waitcnt lgkmcnt(4)
    v_pk_add_f16 v24, v24, v28
    v_pk_add_f16 v25, v25, v29
    v_pk_add_f16 v26, v26, v30
    v_pk_add_f16 v27, v27, v31
    v_pk_add_f16 v16, v16, v24
    v_pk_add_f16 v17, v17, v25
    v_pk_add_f16 v18, v18, v26
    v_pk_add_f16 v19, v19, v27
    v_fma_mix_f32 v52, v16, 1.0, v52 op_sel:[0,0,0] op_sel_hi:[1,0,0]
    v_fma_mix_f32 v53, v16, 1.0, v53 op_sel:[1,0,0] op_sel_hi:[1,0,0]
    v_fma_mix_f32 v54, v17, 1.0, v54 op_sel:[0,0,0] op_sel_hi:[1,0,0]
    v_fma_mix_f32 v55, v17, 1.0, v55 op_sel:[1,0,0] op_sel_hi:[1,0,0]
    v_fma_mix_f32 v60, v18, 1.0, v60 op_sel:[0,0,0] op_sel_hi:[1,0,0]
    v_fma_mix_f32 v61, v18, 1.0, v61 op_sel:[1,0,0] op_sel_hi:[1,0,0]
    v_fma_mix_f32 v62, v19, 1.0, v62 op_sel:[0,0,0] op_sel_hi:[1,0,0]
    v_fma_mix_f32 v63, v19, 1.0, v63 op_sel:[1,0,0] op_sel_hi:[1,0,0]
    s_waitcnt lgkmcnt(2)
    v_pk_add_f16 v32, v32, v36
    v_pk_add_f16 v33, v33, v37
    v_pk_add_f16 v34, v34, v38
    v_pk_add_f16 v35, v35, v39
    s_waitcnt lgkmcnt(0)
    v_pk_add_f16 v40, v40, v44
    v_pk_add_f16 v41, v41, v45
    v_pk_add_f16 v42, v42, v46
    v_pk_add_f16 v43, v43, v47
    v_pk_add_f16 v32, v32, v40
    v_pk_add_f16 v33, v33, v41
    v_pk_add_f16 v34, v34, v42
    v_pk_add_f16 v35, v35, v43
    v_fma_mix_f32 v52, v32, 1.0, v52 op_sel:[0,0,0] op_sel_hi:[1,0,0]
    v_fma_mix_f32 v53, v32, 1.0, v53 op_sel:[1,0,0] op_sel_hi:[1,0,0]
    v_fma_mix_f32 v54, v33, 1.0, v54 op_sel:[0,0,0] op_sel_hi:[1,0,0]
    v_fma_mix_f32 v55, v33, 1.0, v55 op_sel:[1,0,0] op_sel_hi:[1,0,0]
    v_fma_mix_f32 v60, v34, 1.0, v60 op_sel:[0,0,0] op_sel_hi:[1,0,0]
    v_fma_mix_f32 v61, v34, 1.0, v61 op_sel:[1,0,0] op_sel_hi:[1,0,0]
    v_fma_mix_f32 v62, v35, 1.0, v62 op_sel:[0,0,0] op_sel_hi:[1,0,0]
    v_fma_mix_f32 v63, v35, 1.0, v63 op_sel:[1,0,0] op_sel_hi:[1,0,0]
    v_cvt_pk_bf16_f32 v24, v52, v53
    v_cvt_pk_bf16_f32 v25, v54, v55
    v_cvt_pk_bf16_f32 v26, v60, v61
    v_cvt_pk_bf16_f32 v27, v62, v63
    buffer_store_dwordx4 v[24:27], v11, s[12:15], 0 offen
    s_cmp_lg_u32 s48, 7
    s_cbranch_scc1 G2_end
    s_mov_b32 s49, 0
    v_lshlrev_b32 v7, 2, v4
G2_mp:
    v_subrev_u32 v160, s76, v160
    v_subrev_u32 v161, s76, v161
    v_subrev_u32 v162, s76, v162
    v_subrev_u32 v163, s76, v163
    v_max3_u32 v160, v160, v161, v162
    v_max_u32 v160, v160, v163
    v_cmp_ne_u32 vcc, 0, v160
    s_cmp_eq_u64 vcc, 0
    s_cbranch_scc1 G2_mo
    s_sleep 2
    buffer_load_dword v160, v7, s[64:67], s70 offen sc1
    buffer_load_dword v161, v7, s[64:67], s71 offen sc1
    buffer_load_dword v162, v7, s[64:67], s72 offen sc1
    buffer_load_dword v163, v7, s[64:67], s73 offen sc1
    s_waitcnt vmcnt(0)
    s_add_u32 s49, s49, 1
    s_cmp_lt_u32 s49, 0x40000
    s_cbranch_scc1 G2_mp
G2_mo:
    s_sub_u32 s40, s76, 0x9e3779b5
    v_mov_b32 v240, s40
    v_mov_b32 v241, 68608
    s_mov_b64 exec, 1
    buffer_store_dword v240, v241, s[64:67], 0 offen sc1
    s_mov_b64 exec, -1
G2_end:
G1_done:
    s_endpgm
.section .rodata,"a"
.p2align 6
.amdhsa_kernel g1_kernel
  .amdhsa_next_free_vgpr 256
  .amdhsa_next_free_sgpr 100
  .amdhsa_accum_offset 256
  .amdhsa_group_segment_fixed_size 0
  .amdhsa_kernarg_size 80
  .amdhsa_user_sgpr_count 2
  .amdhsa_user_sgpr_kernarg_segment_ptr 1
  .amdhsa_system_sgpr_workgroup_id_x 1
.end_amdhsa_kernel
```
